```python
import torch

def _softmax(x, axis=-1):
    return torch.softmax(x, dim=axis)
def _gelu(x):
    return torch.nn.functional.gelu(x, approximate="tanh")
def _silu(x):
    return torch.nn.functional.silu(x)
def _sigmoid(x):
    return torch.sigmoid(x)
def _layernorm(x, axis=-1, eps=1e-5):
    m = x.mean(dim=axis, keepdim=True)
    v = x.var(dim=axis, keepdim=True, unbiased=False)
    return (x - m) / torch.sqrt(v + eps)
def _scatter_add(tgt, idx, src, axis=0):
    return tgt.clone().index_add_(axis, idx, src)
def _segment_sum(src, seg, n):
    out = torch.zeros((n,) + src.shape[1:], dtype=src.dtype)
    return out.index_add_(0, seg, src)
def _pad(x, pw):
    flat = tuple(v for pair in reversed(pw) for v in pair)
    return torch.nn.functional.pad(x, flat)

kernel_name = 'gated_mix__linear_attn_block__dense_activation_relu__prompt'

def setup_inputs():

    _w = (lambda a: (lambda t: t.to(torch.bfloat16) if t.is_floating_point() else t)(torch.as_tensor(a)))
    def _A_setup():
        B, S, D = 1, 2048, 512
        return {
            "x": _w((lambda *s: torch.randn(*s, dtype=torch.bfloat16) * 0.05)(B, S, D)),
            "wqkv": _w((lambda *s: torch.randn(*s, dtype=torch.bfloat16) * 0.8)(D, 3 * D)),
            "wo": _w((lambda *s: torch.randn(*s, dtype=torch.bfloat16) * 0.2)(D, D)),
        }
    _A_in = _A_setup()

    def _B_setup():
        B, S, D, Dff = 1, 2048, 512, 1792
        return {
            "x": _w((lambda *s: torch.randn(*s, dtype=torch.bfloat16) * 0.05)(B, S, D)),
            "w1": _w((lambda *s: torch.randn(*s, dtype=torch.bfloat16) * 0.05)(D, Dff)),
            "w2": _w((lambda *s: torch.randn(*s, dtype=torch.bfloat16) * 0.05)(Dff, D)),
        }
    _B_in = _B_setup()

    return {
        "A_x": _A_in["x"],
        "A_wqkv": _A_in["wqkv"],
        "A_wo": _A_in["wo"],
        "B_x": _B_in["x"],
        "B_w1": _B_in["w1"],
        "B_w2": _B_in["w2"],
        "gate_w": _w((lambda *s: torch.randn(*s, dtype=torch.bfloat16) * 0.05)(512) * 16.0),
    }

def reference(A_x, A_wqkv, A_wo, B_x, B_w1, B_w2, gate_w):
    def _A_ref(x, wqkv, wo):
        B, S, D = x.shape
        H = 32; Dh = D // H
        qkv = (lambda x, *d: x.permute(*d))((x @ wqkv).reshape(B, S, 3, H, Dh), 2, 0, 3, 1, 4)
        q, k, v = qkv[0], qkv[1], qkv[2]
        phi = lambda t: torch.where(t > 0, t + 1, torch.exp(t)) + 1e-6
        pq, pk = phi(q), phi(k)
        kv = torch.einsum("bhsd,bhse->bhde", pk, v)
        z = torch.einsum("bhsd->bhd", pk)
        num = torch.einsum("bhqd,bhde->bhqe", pq, kv)
        den = torch.einsum("bhqd,bhd->bhq", pq, z)[..., None] + 1e-6
        o = num / den
        return (lambda x, *d: x.permute(*d))(o, 0, 2, 1, 3).reshape(B, S, D) @ wo

    def _B_ref(x, w1, w2):
        h = torch.einsum("bsd,df->bsf", x, w1)
        zero = torch.zeros_like(h)
        h = torch.maximum(h, zero)
        return torch.einsum("bsf,fd->bsd", h, w2)

    x = A_x
    g = _sigmoid((x * gate_w).sum(-1, keepdims=True))
    a = _A_ref(x, A_wqkv, A_wo)
    b = _B_ref(x, B_w1, B_w2)
    return g * a + (1 - g) * b
```

```asm
; @launch grid=(256,1,1) block=(512,1,1) lds=163840
.amdgcn_target "amdgcn-amd-amdhsa--gfx950"
.text
.globl gated_mix__linear_attn_block__dense_activation_relu__prompt_kernel
.p2align 8
.type gated_mix__linear_attn_block__dense_activation_relu__prompt_kernel,@function
gated_mix__linear_attn_block__dense_activation_relu__prompt_kernel:
  s_cmp_ge_u32 s2, 256
  s_cbranch_scc1 L_exit
  s_load_dwordx16 s[4:19], s[0:1], 0
  s_load_dwordx4 s[20:23], s[0:1], 64
  v_lshrrev_b32 v2, 6, v0
  v_and_b32 v1, 63, v0
  s_lshr_b32 s3, s2, 3
  v_readfirstlane_b32 s68, v2
  s_nop 1
  s_cmp_lg_u32 s68, 0
  s_cbranch_scc1 L_nopf
  s_and_b32 s62, s3, 7
  s_mul_i32 s62, s62, 7168
  v_lshlrev_b32 v2, 7, v1
  v_add_u32 v2, s62, v2
  s_getpc_b64 s[64:65]
L_pc:
  v_min_u32 v2, L_end-L_pc-4, v2
  s_mov_b32 exec_hi, 0xffffff
  global_load_dword v3, v2, s[64:65]
  s_mov_b64 exec, -1
L_nopf:
  s_and_b32 s52, s68, 3
  s_and_b32 s62, s2, 7
  s_and_b32 s53, s62, 1
  s_lshr_b32 s63, s3, 2
  s_lshl3_add_u32 s53, s53, s63
  s_and_b32 s54, s62, 6
  s_bfe_u32 s55, s2, 0x10001
  s_bfe_u32 s64, s3, 0x10001
  s_add_u32 s54, s54, s64
  s_add_u32 s55, s55, s63
  s_and_b32 s65, s3, 1
  s_and_b32 s64, s3, 3
  s_lshl_b32 s64, s64, 0
  s_add_u32 s55, s55, s64
  s_and_b32 s55, s55, 1
  s_lshl_b32 s69, s55, 7
  s_lshl_b32 s59, s52, 12
  s_cmp_lt_u32 s68, 4
  s_cbranch_scc1 L_comp
L_QL:
  s_lshl_b32 s62, s53, 17
  s_lshl_b32 s63, s52, 15
  s_add_u32 s62, s62, s63
  v_lshrrev_b32 v4, 3, v1
  v_lshlrev_b32 v5, 10, v4
  v_add_u32 v5, s62, v5
  v_lshrrev_b32 v6, 4, v1
  v_xor_b32 v6, v6, v1
  v_and_b32 v6, 7, v6
  v_lshlrev_b32 v6, 4, v6
  v_add_u32 v8, v5, v6
  v_xor_b32 v9, 64, v8
  v_add_u32 v9, 7168, v9
  v_add_u32 v10, 14336, v8
  v_add_u32 v11, 14336, v9
  s_mov_b32 s26, 2097152
  s_mov_b32 s27, 0x20000
  s_mov_b32 s55, s69
  s_add_u32 m0, s59, 0
  s_waitcnt lgkmcnt(0)
  s_mov_b32 s24, s4
  s_and_b32 s25, s5, 0xffff
  buffer_load_dwordx4 v8, s[24:27], s55 offen offset:0 lds
  buffer_load_dwordx4 v9, s[24:27], s55 offen offset:1024 lds
  buffer_load_dwordx4 v10, s[24:27], s55 offen offset:2048 lds
  buffer_load_dwordx4 v11, s[24:27], s55 offen offset:3072 lds
  s_cmp_lg_u32 s65, 0
  s_cbranch_scc1 L_KVL_w
L_QL_w:
  v_lshrrev_b32 v6, 3, v1
  v_and_b32 v6, 2, v6
  v_xor_b32 v6, v6, v1
  v_and_b32 v6, 7, v6
  v_lshlrev_b32 v16, 4, v6
  s_lshl_b32 s62, s52, 4
  v_add_u32 v17, s62, v4
  s_mov_b32 s62, 3584
  v_mad_u32_u24 v5, v17, s62, v16
  s_lshl_b32 s62, s54, 8
  s_add_u32 s62, s62, 4096
  v_add_u32 v12, s62, v5
  v_xor_b32 v13, 64, v12
  v_add_u32 v13, 27648, v13
  v_add_u32 v14, 4294965376, v12
  v_add_u32 v15, 4294965376, v13
  v_lshlrev_b32 v88, 4, v1
  v_mov_b32 v89, 0
  s_sub_u32 s32, s12, 4096
  s_subb_u32 s33, s13, 0
  s_and_b32 s33, s33, 0xffff
  s_mov_b32 s34, 1839104
  s_mov_b32 s35, 0x20000
  s_mul_i32 s62, s55, 1792
  s_add_u32 m0, s59, 16384
  s_nop 0
  buffer_load_dwordx4 v12, s[32:35], s62 offen offset:0 lds
  buffer_load_dwordx4 v13, s[32:35], s62 offen offset:1024 lds
  buffer_load_dwordx4 v14, s[32:35], s62 offen offset:2048 lds
  buffer_load_dwordx4 v15, s[32:35], s62 offen offset:3072 lds
  s_lshl_b32 s65, s53, 3
  s_add_u32 s65, s65, s54
  s_lshl_b32 s65, s65, 2
  s_add_u32 s65, s65, s52
  s_lshl_b32 s65, s65, 12
  buffer_load_dwordx4 v[20:23], v88, s[24:27], s65 offen offset:0
  buffer_load_dwordx4 v[24:27], v88, s[24:27], s65 offen offset:1024
  buffer_load_dwordx4 v[28:31], v88, s[24:27], s65 offen offset:2048
  buffer_load_dwordx4 v[32:35], v88, s[24:27], s65 offen offset:3072
  global_load_dwordx4 v[36:39], v88, s[16:17]
  s_barrier
  s_branch L_QL_rest
L_KVL_w:
  v_lshrrev_b32 v6, 3, v1
  v_and_b32 v6, 2, v6
  v_xor_b32 v6, v6, v1
  v_and_b32 v6, 7, v6
  v_lshlrev_b32 v16, 4, v6
  s_lshl_b32 s62, s52, 4
  v_add_u32 v17, s62, v4
  s_mov_b32 s62, 3072
  v_mad_u32_u24 v5, v17, s62, v16
  s_lshl_b32 s62, s54, 7
  s_add_u32 s62, s62, 5120
  v_add_u32 v12, s62, v5
  v_xor_b32 v13, 64, v12
  v_add_u32 v13, 23552, v13
  v_add_u32 v14, 4294966272, v12
  v_add_u32 v15, 4294966272, v13
  v_lshlrev_b32 v18, 4, v1
  v_mov_b32 v19, 0
  s_sub_u32 s28, s6, 4096
  s_subb_u32 s29, s7, 0
  s_and_b32 s29, s29, 0xffff
  s_mov_b32 s30, 1576960
  s_mov_b32 s31, 0x20000
  s_mul_i32 s62, s55, 1536
  s_add_u32 m0, s59, 16384
  s_nop 0
  buffer_load_dwordx4 v12, s[28:31], s62 offen offset:0 lds
  buffer_load_dwordx4 v13, s[28:31], s62 offen offset:1024 lds
  buffer_load_dwordx4 v14, s[28:31], s62 offen offset:2048 lds
  buffer_load_dwordx4 v15, s[28:31], s62 offen offset:3072 lds
  s_branch L_KVL_rest
L_comp:
  s_lshr_b32 s58, s2, 6
  s_and_b32 s57, s58, 0
  s_lshr_b32 s62, s2, 3
  s_xor_b32 s57, s57, s62
  s_and_b32 s57, s57, 7
  s_and_b32 s62, s2, 7
  s_lshl2_add_u32 s56, s62, s58
  s_lshl_b32 s60, s52, 11
  s_mul_i32 s61, s52, 3072
  s_and_b32 s65, s2, 8
  s_cmp_lg_u32 s65, 0
  s_cbranch_scc1 L_KVC
  s_branch L_QC
L_QC:
  s_waitcnt lgkmcnt(0)
  s_mov_b32 s24, s4
  s_and_b32 s25, s5, 0xffff
  s_mov_b32 s26, 2097152
  s_mov_b32 s27, 0x20000
  s_sub_u32 s32, s12, 4096
  s_subb_u32 s33, s13, 0
  s_and_b32 s33, s33, 0xffff
  s_mov_b32 s34, 1839104
  s_mov_b32 s35, 0x20000
  s_sub_u32 s28, s6, 4096
  s_subb_u32 s29, s7, 0
  s_and_b32 s29, s29, 0xffff
  s_mov_b32 s30, 1576960
  s_mov_b32 s31, 0x20000
  s_mov_b32 s36, s14
  s_and_b32 s37, s15, 0xffff
  s_mov_b32 s38, 1835008
  s_mov_b32 s39, 0x20000
  s_mov_b32 s40, s8
  s_and_b32 s41, s9, 0xffff
  s_mov_b32 s42, 524288
  s_mov_b32 s43, 0x20000
  s_barrier
  s_lshr_b32 s62, s2, 4
  s_lshl_b32 s62, s62, 3
  s_and_b32 s63, s2, 7
  s_add_u32 s62, s62, s63
  s_lshl_b32 s62, s62, 2
  s_add_u32 s62, s62, s52
  s_lshr_b32 s63, s62, 3
  s_add_u32 s63, s63, 128
  v_lshrrev_b32 v100, 1, v1
  v_lshlrev_b32 v100, 6, v100
  v_add_u32 v100, s63, v100
  s_and_b32 s63, s62, 7
  s_lshl_b32 s63, s63, 8
  s_add_u32 s63, s63, 5120
  v_and_b32 v101, 1, v1
  v_lshlrev_b32 v101, 7, v101
  s_mov_b32 s64, 3072
  v_mad_u32_u24 v102, v100, s64, v101
  v_add_u32 v102, s63, v102
  v_cmp_le_u32 vcc, 4, v1
  s_nop 1
  v_cndmask_b32 v4, v102, -1, vcc
  buffer_load_dword v3, v4, s[28:31], 0 offen
  s_lshr_b32 s63, s62, 3
  s_add_u32 s63, s63, 256
  v_lshrrev_b32 v100, 1, v1
  v_lshlrev_b32 v100, 6, v100
  v_add_u32 v100, s63, v100
  s_and_b32 s63, s62, 7
  s_lshl_b32 s63, s63, 8
  s_add_u32 s63, s63, 5120
  v_and_b32 v101, 1, v1
  v_lshlrev_b32 v101, 7, v101
  s_mov_b32 s64, 3072
  v_mad_u32_u24 v102, v100, s64, v101
  v_add_u32 v102, s63, v102
  v_cmp_le_u32 vcc, 8, v1
  s_nop 1
  v_cndmask_b32 v5, v102, -1, vcc
  buffer_load_dword v3, v5, s[28:31], 0 offen
  s_mul_i32 s63, s62, 3584
  s_add_u32 s63, s63, 6144
  v_lshlrev_b32 v102, 7, v1
  v_add_u32 v102, s63, v102
  v_cmp_le_u32 vcc, 12, v1
  s_nop 1
  v_cndmask_b32 v6, v102, -1, vcc
  buffer_load_dword v3, v6, s[32:35], 0 offen
  s_lshr_b32 s63, s62, 3
  s_add_u32 s63, s63, 128
  v_lshrrev_b32 v100, 1, v1
  v_lshlrev_b32 v100, 6, v100
  v_add_u32 v100, s63, v100
  s_and_b32 s63, s62, 7
  s_lshl_b32 s63, s63, 8
  s_add_u32 s63, s63, 4096
  v_and_b32 v101, 1, v1
  v_lshlrev_b32 v101, 7, v101
  s_mov_b32 s64, 3584
  v_mad_u32_u24 v102, v100, s64, v101
  v_add_u32 v102, s63, v102
  v_cmp_le_u32 vcc, 12, v1
  s_nop 1
  v_cndmask_b32 v7, v102, -1, vcc
  buffer_load_dword v3, v7, s[32:35], 0 offen
  s_mul_i32 s63, s62, 3072
  s_add_u32 s63, s63, 4096
  v_lshlrev_b32 v102, 7, v1
  v_add_u32 v102, s63, v102
  v_cmp_le_u32 vcc, 8, v1
  s_nop 1
  v_cndmask_b32 v8, v102, -1, vcc
  buffer_load_dword v3, v8, s[28:31], 0 offen
  s_mov_b32 s44, s22
  s_and_b32 s45, s23, 0xffff
  s_mov_b32 s46, 10354688
  s_mov_b32 s47, 0x20000
  s_mov_b32 s48, s18
  s_and_b32 s49, s19, 0xffff
  s_mov_b32 s50, 2097152
  s_mov_b32 s51, 0x20000
  v_lshlrev_b32 v103, 4, v1
  v_mov_b32 v104, 0
  v_lshrrev_b32 v102, 4, v1
  v_and_b32 v100, 15, v1
  v_lshlrev_b32 v101, 7, v100
  v_add_u32 v101, s59, v101
  v_lshrrev_b32 v100, 1, v100
  v_xor_b32 v100, v100, v102
  v_lshl_add_u32 v105, v100, 4, v101
  v_xor_b32 v106, 64, v105
  v_bfe_u32 v100, v1, 2, 2
  v_lshlrev_b32 v101, 7, v100
  v_lshrrev_b32 v100, 1, v100
  v_lshl_add_u32 v101, v100, 5, v101
  v_and_b32 v100, 3, v1
  v_lshl_add_u32 v101, v100, 3, v101
  v_and_b32 v100, 1, v102
  v_lshl_add_u32 v107, v100, 10, v101
  v_lshl_add_u32 v107, v100, 6, v107
  v_lshl_add_u32 v111, v100, 6, v101
  v_lshl_add_u32 v111, v102, 9, v111
  v_lshrrev_b32 v100, 1, v102
  v_lshl_add_u32 v107, v100, 12, v107
  v_xor_b32 v108, 32, v107
  v_xor_b32 v109, 64, v107
  v_xor_b32 v110, 96, v107
  s_lshr_b32 s62, s52, 1
  s_lshl_b32 s62, s62, 6
  v_xor_b32 v111, s62, v111
  v_xor_b32 v112, 32, v111
  s_and_b32 s62, s52, 1
  s_lshl_b32 s62, s62, 11
  v_add_u32 v113, s62, v103
  s_lshl_b32 s63, s53, 1
  s_lshr_b32 s64, s52, 1
  s_add_u32 s63, s63, s64
  s_mul_i32 s66, s63, 294912
  s_add_u32 s66, s66, s62
  s_mov_b32 s10, 0x3fb8aa3b
  s_mov_b32 s11, 0x3fb8aa3b
  s_mov_b32 s12, 0x358637bd
  s_mov_b32 s13, 0x3f803f80
  s_lshl_b32 s62, s2, 2
  s_add_u32 s62, s62, s52
  s_cmp_lg_u32 s62, 0
  s_cbranch_scc1 L_no_nonce
  s_memrealtime s[62:63]
  s_waitcnt lgkmcnt(0)
  s_or_b32 s62, s62, 1
  v_mov_b32 v100, s62
  s_mov_b64 exec, 1
  global_store_dword v104, v100, s[20:21] sc1
  s_mov_b64 exec, -1
L_no_nonce:
  s_barrier
  ds_read_b128 a[0:3], v105 offset:0
  ds_read_b64_tr_b16 v[68:69], v107 offset:16384
  ds_read_b128 a[4:7], v105 offset:2048
  ds_read_b64_tr_b16 v[70:71], v107 offset:16896
  ds_read_b64_tr_b16 v[72:73], v108 offset:16384
  ds_read_b64_tr_b16 v[74:75], v108 offset:16896
  ds_read_b64_tr_b16 v[76:77], v109 offset:16384
  ds_read_b64_tr_b16 v[78:79], v109 offset:16896
  ds_read_b64_tr_b16 v[80:81], v110 offset:16384
  ds_read_b64_tr_b16 v[82:83], v110 offset:16896
  ds_read_b64_tr_b16 v[84:85], v107 offset:18432
  ds_read_b64_tr_b16 v[86:87], v107 offset:18944
  s_waitcnt lgkmcnt(6)
  v_mfma_f32_16x16x32_bf16 v[4:7], v[68:71], a[0:3], 0
  ds_read_b64_tr_b16 v[88:89], v108 offset:18432
  v_mfma_f32_16x16x32_bf16 v[12:15], v[68:71], a[4:7], 0
  ds_read_b64_tr_b16 v[90:91], v108 offset:18944
  v_mfma_f32_16x16x32_bf16 v[8:11], v[72:75], a[0:3], 0
  ds_read_b64_tr_b16 v[92:93], v109 offset:18432
  v_mfma_f32_16x16x32_bf16 v[16:19], v[72:75], a[4:7], 0
  ds_read_b64_tr_b16 v[94:95], v109 offset:18944
  s_waitcnt lgkmcnt(6)
  v_mfma_f32_16x16x32_bf16 v[20:23], v[76:79], a[0:3], 0
  ds_read_b64_tr_b16 v[96:97], v110 offset:18432
  v_mfma_f32_16x16x32_bf16 v[28:31], v[76:79], a[4:7], 0
  ds_read_b64_tr_b16 v[98:99], v110 offset:18944
  v_mfma_f32_16x16x32_bf16 v[24:27], v[80:83], a[0:3], 0
  ds_read_b128 a[8:11], v106 offset:0
  ds_read_b64_tr_b16 v[68:69], v107 offset:24576
  v_mfma_f32_16x16x32_bf16 v[32:35], v[80:83], a[4:7], 0
  ds_read_b128 a[12:15], v106 offset:2048
  ds_read_b64_tr_b16 v[70:71], v107 offset:25088
  s_waitcnt lgkmcnt(8)
  v_mfma_f32_16x16x32_bf16 v[36:39], v[84:87], a[0:3], 0
  ds_read_b64_tr_b16 v[72:73], v108 offset:24576
  v_mfma_f32_16x16x32_bf16 v[44:47], v[84:87], a[4:7], 0
  ds_read_b64_tr_b16 v[74:75], v108 offset:25088
  v_mfma_f32_16x16x32_bf16 v[40:43], v[88:91], a[0:3], 0
  ds_read_b64_tr_b16 v[76:77], v109 offset:24576
  v_mfma_f32_16x16x32_bf16 v[48:51], v[88:91], a[4:7], 0
  ds_read_b64_tr_b16 v[78:79], v109 offset:25088
  s_waitcnt lgkmcnt(8)
  v_mfma_f32_16x16x32_bf16 v[52:55], v[92:95], a[0:3], 0
  ds_read_b64_tr_b16 v[80:81], v110 offset:24576
  v_mfma_f32_16x16x32_bf16 v[60:63], v[92:95], a[4:7], 0
  ds_read_b64_tr_b16 v[82:83], v110 offset:25088
  v_mfma_f32_16x16x32_bf16 v[56:59], v[96:99], a[0:3], 0
  ds_read_b64_tr_b16 v[84:85], v107 offset:26624
  v_mfma_f32_16x16x32_bf16 v[64:67], v[96:99], a[4:7], 0
  ds_read_b64_tr_b16 v[86:87], v107 offset:27136
  s_waitcnt lgkmcnt(6)
  v_mfma_f32_16x16x32_bf16 v[4:7], v[68:71], a[8:11], v[4:7]
  ds_read_b64_tr_b16 v[88:89], v108 offset:26624
  v_mfma_f32_16x16x32_bf16 v[12:15], v[68:71], a[12:15], v[12:15]
  ds_read_b64_tr_b16 v[90:91], v108 offset:27136
  v_mfma_f32_16x16x32_bf16 v[8:11], v[72:75], a[8:11], v[8:11]
  ds_read_b64_tr_b16 v[92:93], v109 offset:26624
  v_mfma_f32_16x16x32_bf16 v[16:19], v[72:75], a[12:15], v[16:19]
  ds_read_b64_tr_b16 v[94:95], v109 offset:27136
  s_waitcnt lgkmcnt(6)
  v_mfma_f32_16x16x32_bf16 v[20:23], v[76:79], a[8:11], v[20:23]
  ds_read_b64_tr_b16 v[96:97], v110 offset:26624
  v_mfma_f32_16x16x32_bf16 v[28:31], v[76:79], a[12:15], v[28:31]
  ds_read_b64_tr_b16 v[98:99], v110 offset:27136
  v_mfma_f32_16x16x32_bf16 v[24:27], v[80:83], a[8:11], v[24:27]
  s_barrier
  ds_read_b128 a[16:19], v105 offset:32768
  ds_read_b64_tr_b16 v[68:69], v107 offset:49152
  v_mfma_f32_16x16x32_bf16 v[32:35], v[80:83], a[12:15], v[32:35]
  ds_read_b128 a[20:23], v105 offset:34816
  ds_read_b64_tr_b16 v[70:71], v107 offset:49664
  s_waitcnt lgkmcnt(8)
  v_mfma_f32_16x16x32_bf16 v[36:39], v[84:87], a[8:11], v[36:39]
  ds_read_b64_tr_b16 v[72:73], v108 offset:49152
  v_mfma_f32_16x16x32_bf16 v[44:47], v[84:87], a[12:15], v[44:47]
  ds_read_b64_tr_b16 v[74:75], v108 offset:49664
  v_mfma_f32_16x16x32_bf16 v[40:43], v[88:91], a[8:11], v[40:43]
  ds_read_b64_tr_b16 v[76:77], v109 offset:49152
  v_mfma_f32_16x16x32_bf16 v[48:51], v[88:91], a[12:15], v[48:51]
  ds_read_b64_tr_b16 v[78:79], v109 offset:49664
  s_waitcnt lgkmcnt(8)
  v_mfma_f32_16x16x32_bf16 v[52:55], v[92:95], a[8:11], v[52:55]
  ds_read_b64_tr_b16 v[80:81], v110 offset:49152
  v_mfma_f32_16x16x32_bf16 v[60:63], v[92:95], a[12:15], v[60:63]
  ds_read_b64_tr_b16 v[82:83], v110 offset:49664
  v_mfma_f32_16x16x32_bf16 v[56:59], v[96:99], a[8:11], v[56:59]
  ds_read_b64_tr_b16 v[84:85], v107 offset:51200
  v_mfma_f32_16x16x32_bf16 v[64:67], v[96:99], a[12:15], v[64:67]
  ds_read_b64_tr_b16 v[86:87], v107 offset:51712
  s_waitcnt lgkmcnt(6)
  v_mfma_f32_16x16x32_bf16 v[4:7], v[68:71], a[16:19], v[4:7]
  ds_read_b64_tr_b16 v[88:89], v108 offset:51200
  v_mfma_f32_16x16x32_bf16 v[12:15], v[68:71], a[20:23], v[12:15]
  ds_read_b64_tr_b16 v[90:91], v108 offset:51712
  v_mfma_f32_16x16x32_bf16 v[8:11], v[72:75], a[16:19], v[8:11]
  ds_read_b64_tr_b16 v[92:93], v109 offset:51200
  v_mfma_f32_16x16x32_bf16 v[16:19], v[72:75], a[20:23], v[16:19]
  ds_read_b64_tr_b16 v[94:95], v109 offset:51712
  s_waitcnt lgkmcnt(6)
  v_mfma_f32_16x16x32_bf16 v[20:23], v[76:79], a[16:19], v[20:23]
  ds_read_b64_tr_b16 v[96:97], v110 offset:51200
  v_mfma_f32_16x16x32_bf16 v[28:31], v[76:79], a[20:23], v[28:31]
  ds_read_b64_tr_b16 v[98:99], v110 offset:51712
  v_mfma_f32_16x16x32_bf16 v[24:27], v[80:83], a[16:19], v[24:27]
  ds_read_b128 a[24:27], v106 offset:32768
  ds_read_b64_tr_b16 v[68:69], v107 offset:57344
  v_mfma_f32_16x16x32_bf16 v[32:35], v[80:83], a[20:23], v[32:35]
  ds_read_b128 a[28:31], v106 offset:34816
  ds_read_b64_tr_b16 v[70:71], v107 offset:57856
  s_waitcnt lgkmcnt(8)
  v_mfma_f32_16x16x32_bf16 v[36:39], v[84:87], a[16:19], v[36:39]
  ds_read_b64_tr_b16 v[72:73], v108 offset:57344
  v_mfma_f32_16x16x32_bf16 v[44:47], v[84:87], a[20:23], v[44:47]
  ds_read_b64_tr_b16 v[74:75], v108 offset:57856
  v_mfma_f32_16x16x32_bf16 v[40:43], v[88:91], a[16:19], v[40:43]
  ds_read_b64_tr_b16 v[76:77], v109 offset:57344
  v_mfma_f32_16x16x32_bf16 v[48:51], v[88:91], a[20:23], v[48:51]
  ds_read_b64_tr_b16 v[78:79], v109 offset:57856
  s_waitcnt lgkmcnt(8)
  v_mfma_f32_16x16x32_bf16 v[52:55], v[92:95], a[16:19], v[52:55]
  ds_read_b64_tr_b16 v[80:81], v110 offset:57344
  v_mfma_f32_16x16x32_bf16 v[60:63], v[92:95], a[20:23], v[60:63]
  ds_read_b64_tr_b16 v[82:83], v110 offset:57856
  v_mfma_f32_16x16x32_bf16 v[56:59], v[96:99], a[16:19], v[56:59]
  ds_read_b64_tr_b16 v[84:85], v107 offset:59392
  v_mfma_f32_16x16x32_bf16 v[64:67], v[96:99], a[20:23], v[64:67]
  ds_read_b64_tr_b16 v[86:87], v107 offset:59904
  s_waitcnt lgkmcnt(6)
  v_mfma_f32_16x16x32_bf16 v[4:7], v[68:71], a[24:27], v[4:7]
  ds_read_b64_tr_b16 v[88:89], v108 offset:59392
  v_mfma_f32_16x16x32_bf16 v[12:15], v[68:71], a[28:31], v[12:15]
  ds_read_b64_tr_b16 v[90:91], v108 offset:59904
  v_mfma_f32_16x16x32_bf16 v[8:11], v[72:75], a[24:27], v[8:11]
  ds_read_b64_tr_b16 v[92:93], v109 offset:59392
  v_mfma_f32_16x16x32_bf16 v[16:19], v[72:75], a[28:31], v[16:19]
  ds_read_b64_tr_b16 v[94:95], v109 offset:59904
  s_waitcnt lgkmcnt(6)
  v_mfma_f32_16x16x32_bf16 v[20:23], v[76:79], a[24:27], v[20:23]
  ds_read_b64_tr_b16 v[96:97], v110 offset:59392
  v_mfma_f32_16x16x32_bf16 v[28:31], v[76:79], a[28:31], v[28:31]
  ds_read_b64_tr_b16 v[98:99], v110 offset:59904
  v_mfma_f32_16x16x32_bf16 v[24:27], v[80:83], a[24:27], v[24:27]
  s_barrier
  v_add_u32 v105, 65536, v105
  ds_read_b128 a[32:35], v105 offset:0
  v_add_u32 v107, 65536, v107
  ds_read_b64_tr_b16 v[68:69], v107 offset:16384
  v_mfma_f32_16x16x32_bf16 v[32:35], v[80:83], a[28:31], v[32:35]
  ds_read_b128 a[36:39], v105 offset:2048
  ds_read_b64_tr_b16 v[70:71], v107 offset:16896
  s_waitcnt lgkmcnt(8)
  v_mfma_f32_16x16x32_bf16 v[36:39], v[84:87], a[24:27], v[36:39]
  v_add_u32 v108, 65536, v108
  ds_read_b64_tr_b16 v[72:73], v108 offset:16384
  v_mfma_f32_16x16x32_bf16 v[44:47], v[84:87], a[28:31], v[44:47]
  ds_read_b64_tr_b16 v[74:75], v108 offset:16896
  v_mfma_f32_16x16x32_bf16 v[40:43], v[88:91], a[24:27], v[40:43]
  v_add_u32 v109, 65536, v109
  ds_read_b64_tr_b16 v[76:77], v109 offset:16384
  v_mfma_f32_16x16x32_bf16 v[48:51], v[88:91], a[28:31], v[48:51]
  ds_read_b64_tr_b16 v[78:79], v109 offset:16896
  s_waitcnt lgkmcnt(8)
  v_mfma_f32_16x16x32_bf16 v[52:55], v[92:95], a[24:27], v[52:55]
  v_add_u32 v110, 65536, v110
  ds_read_b64_tr_b16 v[80:81], v110 offset:16384
  v_mfma_f32_16x16x32_bf16 v[60:63], v[92:95], a[28:31], v[60:63]
  ds_read_b64_tr_b16 v[82:83], v110 offset:16896
  v_mfma_f32_16x16x32_bf16 v[56:59], v[96:99], a[24:27], v[56:59]
  ds_read_b64_tr_b16 v[84:85], v107 offset:18432
  v_mfma_f32_16x16x32_bf16 v[64:67], v[96:99], a[28:31], v[64:67]
  ds_read_b64_tr_b16 v[86:87], v107 offset:18944
  s_waitcnt lgkmcnt(6)
  v_mfma_f32_16x16x32_bf16 v[4:7], v[68:71], a[32:35], v[4:7]
  ds_read_b64_tr_b16 v[88:89], v108 offset:18432
  v_mfma_f32_16x16x32_bf16 v[12:15], v[68:71], a[36:39], v[12:15]
  ds_read_b64_tr_b16 v[90:91], v108 offset:18944
  v_mfma_f32_16x16x32_bf16 v[8:11], v[72:75], a[32:35], v[8:11]
  ds_read_b64_tr_b16 v[92:93], v109 offset:18432
  v_mfma_f32_16x16x32_bf16 v[16:19], v[72:75], a[36:39], v[16:19]
  ds_read_b64_tr_b16 v[94:95], v109 offset:18944
  s_waitcnt lgkmcnt(6)
  v_mfma_f32_16x16x32_bf16 v[20:23], v[76:79], a[32:35], v[20:23]
  ds_read_b64_tr_b16 v[96:97], v110 offset:18432
  v_mfma_f32_16x16x32_bf16 v[28:31], v[76:79], a[36:39], v[28:31]
  ds_read_b64_tr_b16 v[98:99], v110 offset:18944
  v_mfma_f32_16x16x32_bf16 v[24:27], v[80:83], a[32:35], v[24:27]
  v_add_u32 v106, 65536, v106
  ds_read_b128 a[40:43], v106 offset:0
  ds_read_b64_tr_b16 v[68:69], v107 offset:24576
  v_mfma_f32_16x16x32_bf16 v[32:35], v[80:83], a[36:39], v[32:35]
  ds_read_b128 a[44:47], v106 offset:2048
  ds_read_b64_tr_b16 v[70:71], v107 offset:25088
  s_waitcnt lgkmcnt(8)
  v_mfma_f32_16x16x32_bf16 v[36:39], v[84:87], a[32:35], v[36:39]
  ds_read_b64_tr_b16 v[72:73], v108 offset:24576
  v_mfma_f32_16x16x32_bf16 v[44:47], v[84:87], a[36:39], v[44:47]
  ds_read_b64_tr_b16 v[74:75], v108 offset:25088
  v_mfma_f32_16x16x32_bf16 v[40:43], v[88:91], a[32:35], v[40:43]
  ds_read_b64_tr_b16 v[76:77], v109 offset:24576
  v_mfma_f32_16x16x32_bf16 v[48:51], v[88:91], a[36:39], v[48:51]
  ds_read_b64_tr_b16 v[78:79], v109 offset:25088
  s_waitcnt lgkmcnt(8)
  v_mfma_f32_16x16x32_bf16 v[52:55], v[92:95], a[32:35], v[52:55]
  ds_read_b64_tr_b16 v[80:81], v110 offset:24576
  v_mfma_f32_16x16x32_bf16 v[60:63], v[92:95], a[36:39], v[60:63]
  ds_read_b64_tr_b16 v[82:83], v110 offset:25088
  v_mfma_f32_16x16x32_bf16 v[56:59], v[96:99], a[32:35], v[56:59]
  ds_read_b64_tr_b16 v[84:85], v107 offset:26624
  v_mfma_f32_16x16x32_bf16 v[64:67], v[96:99], a[36:39], v[64:67]
  ds_read_b64_tr_b16 v[86:87], v107 offset:27136
  s_waitcnt lgkmcnt(6)
  v_mfma_f32_16x16x32_bf16 v[4:7], v[68:71], a[40:43], v[4:7]
  ds_read_b64_tr_b16 v[88:89], v108 offset:26624
  v_mfma_f32_16x16x32_bf16 v[12:15], v[68:71], a[44:47], v[12:15]
  ds_read_b64_tr_b16 v[90:91], v108 offset:27136
  v_mfma_f32_16x16x32_bf16 v[8:11], v[72:75], a[40:43], v[8:11]
  ds_read_b64_tr_b16 v[92:93], v109 offset:26624
  v_mfma_f32_16x16x32_bf16 v[16:19], v[72:75], a[44:47], v[16:19]
  ds_read_b64_tr_b16 v[94:95], v109 offset:27136
  s_waitcnt lgkmcnt(6)
  v_mfma_f32_16x16x32_bf16 v[20:23], v[76:79], a[40:43], v[20:23]
  ds_read_b64_tr_b16 v[96:97], v110 offset:26624
  v_mfma_f32_16x16x32_bf16 v[28:31], v[76:79], a[44:47], v[28:31]
  ds_read_b64_tr_b16 v[98:99], v110 offset:27136
  v_mfma_f32_16x16x32_bf16 v[24:27], v[80:83], a[40:43], v[24:27]
  s_barrier
  v_add_u32 v105, 4294901760, v105
  ds_read_b128 a[48:51], v105 offset:0
  ds_read_b64_tr_b16 v[68:69], v107 offset:32768
  v_mfma_f32_16x16x32_bf16 v[32:35], v[80:83], a[44:47], v[32:35]
  ds_read_b128 a[52:55], v105 offset:2048
  ds_read_b64_tr_b16 v[70:71], v107 offset:33280
  s_waitcnt lgkmcnt(8)
  v_mfma_f32_16x16x32_bf16 v[36:39], v[84:87], a[40:43], v[36:39]
  ds_read_b64_tr_b16 v[72:73], v108 offset:32768
  v_mfma_f32_16x16x32_bf16 v[44:47], v[84:87], a[44:47], v[44:47]
  ds_read_b64_tr_b16 v[74:75], v108 offset:33280
  v_mfma_f32_16x16x32_bf16 v[40:43], v[88:91], a[40:43], v[40:43]
  ds_read_b64_tr_b16 v[76:77], v109 offset:32768
  v_mfma_f32_16x16x32_bf16 v[48:51], v[88:91], a[44:47], v[48:51]
  ds_read_b64_tr_b16 v[78:79], v109 offset:33280
  s_waitcnt lgkmcnt(8)
  v_mfma_f32_16x16x32_bf16 v[52:55], v[92:95], a[40:43], v[52:55]
  ds_read_b64_tr_b16 v[80:81], v110 offset:32768
  v_mfma_f32_16x16x32_bf16 v[60:63], v[92:95], a[44:47], v[60:63]
  ds_read_b64_tr_b16 v[82:83], v110 offset:33280
  v_mfma_f32_16x16x32_bf16 v[56:59], v[96:99], a[40:43], v[56:59]
  ds_read_b64_tr_b16 v[84:85], v107 offset:34816
  v_mfma_f32_16x16x32_bf16 v[64:67], v[96:99], a[44:47], v[64:67]
  ds_read_b64_tr_b16 v[86:87], v107 offset:35328
  s_waitcnt lgkmcnt(6)
  v_mfma_f32_16x16x32_bf16 v[4:7], v[68:71], a[48:51], v[4:7]
  ds_read_b64_tr_b16 v[88:89], v108 offset:34816
  v_mfma_f32_16x16x32_bf16 v[12:15], v[68:71], a[52:55], v[12:15]
  ds_read_b64_tr_b16 v[90:91], v108 offset:35328
  v_mfma_f32_16x16x32_bf16 v[8:11], v[72:75], a[48:51], v[8:11]
  ds_read_b64_tr_b16 v[92:93], v109 offset:34816
  v_mfma_f32_16x16x32_bf16 v[16:19], v[72:75], a[52:55], v[16:19]
  ds_read_b64_tr_b16 v[94:95], v109 offset:35328
  s_waitcnt lgkmcnt(6)
  v_mfma_f32_16x16x32_bf16 v[20:23], v[76:79], a[48:51], v[20:23]
  ds_read_b64_tr_b16 v[96:97], v110 offset:34816
  v_mfma_f32_16x16x32_bf16 v[28:31], v[76:79], a[52:55], v[28:31]
  ds_read_b64_tr_b16 v[98:99], v110 offset:35328
  v_mfma_f32_16x16x32_bf16 v[24:27], v[80:83], a[48:51], v[24:27]
  v_add_u32 v106, 4294901760, v106
  ds_read_b128 a[56:59], v106 offset:0
  ds_read_b64_tr_b16 v[68:69], v107 offset:40960
  v_mfma_f32_16x16x32_bf16 v[32:35], v[80:83], a[52:55], v[32:35]
  ds_read_b128 a[60:63], v106 offset:2048
  ds_read_b64_tr_b16 v[70:71], v107 offset:41472
  s_waitcnt lgkmcnt(8)
  v_mfma_f32_16x16x32_bf16 v[36:39], v[84:87], a[48:51], v[36:39]
  ds_read_b64_tr_b16 v[72:73], v108 offset:40960
  v_mfma_f32_16x16x32_bf16 v[44:47], v[84:87], a[52:55], v[44:47]
  ds_read_b64_tr_b16 v[74:75], v108 offset:41472
  v_mfma_f32_16x16x32_bf16 v[40:43], v[88:91], a[48:51], v[40:43]
  ds_read_b64_tr_b16 v[76:77], v109 offset:40960
  v_mfma_f32_16x16x32_bf16 v[48:51], v[88:91], a[52:55], v[48:51]
  ds_read_b64_tr_b16 v[78:79], v109 offset:41472
  s_waitcnt lgkmcnt(8)
  v_mfma_f32_16x16x32_bf16 v[52:55], v[92:95], a[48:51], v[52:55]
  ds_read_b64_tr_b16 v[80:81], v110 offset:40960
  v_mfma_f32_16x16x32_bf16 v[60:63], v[92:95], a[52:55], v[60:63]
  ds_read_b64_tr_b16 v[82:83], v110 offset:41472
  v_mfma_f32_16x16x32_bf16 v[56:59], v[96:99], a[48:51], v[56:59]
  ds_read_b64_tr_b16 v[84:85], v107 offset:43008
  v_mfma_f32_16x16x32_bf16 v[64:67], v[96:99], a[52:55], v[64:67]
  ds_read_b64_tr_b16 v[86:87], v107 offset:43520
  s_waitcnt lgkmcnt(6)
  v_mfma_f32_16x16x32_bf16 v[4:7], v[68:71], a[56:59], v[4:7]
  ds_read_b64_tr_b16 v[88:89], v108 offset:43008
  v_mfma_f32_16x16x32_bf16 v[12:15], v[68:71], a[60:63], v[12:15]
  ds_read_b64_tr_b16 v[90:91], v108 offset:43520
  v_mfma_f32_16x16x32_bf16 v[8:11], v[72:75], a[56:59], v[8:11]
  ds_read_b64_tr_b16 v[92:93], v109 offset:43008
  v_mfma_f32_16x16x32_bf16 v[16:19], v[72:75], a[60:63], v[16:19]
  ds_read_b64_tr_b16 v[94:95], v109 offset:43520
  s_waitcnt lgkmcnt(6)
  v_mfma_f32_16x16x32_bf16 v[20:23], v[76:79], a[56:59], v[20:23]
  ds_read_b64_tr_b16 v[96:97], v110 offset:43008
  v_mfma_f32_16x16x32_bf16 v[28:31], v[76:79], a[60:63], v[28:31]
  ds_read_b64_tr_b16 v[98:99], v110 offset:43520
  v_mfma_f32_16x16x32_bf16 v[24:27], v[80:83], a[56:59], v[24:27]
  s_barrier
  global_load_dword v114, v104, s[20:21] sc1
  ds_read_b128 a[64:67], v105 offset:16384
  v_add_u32 v107, 4294901760, v107
  ds_read_b64_tr_b16 v[68:69], v107 offset:32768
  v_mfma_f32_16x16x32_bf16 v[32:35], v[80:83], a[60:63], v[32:35]
  ds_read_b128 a[68:71], v105 offset:18432
  ds_read_b64_tr_b16 v[70:71], v107 offset:33280
  s_waitcnt lgkmcnt(8)
  v_mfma_f32_16x16x32_bf16 v[36:39], v[84:87], a[56:59], v[36:39]
  v_add_u32 v108, 4294901760, v108
  ds_read_b64_tr_b16 v[72:73], v108 offset:32768
  v_mfma_f32_16x16x32_bf16 v[44:47], v[84:87], a[60:63], v[44:47]
  ds_read_b64_tr_b16 v[74:75], v108 offset:33280
  v_mfma_f32_16x16x32_bf16 v[40:43], v[88:91], a[56:59], v[40:43]
  v_add_u32 v109, 4294901760, v109
  ds_read_b64_tr_b16 v[76:77], v109 offset:32768
  v_mfma_f32_16x16x32_bf16 v[48:51], v[88:91], a[60:63], v[48:51]
  ds_read_b64_tr_b16 v[78:79], v109 offset:33280
  s_waitcnt lgkmcnt(8)
  v_mfma_f32_16x16x32_bf16 v[52:55], v[92:95], a[56:59], v[52:55]
  v_add_u32 v110, 4294901760, v110
  ds_read_b64_tr_b16 v[80:81], v110 offset:32768
  v_mfma_f32_16x16x32_bf16 v[60:63], v[92:95], a[60:63], v[60:63]
  ds_read_b64_tr_b16 v[82:83], v110 offset:33280
  v_mfma_f32_16x16x32_bf16 v[56:59], v[96:99], a[56:59], v[56:59]
  ds_read_b64_tr_b16 v[84:85], v107 offset:34816
  v_mfma_f32_16x16x32_bf16 v[64:67], v[96:99], a[60:63], v[64:67]
  ds_read_b64_tr_b16 v[86:87], v107 offset:35328
  s_waitcnt lgkmcnt(6)
  v_mfma_f32_16x16x32_bf16 v[4:7], v[68:71], a[64:67], v[4:7]
  ds_read_b64_tr_b16 v[88:89], v108 offset:34816
  v_mfma_f32_16x16x32_bf16 v[12:15], v[68:71], a[68:71], v[12:15]
  ds_read_b64_tr_b16 v[90:91], v108 offset:35328
  v_mfma_f32_16x16x32_bf16 v[8:11], v[72:75], a[64:67], v[8:11]
  ds_read_b64_tr_b16 v[92:93], v109 offset:34816
  v_mfma_f32_16x16x32_bf16 v[16:19], v[72:75], a[68:71], v[16:19]
  ds_read_b64_tr_b16 v[94:95], v109 offset:35328
  s_waitcnt lgkmcnt(6)
  v_mfma_f32_16x16x32_bf16 v[20:23], v[76:79], a[64:67], v[20:23]
  ds_read_b64_tr_b16 v[96:97], v110 offset:34816
  v_mfma_f32_16x16x32_bf16 v[28:31], v[76:79], a[68:71], v[28:31]
  ds_read_b64_tr_b16 v[98:99], v110 offset:35328
  v_mfma_f32_16x16x32_bf16 v[24:27], v[80:83], a[64:67], v[24:27]
  ds_read_b128 a[72:75], v106 offset:16384
  ds_read_b64_tr_b16 v[68:69], v107 offset:40960
  v_mfma_f32_16x16x32_bf16 v[32:35], v[80:83], a[68:71], v[32:35]
  ds_read_b128 a[76:79], v106 offset:18432
  ds_read_b64_tr_b16 v[70:71], v107 offset:41472
  s_waitcnt lgkmcnt(8)
  v_mfma_f32_16x16x32_bf16 v[36:39], v[84:87], a[64:67], v[36:39]
  ds_read_b64_tr_b16 v[72:73], v108 offset:40960
  v_mfma_f32_16x16x32_bf16 v[44:47], v[84:87], a[68:71], v[44:47]
  ds_read_b64_tr_b16 v[74:75], v108 offset:41472
  v_mfma_f32_16x16x32_bf16 v[40:43], v[88:91], a[64:67], v[40:43]
  ds_read_b64_tr_b16 v[76:77], v109 offset:40960
  v_mfma_f32_16x16x32_bf16 v[48:51], v[88:91], a[68:71], v[48:51]
  ds_read_b64_tr_b16 v[78:79], v109 offset:41472
  s_waitcnt lgkmcnt(8)
  v_mfma_f32_16x16x32_bf16 v[52:55], v[92:95], a[64:67], v[52:55]
  ds_read_b64_tr_b16 v[80:81], v110 offset:40960
  v_mfma_f32_16x16x32_bf16 v[60:63], v[92:95], a[68:71], v[60:63]
  ds_read_b64_tr_b16 v[82:83], v110 offset:41472
  v_mfma_f32_16x16x32_bf16 v[56:59], v[96:99], a[64:67], v[56:59]
  ds_read_b64_tr_b16 v[84:85], v107 offset:43008
  v_mfma_f32_16x16x32_bf16 v[64:67], v[96:99], a[68:71], v[64:67]
  ds_read_b64_tr_b16 v[86:87], v107 offset:43520
  s_waitcnt lgkmcnt(6)
  v_mfma_f32_16x16x32_bf16 v[4:7], v[68:71], a[72:75], v[4:7]
  ds_read_b64_tr_b16 v[88:89], v108 offset:43008
  v_mfma_f32_16x16x32_bf16 v[12:15], v[68:71], a[76:79], v[12:15]
  ds_read_b64_tr_b16 v[90:91], v108 offset:43520
  v_mfma_f32_16x16x32_bf16 v[8:11], v[72:75], a[72:75], v[8:11]
  ds_read_b64_tr_b16 v[92:93], v109 offset:43008
  v_mfma_f32_16x16x32_bf16 v[16:19], v[72:75], a[76:79], v[16:19]
  ds_read_b64_tr_b16 v[94:95], v109 offset:43520
  s_waitcnt lgkmcnt(6)
  v_mfma_f32_16x16x32_bf16 v[20:23], v[76:79], a[72:75], v[20:23]
  ds_read_b64_tr_b16 v[96:97], v110 offset:43008
  v_mfma_f32_16x16x32_bf16 v[28:31], v[76:79], a[76:79], v[28:31]
  ds_read_b64_tr_b16 v[98:99], v110 offset:43520
  v_mfma_f32_16x16x32_bf16 v[24:27], v[80:83], a[72:75], v[24:27]
  s_barrier
  ds_read_b128 a[80:83], v105 offset:49152
  v_add_u32 v107, 65536, v107
  ds_read_b64_tr_b16 v[68:69], v107 offset:0
  v_mfma_f32_16x16x32_bf16 v[32:35], v[80:83], a[76:79], v[32:35]
  ds_read_b128 a[84:87], v105 offset:51200
  ds_read_b64_tr_b16 v[70:71], v107 offset:512
  s_waitcnt lgkmcnt(8)
  v_mfma_f32_16x16x32_bf16 v[36:39], v[84:87], a[72:75], v[36:39]
  v_add_u32 v108, 65536, v108
  ds_read_b64_tr_b16 v[72:73], v108 offset:0
  v_mfma_f32_16x16x32_bf16 v[44:47], v[84:87], a[76:79], v[44:47]
  ds_read_b64_tr_b16 v[74:75], v108 offset:512
  v_mfma_f32_16x16x32_bf16 v[40:43], v[88:91], a[72:75], v[40:43]
  v_add_u32 v109, 65536, v109
  ds_read_b64_tr_b16 v[76:77], v109 offset:0
  v_mfma_f32_16x16x32_bf16 v[48:51], v[88:91], a[76:79], v[48:51]
  ds_read_b64_tr_b16 v[78:79], v109 offset:512
  s_waitcnt lgkmcnt(8)
  v_mfma_f32_16x16x32_bf16 v[52:55], v[92:95], a[72:75], v[52:55]
  v_add_u32 v110, 65536, v110
  ds_read_b64_tr_b16 v[80:81], v110 offset:0
  v_mfma_f32_16x16x32_bf16 v[60:63], v[92:95], a[76:79], v[60:63]
  ds_read_b64_tr_b16 v[82:83], v110 offset:512
  v_mfma_f32_16x16x32_bf16 v[56:59], v[96:99], a[72:75], v[56:59]
  ds_read_b64_tr_b16 v[84:85], v107 offset:2048
  v_mfma_f32_16x16x32_bf16 v[64:67], v[96:99], a[76:79], v[64:67]
  ds_read_b64_tr_b16 v[86:87], v107 offset:2560
  s_waitcnt lgkmcnt(6)
  v_mfma_f32_16x16x32_bf16 v[4:7], v[68:71], a[80:83], v[4:7]
  ds_read_b64_tr_b16 v[88:89], v108 offset:2048
  v_mfma_f32_16x16x32_bf16 v[12:15], v[68:71], a[84:87], v[12:15]
  ds_read_b64_tr_b16 v[90:91], v108 offset:2560
  v_mfma_f32_16x16x32_bf16 v[8:11], v[72:75], a[80:83], v[8:11]
  ds_read_b64_tr_b16 v[92:93], v109 offset:2048
  v_mfma_f32_16x16x32_bf16 v[16:19], v[72:75], a[84:87], v[16:19]
  ds_read_b64_tr_b16 v[94:95], v109 offset:2560
  s_waitcnt lgkmcnt(6)
  v_mfma_f32_16x16x32_bf16 v[20:23], v[76:79], a[80:83], v[20:23]
  ds_read_b64_tr_b16 v[96:97], v110 offset:2048
  v_mfma_f32_16x16x32_bf16 v[28:31], v[76:79], a[84:87], v[28:31]
  ds_read_b64_tr_b16 v[98:99], v110 offset:2560
  v_mfma_f32_16x16x32_bf16 v[24:27], v[80:83], a[80:83], v[24:27]
  ds_read_b128 a[88:91], v106 offset:49152
  ds_read_b64_tr_b16 v[68:69], v107 offset:8192
  v_mfma_f32_16x16x32_bf16 v[32:35], v[80:83], a[84:87], v[32:35]
  ds_read_b128 a[92:95], v106 offset:51200
  ds_read_b64_tr_b16 v[70:71], v107 offset:8704
  s_waitcnt lgkmcnt(8)
  v_mfma_f32_16x16x32_bf16 v[36:39], v[84:87], a[80:83], v[36:39]
  ds_read_b64_tr_b16 v[72:73], v108 offset:8192
  v_mfma_f32_16x16x32_bf16 v[44:47], v[84:87], a[84:87], v[44:47]
  ds_read_b64_tr_b16 v[74:75], v108 offset:8704
  v_mfma_f32_16x16x32_bf16 v[40:43], v[88:91], a[80:83], v[40:43]
  ds_read_b64_tr_b16 v[76:77], v109 offset:8192
  v_mfma_f32_16x16x32_bf16 v[48:51], v[88:91], a[84:87], v[48:51]
  ds_read_b64_tr_b16 v[78:79], v109 offset:8704
  s_waitcnt lgkmcnt(8)
  v_mfma_f32_16x16x32_bf16 v[52:55], v[92:95], a[80:83], v[52:55]
  ds_read_b64_tr_b16 v[80:81], v110 offset:8192
  v_mfma_f32_16x16x32_bf16 v[60:63], v[92:95], a[84:87], v[60:63]
  ds_read_b64_tr_b16 v[82:83], v110 offset:8704
  v_mfma_f32_16x16x32_bf16 v[56:59], v[96:99], a[80:83], v[56:59]
  ds_read_b64_tr_b16 v[84:85], v107 offset:10240
  v_mfma_f32_16x16x32_bf16 v[64:67], v[96:99], a[84:87], v[64:67]
  ds_read_b64_tr_b16 v[86:87], v107 offset:10752
  s_waitcnt lgkmcnt(6)
  v_mfma_f32_16x16x32_bf16 v[4:7], v[68:71], a[88:91], v[4:7]
  ds_read_b64_tr_b16 v[88:89], v108 offset:10240
  v_mfma_f32_16x16x32_bf16 v[12:15], v[68:71], a[92:95], v[12:15]
  ds_read_b64_tr_b16 v[90:91], v108 offset:10752
  v_mfma_f32_16x16x32_bf16 v[8:11], v[72:75], a[88:91], v[8:11]
  ds_read_b64_tr_b16 v[92:93], v109 offset:10240
  v_mfma_f32_16x16x32_bf16 v[16:19], v[72:75], a[92:95], v[16:19]
  ds_read_b64_tr_b16 v[94:95], v109 offset:10752
  s_waitcnt lgkmcnt(6)
  v_mfma_f32_16x16x32_bf16 v[20:23], v[76:79], a[88:91], v[20:23]
  ds_read_b64_tr_b16 v[96:97], v110 offset:10240
  v_mfma_f32_16x16x32_bf16 v[28:31], v[76:79], a[92:95], v[28:31]
  ds_read_b64_tr_b16 v[98:99], v110 offset:10752
  v_mfma_f32_16x16x32_bf16 v[24:27], v[80:83], a[88:91], v[24:27]
  s_barrier
  ds_read_b128 a[96:99], v105 offset:0
  ds_read_b64_tr_b16 v[68:69], v107 offset:16384
  v_mfma_f32_16x16x32_bf16 v[32:35], v[80:83], a[92:95], v[32:35]
  ds_read_b128 a[100:103], v105 offset:2048
  ds_read_b64_tr_b16 v[70:71], v107 offset:16896
  s_waitcnt lgkmcnt(8)
  v_mfma_f32_16x16x32_bf16 v[36:39], v[84:87], a[88:91], v[36:39]
  ds_read_b64_tr_b16 v[72:73], v108 offset:16384
  v_mfma_f32_16x16x32_bf16 v[44:47], v[84:87], a[92:95], v[44:47]
  ds_read_b64_tr_b16 v[74:75], v108 offset:16896
  v_mfma_f32_16x16x32_bf16 v[40:43], v[88:91], a[88:91], v[40:43]
  ds_read_b128 a[104:107], v106 offset:0
  ds_read_b64_tr_b16 v[76:77], v107 offset:24576
  v_mfma_f32_16x16x32_bf16 v[48:51], v[88:91], a[92:95], v[48:51]
  ds_read_b128 a[108:111], v106 offset:2048
  ds_read_b64_tr_b16 v[78:79], v107 offset:25088
  s_waitcnt lgkmcnt(10)
  v_mfma_f32_16x16x32_bf16 v[52:55], v[92:95], a[88:91], v[52:55]
  ds_read_b64_tr_b16 v[80:81], v108 offset:24576
  v_mfma_f32_16x16x32_bf16 v[60:63], v[92:95], a[92:95], v[60:63]
  ds_read_b64_tr_b16 v[82:83], v108 offset:25088
  v_mfma_f32_16x16x32_bf16 v[56:59], v[96:99], a[88:91], v[56:59]
  s_barrier
  ds_read_b128 a[112:115], v105 offset:16384
  ds_read_b64_tr_b16 v[84:85], v107 offset:32768
  v_mfma_f32_16x16x32_bf16 v[64:67], v[96:99], a[92:95], v[64:67]
  ds_read_b128 a[116:119], v105 offset:18432
  ds_read_b64_tr_b16 v[86:87], v107 offset:33280
  s_waitcnt lgkmcnt(10)
  v_mfma_f32_16x16x32_bf16 v[4:7], v[68:71], a[96:99], v[4:7]
  ds_read_b64_tr_b16 v[88:89], v108 offset:32768
  v_mfma_f32_16x16x32_bf16 v[12:15], v[68:71], a[100:103], v[12:15]
  ds_read_b64_tr_b16 v[90:91], v108 offset:33280
  v_mfma_f32_16x16x32_bf16 v[8:11], v[72:75], a[96:99], v[8:11]
  ds_read_b128 a[120:123], v106 offset:16384
  ds_read_b64_tr_b16 v[92:93], v107 offset:40960
  v_mfma_f32_16x16x32_bf16 v[16:19], v[72:75], a[100:103], v[16:19]
  ds_read_b128 a[124:127], v106 offset:18432
  ds_read_b64_tr_b16 v[94:95], v107 offset:41472
  s_waitcnt lgkmcnt(10)
  v_mfma_f32_16x16x32_bf16 v[4:7], v[76:79], a[104:107], v[4:7]
  ds_read_b64_tr_b16 v[96:97], v108 offset:40960
  v_mfma_f32_16x16x32_bf16 v[12:15], v[76:79], a[108:111], v[12:15]
  ds_read_b64_tr_b16 v[98:99], v108 offset:41472
  v_mfma_f32_16x16x32_bf16 v[8:11], v[80:83], a[104:107], v[8:11]
  ds_read_b64_tr_b16 v[68:69], v109 offset:16384
  v_mfma_f32_16x16x32_bf16 v[16:19], v[80:83], a[108:111], v[16:19]
  ds_read_b64_tr_b16 v[70:71], v109 offset:16896
  s_waitcnt lgkmcnt(8)
  v_mfma_f32_16x16x32_bf16 v[4:7], v[84:87], a[112:115], v[4:7]
  ds_read_b64_tr_b16 v[72:73], v110 offset:16384
  v_mfma_f32_16x16x32_bf16 v[12:15], v[84:87], a[116:119], v[12:15]
  ds_read_b64_tr_b16 v[74:75], v110 offset:16896
  v_mfma_f32_16x16x32_bf16 v[8:11], v[88:91], a[112:115], v[8:11]
  ds_read_b64_tr_b16 v[76:77], v109 offset:24576
  v_mfma_f32_16x16x32_bf16 v[16:19], v[88:91], a[116:119], v[16:19]
  ds_read_b64_tr_b16 v[78:79], v109 offset:25088
  s_waitcnt lgkmcnt(6)
  v_mfma_f32_16x16x32_bf16 v[4:7], v[92:95], a[120:123], v[4:7]
  ds_read_b64_tr_b16 v[80:81], v110 offset:24576
  v_mfma_f32_16x16x32_bf16 v[12:15], v[92:95], a[124:127], v[12:15]
  ds_read_b64_tr_b16 v[82:83], v110 offset:25088
  v_mfma_f32_16x16x32_bf16 v[8:11], v[96:99], a[120:123], v[8:11]
  ds_read_b64_tr_b16 v[84:85], v109 offset:32768
  v_mfma_f32_16x16x32_bf16 v[16:19], v[96:99], a[124:127], v[16:19]
  ds_read_b64_tr_b16 v[86:87], v109 offset:33280
  s_waitcnt lgkmcnt(6)
  v_mfma_f32_16x16x32_bf16 v[20:23], v[68:71], a[96:99], v[20:23]
  ds_read_b64_tr_b16 v[88:89], v110 offset:32768
  v_mfma_f32_16x16x32_bf16 v[28:31], v[68:71], a[100:103], v[28:31]
  ds_read_b64_tr_b16 v[90:91], v110 offset:33280
  v_mfma_f32_16x16x32_bf16 v[24:27], v[72:75], a[96:99], v[24:27]
  ds_read_b64_tr_b16 v[92:93], v109 offset:40960
  v_mfma_f32_16x16x32_bf16 v[32:35], v[72:75], a[100:103], v[32:35]
  ds_read_b64_tr_b16 v[94:95], v109 offset:41472
  v_cvt_pk_bf16_f32 v4, v4, v5
  v_cvt_pk_bf16_f32 v5, v6, v7
  v_cvt_pk_bf16_f32 v6, v8, v9
  v_cvt_pk_bf16_f32 v7, v10, v11
  s_waitcnt lgkmcnt(6)
  v_mfma_f32_16x16x32_bf16 v[20:23], v[76:79], a[104:107], v[20:23]
  ds_read_b64_tr_b16 v[96:97], v110 offset:40960
  v_mfma_f32_16x16x32_bf16 v[28:31], v[76:79], a[108:111], v[28:31]
  ds_read_b64_tr_b16 v[98:99], v110 offset:41472
  v_cvt_pk_bf16_f32 v8, v12, v13
  v_cvt_pk_bf16_f32 v9, v14, v15
  v_cvt_pk_bf16_f32 v10, v16, v17
  v_cvt_pk_bf16_f32 v11, v18, v19
  v_mfma_f32_16x16x32_bf16 v[24:27], v[80:83], a[104:107], v[24:27]
  ds_read_b64_tr_b16 v[68:69], v107 offset:18432
  v_mfma_f32_16x16x32_bf16 v[32:35], v[80:83], a[108:111], v[32:35]
  ds_read_b64_tr_b16 v[70:71], v107 offset:18944
  v_pk_max_i16 v4, v4, 0
  v_pk_max_i16 v5, v5, 0
  v_pk_max_i16 v6, v6, 0
  v_pk_max_i16 v7, v7, 0
  s_waitcnt lgkmcnt(6)
  v_mfma_f32_16x16x32_bf16 v[20:23], v[84:87], a[112:115], v[20:23]
  ds_read_b64_tr_b16 v[72:73], v108 offset:18432
  v_mfma_f32_16x16x32_bf16 v[28:31], v[84:87], a[116:119], v[28:31]
  ds_read_b64_tr_b16 v[74:75], v108 offset:18944
  v_pk_max_i16 v8, v8, 0
  v_pk_max_i16 v9, v9, 0
  v_pk_max_i16 v10, v10, 0
  v_pk_max_i16 v11, v11, 0
  v_mfma_f32_16x16x32_bf16 v[24:27], v[88:91], a[112:115], v[24:27]
  ds_read_b64_tr_b16 v[76:77], v107 offset:26624
  v_mfma_f32_16x16x32_bf16 v[32:35], v[88:91], a[116:119], v[32:35]
  ds_read_b64_tr_b16 v[78:79], v107 offset:27136
  s_lshl_b32 s8, s54, 14
  s_add_u32 s8, s8, s66
  buffer_store_dwordx4 v[4:7], v103, s[44:47], s8 offen offset:0 sc1
  s_waitcnt lgkmcnt(6)
  v_mfma_f32_16x16x32_bf16 v[20:23], v[92:95], a[120:123], v[20:23]
  ds_read_b64_tr_b16 v[80:81], v108 offset:26624
  v_mfma_f32_16x16x32_bf16 v[28:31], v[92:95], a[124:127], v[28:31]
  ds_read_b64_tr_b16 v[82:83], v108 offset:27136
  buffer_store_dwordx4 v[8:11], v103, s[44:47], s8 offen offset:1024 sc1
  v_mfma_f32_16x16x32_bf16 v[24:27], v[96:99], a[120:123], v[24:27]
  ds_read_b64_tr_b16 v[84:85], v107 offset:34816
  v_mfma_f32_16x16x32_bf16 v[32:35], v[96:99], a[124:127], v[32:35]
  ds_read_b64_tr_b16 v[86:87], v107 offset:35328
  s_waitcnt lgkmcnt(6)
  v_mfma_f32_16x16x32_bf16 v[36:39], v[68:71], a[96:99], v[36:39]
  ds_read_b64_tr_b16 v[88:89], v108 offset:34816
  v_mfma_f32_16x16x32_bf16 v[44:47], v[68:71], a[100:103], v[44:47]
  ds_read_b64_tr_b16 v[90:91], v108 offset:35328
  v_mfma_f32_16x16x32_bf16 v[40:43], v[72:75], a[96:99], v[40:43]
  ds_read_b64_tr_b16 v[92:93], v107 offset:43008
  v_mfma_f32_16x16x32_bf16 v[48:51], v[72:75], a[100:103], v[48:51]
  ds_read_b64_tr_b16 v[94:95], v107 offset:43520
  v_cvt_pk_bf16_f32 v20, v20, v21
  v_cvt_pk_bf16_f32 v21, v22, v23
  v_cvt_pk_bf16_f32 v22, v24, v25
  v_cvt_pk_bf16_f32 v23, v26, v27
  s_waitcnt lgkmcnt(6)
  v_mfma_f32_16x16x32_bf16 v[36:39], v[76:79], a[104:107], v[36:39]
  ds_read_b64_tr_b16 v[96:97], v108 offset:43008
  v_mfma_f32_16x16x32_bf16 v[44:47], v[76:79], a[108:111], v[44:47]
  ds_read_b64_tr_b16 v[98:99], v108 offset:43520
  v_cvt_pk_bf16_f32 v24, v28, v29
  v_cvt_pk_bf16_f32 v25, v30, v31
  v_cvt_pk_bf16_f32 v26, v32, v33
  v_cvt_pk_bf16_f32 v27, v34, v35
  v_mfma_f32_16x16x32_bf16 v[40:43], v[80:83], a[104:107], v[40:43]
  ds_read_b64_tr_b16 v[68:69], v109 offset:18432
  v_mfma_f32_16x16x32_bf16 v[48:51], v[80:83], a[108:111], v[48:51]
  ds_read_b64_tr_b16 v[70:71], v109 offset:18944
  v_pk_max_i16 v20, v20, 0
  v_pk_max_i16 v21, v21, 0
  v_pk_max_i16 v22, v22, 0
  v_pk_max_i16 v23, v23, 0
  s_waitcnt lgkmcnt(6)
  v_mfma_f32_16x16x32_bf16 v[36:39], v[84:87], a[112:115], v[36:39]
  ds_read_b64_tr_b16 v[72:73], v110 offset:18432
  v_mfma_f32_16x16x32_bf16 v[44:47], v[84:87], a[116:119], v[44:47]
  ds_read_b64_tr_b16 v[74:75], v110 offset:18944
  v_pk_max_i16 v24, v24, 0
  v_pk_max_i16 v25, v25, 0
  v_pk_max_i16 v26, v26, 0
  v_pk_max_i16 v27, v27, 0
  v_mfma_f32_16x16x32_bf16 v[40:43], v[88:91], a[112:115], v[40:43]
  ds_read_b64_tr_b16 v[76:77], v109 offset:26624
  v_mfma_f32_16x16x32_bf16 v[48:51], v[88:91], a[116:119], v[48:51]
  ds_read_b64_tr_b16 v[78:79], v109 offset:27136
  s_add_u32 s8, s8, 4096
  buffer_store_dwordx4 v[20:23], v103, s[44:47], s8 offen offset:0 sc1
  s_waitcnt lgkmcnt(6)
  v_mfma_f32_16x16x32_bf16 v[36:39], v[92:95], a[120:123], v[36:39]
  ds_read_b64_tr_b16 v[80:81], v110 offset:26624
  v_mfma_f32_16x16x32_bf16 v[44:47], v[92:95], a[124:127], v[44:47]
  ds_read_b64_tr_b16 v[82:83], v110 offset:27136
  buffer_store_dwordx4 v[24:27], v103, s[44:47], s8 offen offset:1024 sc1
  v_mfma_f32_16x16x32_bf16 v[40:43], v[96:99], a[120:123], v[40:43]
  ds_read_b64_tr_b16 v[84:85], v109 offset:34816
  v_mfma_f32_16x16x32_bf16 v[48:51], v[96:99], a[124:127], v[48:51]
  ds_read_b64_tr_b16 v[86:87], v109 offset:35328
  s_waitcnt lgkmcnt(6)
  v_mfma_f32_16x16x32_bf16 v[52:55], v[68:71], a[96:99], v[52:55]
  ds_read_b64_tr_b16 v[88:89], v110 offset:34816
  v_mfma_f32_16x16x32_bf16 v[60:63], v[68:71], a[100:103], v[60:63]
  ds_read_b64_tr_b16 v[90:91], v110 offset:35328
  v_mfma_f32_16x16x32_bf16 v[56:59], v[72:75], a[96:99], v[56:59]
  ds_read_b64_tr_b16 v[92:93], v109 offset:43008
  v_mfma_f32_16x16x32_bf16 v[64:67], v[72:75], a[100:103], v[64:67]
  ds_read_b64_tr_b16 v[94:95], v109 offset:43520
  v_cvt_pk_bf16_f32 v36, v36, v37
  v_cvt_pk_bf16_f32 v37, v38, v39
  v_cvt_pk_bf16_f32 v38, v40, v41
  v_cvt_pk_bf16_f32 v39, v42, v43
  s_waitcnt lgkmcnt(6)
  v_mfma_f32_16x16x32_bf16 v[52:55], v[76:79], a[104:107], v[52:55]
  ds_read_b64_tr_b16 v[96:97], v110 offset:43008
  v_mfma_f32_16x16x32_bf16 v[60:63], v[76:79], a[108:111], v[60:63]
  ds_read_b64_tr_b16 v[98:99], v110 offset:43520
  v_cvt_pk_bf16_f32 v40, v44, v45
  v_cvt_pk_bf16_f32 v41, v46, v47
  v_cvt_pk_bf16_f32 v42, v48, v49
  v_cvt_pk_bf16_f32 v43, v50, v51
  v_mfma_f32_16x16x32_bf16 v[56:59], v[80:83], a[104:107], v[56:59]
  v_mfma_f32_16x16x32_bf16 v[64:67], v[80:83], a[108:111], v[64:67]
  v_pk_max_i16 v36, v36, 0
  v_pk_max_i16 v37, v37, 0
  v_pk_max_i16 v38, v38, 0
  v_pk_max_i16 v39, v39, 0
  s_waitcnt lgkmcnt(4)
  v_mfma_f32_16x16x32_bf16 v[52:55], v[84:87], a[112:115], v[52:55]
  v_mfma_f32_16x16x32_bf16 v[60:63], v[84:87], a[116:119], v[60:63]
  v_pk_max_i16 v40, v40, 0
  v_pk_max_i16 v41, v41, 0
  v_pk_max_i16 v42, v42, 0
  v_pk_max_i16 v43, v43, 0
  v_mfma_f32_16x16x32_bf16 v[56:59], v[88:91], a[112:115], v[56:59]
  v_mfma_f32_16x16x32_bf16 v[64:67], v[88:91], a[116:119], v[64:67]
  s_add_u32 s8, s8, 4096
  buffer_store_dwordx4 v[36:39], v103, s[44:47], s8 offen offset:0 sc1
  s_waitcnt lgkmcnt(0)
  v_mfma_f32_16x16x32_bf16 v[52:55], v[92:95], a[120:123], v[52:55]
  v_mfma_f32_16x16x32_bf16 v[60:63], v[92:95], a[124:127], v[60:63]
  buffer_store_dwordx4 v[40:43], v103, s[44:47], s8 offen offset:1024 sc1
  v_mfma_f32_16x16x32_bf16 v[56:59], v[96:99], a[120:123], v[56:59]
  v_mfma_f32_16x16x32_bf16 v[64:67], v[96:99], a[124:127], v[64:67]
  s_waitcnt vmcnt(6)
  v_cmp_eq_u32 vcc, 0, v114
  s_cbranch_vccnz L_slow_QC_nonce
L_back_QC_nonce:
  s_nop 0
  v_cvt_pk_bf16_f32 v52, v52, v53
  v_cvt_pk_bf16_f32 v53, v54, v55
  s_nop 0
  v_cvt_pk_bf16_f32 v54, v56, v57
  v_cvt_pk_bf16_f32 v55, v58, v59
  v_cvt_pk_bf16_f32 v56, v60, v61
  v_cvt_pk_bf16_f32 v57, v62, v63
  v_cvt_pk_bf16_f32 v58, v64, v65
  v_cvt_pk_bf16_f32 v59, v66, v67
  v_pk_max_i16 v52, v52, 0
  v_pk_max_i16 v53, v53, 0
  v_pk_max_i16 v54, v54, 0
  v_pk_max_i16 v55, v55, 0
  v_pk_max_i16 v56, v56, 0
  v_pk_max_i16 v57, v57, 0
  v_pk_max_i16 v58, v58, 0
  v_pk_max_i16 v59, v59, 0
  s_add_u32 s8, s8, 4096
  buffer_store_dwordx4 v[52:55], v103, s[44:47], s8 offen offset:0 sc1
  buffer_store_dwordx4 v[56:59], v103, s[44:47], s8 offen offset:1024 sc1
  v_lshrrev_b32 v100, 5, v1
  v_mul_u32_u24 v101, 2048, v100
  v_sub_u32 v107, v107, v101
  v_sub_u32 v108, v108, v101
  v_sub_u32 v109, v109, v101
  v_sub_u32 v110, v110, v101
  s_barrier
  v_add_u32 v107, 4294901760, v107
  ds_read_b64_tr_b16 v[68:69], v107 offset:32768
  ds_read_b64_tr_b16 v[70:71], v107 offset:33280
  v_add_u32 v108, 4294901760, v108
  ds_read_b64_tr_b16 v[72:73], v108 offset:32768
  ds_read_b64_tr_b16 v[74:75], v108 offset:33280
  v_add_u32 v109, 4294901760, v109
  ds_read_b64_tr_b16 v[76:77], v109 offset:32768
  ds_read_b64_tr_b16 v[78:79], v109 offset:33280
  v_add_u32 v110, 4294901760, v110
  ds_read_b64_tr_b16 v[80:81], v110 offset:32768
  ds_read_b64_tr_b16 v[82:83], v110 offset:33280
  ds_read_b64_tr_b16 v[84:85], v107 offset:36864
  ds_read_b64_tr_b16 v[86:87], v107 offset:37376
  s_waitcnt lgkmcnt(6)
  v_mfma_f32_16x16x32_bf16 v[4:7], v[68:71], a[0:3], 0
  ds_read_b64_tr_b16 v[88:89], v108 offset:36864
  v_mfma_f32_16x16x32_bf16 v[12:15], v[68:71], a[4:7], 0
  ds_read_b64_tr_b16 v[90:91], v108 offset:37376
  v_mfma_f32_16x16x32_bf16 v[8:11], v[72:75], a[0:3], 0
  ds_read_b64_tr_b16 v[92:93], v109 offset:36864
  v_mfma_f32_16x16x32_bf16 v[16:19], v[72:75], a[4:7], 0
  ds_read_b64_tr_b16 v[94:95], v109 offset:37376
  s_waitcnt lgkmcnt(6)
  v_mfma_f32_16x16x32_bf16 v[20:23], v[76:79], a[0:3], 0
  ds_read_b64_tr_b16 v[96:97], v110 offset:36864
  v_mfma_f32_16x16x32_bf16 v[28:31], v[76:79], a[4:7], 0
  ds_read_b64_tr_b16 v[98:99], v110 offset:37376
  v_mfma_f32_16x16x32_bf16 v[24:27], v[80:83], a[0:3], 0
  ds_read_b64_tr_b16 v[68:69], v107 offset:40960
  v_mfma_f32_16x16x32_bf16 v[32:35], v[80:83], a[4:7], 0
  ds_read_b64_tr_b16 v[70:71], v107 offset:41472
  s_waitcnt lgkmcnt(6)
  v_mfma_f32_16x16x32_bf16 v[4:7], v[84:87], a[8:11], v[4:7]
  ds_read_b64_tr_b16 v[72:73], v108 offset:40960
  v_mfma_f32_16x16x32_bf16 v[12:15], v[84:87], a[12:15], v[12:15]
  ds_read_b64_tr_b16 v[74:75], v108 offset:41472
  v_mfma_f32_16x16x32_bf16 v[8:11], v[88:91], a[8:11], v[8:11]
  ds_read_b64_tr_b16 v[76:77], v109 offset:40960
  v_mfma_f32_16x16x32_bf16 v[16:19], v[88:91], a[12:15], v[16:19]
  ds_read_b64_tr_b16 v[78:79], v109 offset:41472
  s_waitcnt lgkmcnt(6)
  v_mfma_f32_16x16x32_bf16 v[20:23], v[92:95], a[8:11], v[20:23]
  ds_read_b64_tr_b16 v[80:81], v110 offset:40960
  v_mfma_f32_16x16x32_bf16 v[28:31], v[92:95], a[12:15], v[28:31]
  ds_read_b64_tr_b16 v[82:83], v110 offset:41472
  v_mfma_f32_16x16x32_bf16 v[24:27], v[96:99], a[8:11], v[24:27]
  ds_read_b64_tr_b16 v[84:85], v107 offset:45056
  v_mfma_f32_16x16x32_bf16 v[32:35], v[96:99], a[12:15], v[32:35]
  ds_read_b64_tr_b16 v[86:87], v107 offset:45568
  s_waitcnt lgkmcnt(6)
  v_mfma_f32_16x16x32_bf16 v[4:7], v[68:71], a[16:19], v[4:7]
  ds_read_b64_tr_b16 v[88:89], v108 offset:45056
  v_mfma_f32_16x16x32_bf16 v[12:15], v[68:71], a[20:23], v[12:15]
  ds_read_b64_tr_b16 v[90:91], v108 offset:45568
  v_mfma_f32_16x16x32_bf16 v[8:11], v[72:75], a[16:19], v[8:11]
  ds_read_b64_tr_b16 v[92:93], v109 offset:45056
  v_mfma_f32_16x16x32_bf16 v[16:19], v[72:75], a[20:23], v[16:19]
  ds_read_b64_tr_b16 v[94:95], v109 offset:45568
  s_waitcnt lgkmcnt(6)
  v_mfma_f32_16x16x32_bf16 v[20:23], v[76:79], a[16:19], v[20:23]
  ds_read_b64_tr_b16 v[96:97], v110 offset:45056
  v_mfma_f32_16x16x32_bf16 v[28:31], v[76:79], a[20:23], v[28:31]
  ds_read_b64_tr_b16 v[98:99], v110 offset:45568
  s_waitcnt vmcnt(0)
  s_lshl_b32 s65, s53, 3
  s_add_u32 s65, s65, s54
  s_lshl_b32 s65, s65, 5
  s_add_u32 s65, s65, s52
  s_lshl_b32 s65, s65, 2
  s_add_u32 s65, s65, 10010624
  s_mov_b64 exec, 1
  buffer_store_dword v114, off, s[44:47], s65 sc1
  s_mov_b64 exec, -1
  v_mfma_f32_16x16x32_bf16 v[24:27], v[80:83], a[16:19], v[24:27]
  s_barrier
  ds_read_b64_tr_b16 v[68:69], v107 offset:49152
  v_mfma_f32_16x16x32_bf16 v[32:35], v[80:83], a[20:23], v[32:35]
  ds_read_b64_tr_b16 v[70:71], v107 offset:49664
  s_waitcnt lgkmcnt(6)
  v_mfma_f32_16x16x32_bf16 v[4:7], v[84:87], a[24:27], v[4:7]
  ds_read_b64_tr_b16 v[72:73], v108 offset:49152
  v_mfma_f32_16x16x32_bf16 v[12:15], v[84:87], a[28:31], v[12:15]
  ds_read_b64_tr_b16 v[74:75], v108 offset:49664
  v_mfma_f32_16x16x32_bf16 v[8:11], v[88:91], a[24:27], v[8:11]
  ds_read_b64_tr_b16 v[76:77], v109 offset:49152
  v_mfma_f32_16x16x32_bf16 v[16:19], v[88:91], a[28:31], v[16:19]
  ds_read_b64_tr_b16 v[78:79], v109 offset:49664
  s_waitcnt lgkmcnt(6)
  v_mfma_f32_16x16x32_bf16 v[20:23], v[92:95], a[24:27], v[20:23]
  ds_read_b64_tr_b16 v[80:81], v110 offset:49152
  v_mfma_f32_16x16x32_bf16 v[28:31], v[92:95], a[28:31], v[28:31]
  ds_read_b64_tr_b16 v[82:83], v110 offset:49664
  v_mfma_f32_16x16x32_bf16 v[24:27], v[96:99], a[24:27], v[24:27]
  ds_read_b64_tr_b16 v[84:85], v107 offset:53248
  v_mfma_f32_16x16x32_bf16 v[32:35], v[96:99], a[28:31], v[32:35]
  ds_read_b64_tr_b16 v[86:87], v107 offset:53760
  s_waitcnt lgkmcnt(6)
  v_mfma_f32_16x16x32_bf16 v[4:7], v[68:71], a[32:35], v[4:7]
  ds_read_b64_tr_b16 v[88:89], v108 offset:53248
  v_mfma_f32_16x16x32_bf16 v[12:15], v[68:71], a[36:39], v[12:15]
  ds_read_b64_tr_b16 v[90:91], v108 offset:53760
  v_mfma_f32_16x16x32_bf16 v[8:11], v[72:75], a[32:35], v[8:11]
  ds_read_b64_tr_b16 v[92:93], v109 offset:53248
  v_mfma_f32_16x16x32_bf16 v[16:19], v[72:75], a[36:39], v[16:19]
  ds_read_b64_tr_b16 v[94:95], v109 offset:53760
  s_waitcnt lgkmcnt(6)
  v_mfma_f32_16x16x32_bf16 v[20:23], v[76:79], a[32:35], v[20:23]
  ds_read_b64_tr_b16 v[96:97], v110 offset:53248
  v_mfma_f32_16x16x32_bf16 v[28:31], v[76:79], a[36:39], v[28:31]
  ds_read_b64_tr_b16 v[98:99], v110 offset:53760
  v_mfma_f32_16x16x32_bf16 v[24:27], v[80:83], a[32:35], v[24:27]
  ds_read_b64_tr_b16 v[68:69], v107 offset:57344
  v_mfma_f32_16x16x32_bf16 v[32:35], v[80:83], a[36:39], v[32:35]
  ds_read_b64_tr_b16 v[70:71], v107 offset:57856
  s_waitcnt lgkmcnt(6)
  v_mfma_f32_16x16x32_bf16 v[4:7], v[84:87], a[40:43], v[4:7]
  ds_read_b64_tr_b16 v[72:73], v108 offset:57344
  v_mfma_f32_16x16x32_bf16 v[12:15], v[84:87], a[44:47], v[12:15]
  ds_read_b64_tr_b16 v[74:75], v108 offset:57856
  v_mfma_f32_16x16x32_bf16 v[8:11], v[88:91], a[40:43], v[8:11]
  ds_read_b64_tr_b16 v[76:77], v109 offset:57344
  v_mfma_f32_16x16x32_bf16 v[16:19], v[88:91], a[44:47], v[16:19]
  ds_read_b64_tr_b16 v[78:79], v109 offset:57856
  s_waitcnt lgkmcnt(6)
  v_mfma_f32_16x16x32_bf16 v[20:23], v[92:95], a[40:43], v[20:23]
  ds_read_b64_tr_b16 v[80:81], v110 offset:57344
  v_mfma_f32_16x16x32_bf16 v[28:31], v[92:95], a[44:47], v[28:31]
  ds_read_b64_tr_b16 v[82:83], v110 offset:57856
  v_mfma_f32_16x16x32_bf16 v[24:27], v[96:99], a[40:43], v[24:27]
  ds_read_b64_tr_b16 v[84:85], v107 offset:61440
  v_mfma_f32_16x16x32_bf16 v[32:35], v[96:99], a[44:47], v[32:35]
  ds_read_b64_tr_b16 v[86:87], v107 offset:61952
  s_waitcnt lgkmcnt(6)
  v_mfma_f32_16x16x32_bf16 v[4:7], v[68:71], a[48:51], v[4:7]
  ds_read_b64_tr_b16 v[88:89], v108 offset:61440
  v_mfma_f32_16x16x32_bf16 v[12:15], v[68:71], a[52:55], v[12:15]
  ds_read_b64_tr_b16 v[90:91], v108 offset:61952
  v_mfma_f32_16x16x32_bf16 v[8:11], v[72:75], a[48:51], v[8:11]
  ds_read_b64_tr_b16 v[92:93], v109 offset:61440
  v_mfma_f32_16x16x32_bf16 v[16:19], v[72:75], a[52:55], v[16:19]
  ds_read_b64_tr_b16 v[94:95], v109 offset:61952
  s_waitcnt lgkmcnt(6)
  v_mfma_f32_16x16x32_bf16 v[20:23], v[76:79], a[48:51], v[20:23]
  ds_read_b64_tr_b16 v[96:97], v110 offset:61440
  v_mfma_f32_16x16x32_bf16 v[28:31], v[76:79], a[52:55], v[28:31]
  ds_read_b64_tr_b16 v[98:99], v110 offset:61952
  v_mfma_f32_16x16x32_bf16 v[24:27], v[80:83], a[48:51], v[24:27]
  s_barrier
  v_add_u32 v107, 65536, v107
  ds_read_b64_tr_b16 v[68:69], v107 offset:0
  v_mfma_f32_16x16x32_bf16 v[32:35], v[80:83], a[52:55], v[32:35]
  ds_read_b64_tr_b16 v[70:71], v107 offset:512
  s_waitcnt lgkmcnt(6)
  v_mfma_f32_16x16x32_bf16 v[4:7], v[84:87], a[56:59], v[4:7]
  v_add_u32 v108, 65536, v108
  ds_read_b64_tr_b16 v[72:73], v108 offset:0
  v_mfma_f32_16x16x32_bf16 v[12:15], v[84:87], a[60:63], v[12:15]
  ds_read_b64_tr_b16 v[74:75], v108 offset:512
  v_mfma_f32_16x16x32_bf16 v[8:11], v[88:91], a[56:59], v[8:11]
  v_add_u32 v109, 65536, v109
  ds_read_b64_tr_b16 v[76:77], v109 offset:0
  v_mfma_f32_16x16x32_bf16 v[16:19], v[88:91], a[60:63], v[16:19]
  ds_read_b64_tr_b16 v[78:79], v109 offset:512
  s_waitcnt lgkmcnt(6)
  v_mfma_f32_16x16x32_bf16 v[20:23], v[92:95], a[56:59], v[20:23]
  v_add_u32 v110, 65536, v110
  ds_read_b64_tr_b16 v[80:81], v110 offset:0
  v_mfma_f32_16x16x32_bf16 v[28:31], v[92:95], a[60:63], v[28:31]
  ds_read_b64_tr_b16 v[82:83], v110 offset:512
  v_mfma_f32_16x16x32_bf16 v[24:27], v[96:99], a[56:59], v[24:27]
  ds_read_b64_tr_b16 v[84:85], v107 offset:4096
  v_mfma_f32_16x16x32_bf16 v[32:35], v[96:99], a[60:63], v[32:35]
  ds_read_b64_tr_b16 v[86:87], v107 offset:4608
  s_waitcnt lgkmcnt(6)
  v_mfma_f32_16x16x32_bf16 v[4:7], v[68:71], a[64:67], v[4:7]
  ds_read_b64_tr_b16 v[88:89], v108 offset:4096
  v_mfma_f32_16x16x32_bf16 v[12:15], v[68:71], a[68:71], v[12:15]
  ds_read_b64_tr_b16 v[90:91], v108 offset:4608
  v_mfma_f32_16x16x32_bf16 v[8:11], v[72:75], a[64:67], v[8:11]
  ds_read_b64_tr_b16 v[92:93], v109 offset:4096
  v_mfma_f32_16x16x32_bf16 v[16:19], v[72:75], a[68:71], v[16:19]
  ds_read_b64_tr_b16 v[94:95], v109 offset:4608
  s_waitcnt lgkmcnt(6)
  v_mfma_f32_16x16x32_bf16 v[20:23], v[76:79], a[64:67], v[20:23]
  ds_read_b64_tr_b16 v[96:97], v110 offset:4096
  v_mfma_f32_16x16x32_bf16 v[28:31], v[76:79], a[68:71], v[28:31]
  ds_read_b64_tr_b16 v[98:99], v110 offset:4608
  v_mfma_f32_16x16x32_bf16 v[24:27], v[80:83], a[64:67], v[24:27]
  ds_read_b64_tr_b16 v[68:69], v107 offset:8192
  v_mfma_f32_16x16x32_bf16 v[32:35], v[80:83], a[68:71], v[32:35]
  ds_read_b64_tr_b16 v[70:71], v107 offset:8704
  s_waitcnt lgkmcnt(6)
  v_mfma_f32_16x16x32_bf16 v[4:7], v[84:87], a[72:75], v[4:7]
  ds_read_b64_tr_b16 v[72:73], v108 offset:8192
  v_mfma_f32_16x16x32_bf16 v[12:15], v[84:87], a[76:79], v[12:15]
  ds_read_b64_tr_b16 v[74:75], v108 offset:8704
  v_mfma_f32_16x16x32_bf16 v[8:11], v[88:91], a[72:75], v[8:11]
  ds_read_b64_tr_b16 v[76:77], v109 offset:8192
  v_mfma_f32_16x16x32_bf16 v[16:19], v[88:91], a[76:79], v[16:19]
  ds_read_b64_tr_b16 v[78:79], v109 offset:8704
  s_waitcnt lgkmcnt(6)
  v_mfma_f32_16x16x32_bf16 v[20:23], v[92:95], a[72:75], v[20:23]
  ds_read_b64_tr_b16 v[80:81], v110 offset:8192
  v_mfma_f32_16x16x32_bf16 v[28:31], v[92:95], a[76:79], v[28:31]
  ds_read_b64_tr_b16 v[82:83], v110 offset:8704
  v_mfma_f32_16x16x32_bf16 v[24:27], v[96:99], a[72:75], v[24:27]
  ds_read_b64_tr_b16 v[84:85], v107 offset:12288
  v_mfma_f32_16x16x32_bf16 v[32:35], v[96:99], a[76:79], v[32:35]
  ds_read_b64_tr_b16 v[86:87], v107 offset:12800
  s_waitcnt lgkmcnt(6)
  v_mfma_f32_16x16x32_bf16 v[4:7], v[68:71], a[80:83], v[4:7]
  ds_read_b64_tr_b16 v[88:89], v108 offset:12288
  v_mfma_f32_16x16x32_bf16 v[12:15], v[68:71], a[84:87], v[12:15]
  ds_read_b64_tr_b16 v[90:91], v108 offset:12800
  v_mfma_f32_16x16x32_bf16 v[8:11], v[72:75], a[80:83], v[8:11]
  ds_read_b64_tr_b16 v[92:93], v109 offset:12288
  v_mfma_f32_16x16x32_bf16 v[16:19], v[72:75], a[84:87], v[16:19]
  ds_read_b64_tr_b16 v[94:95], v109 offset:12800
  s_waitcnt lgkmcnt(6)
  v_mfma_f32_16x16x32_bf16 v[20:23], v[76:79], a[80:83], v[20:23]
  ds_read_b64_tr_b16 v[96:97], v110 offset:12288
  v_mfma_f32_16x16x32_bf16 v[28:31], v[76:79], a[84:87], v[28:31]
  ds_read_b64_tr_b16 v[98:99], v110 offset:12800
  v_mfma_f32_16x16x32_bf16 v[24:27], v[80:83], a[80:83], v[24:27]
  s_barrier
  ds_read_b64_tr_b16 v[68:69], v107 offset:49152
  v_mfma_f32_16x16x32_bf16 v[32:35], v[80:83], a[84:87], v[32:35]
  ds_read_b64_tr_b16 v[70:71], v107 offset:49664
  s_waitcnt lgkmcnt(6)
  v_mfma_f32_16x16x32_bf16 v[4:7], v[84:87], a[88:91], v[4:7]
  ds_read_b64_tr_b16 v[72:73], v108 offset:49152
  v_mfma_f32_16x16x32_bf16 v[12:15], v[84:87], a[92:95], v[12:15]
  ds_read_b64_tr_b16 v[74:75], v108 offset:49664
  v_mfma_f32_16x16x32_bf16 v[8:11], v[88:91], a[88:91], v[8:11]
  ds_read_b64_tr_b16 v[76:77], v109 offset:49152
  v_mfma_f32_16x16x32_bf16 v[16:19], v[88:91], a[92:95], v[16:19]
  ds_read_b64_tr_b16 v[78:79], v109 offset:49664
  s_waitcnt lgkmcnt(6)
  v_mfma_f32_16x16x32_bf16 v[20:23], v[92:95], a[88:91], v[20:23]
  ds_read_b64_tr_b16 v[80:81], v110 offset:49152
  v_mfma_f32_16x16x32_bf16 v[28:31], v[92:95], a[92:95], v[28:31]
  ds_read_b64_tr_b16 v[82:83], v110 offset:49664
  v_mfma_f32_16x16x32_bf16 v[24:27], v[96:99], a[88:91], v[24:27]
  ds_read_b64_tr_b16 v[84:85], v107 offset:53248
  v_mfma_f32_16x16x32_bf16 v[32:35], v[96:99], a[92:95], v[32:35]
  ds_read_b64_tr_b16 v[86:87], v107 offset:53760
  s_waitcnt lgkmcnt(6)
  v_mfma_f32_16x16x32_bf16 v[4:7], v[68:71], a[96:99], v[4:7]
  ds_read_b64_tr_b16 v[88:89], v108 offset:53248
  v_mfma_f32_16x16x32_bf16 v[12:15], v[68:71], a[100:103], v[12:15]
  ds_read_b64_tr_b16 v[90:91], v108 offset:53760
  v_mfma_f32_16x16x32_bf16 v[8:11], v[72:75], a[96:99], v[8:11]
  ds_read_b64_tr_b16 v[92:93], v109 offset:53248
  v_mfma_f32_16x16x32_bf16 v[16:19], v[72:75], a[100:103], v[16:19]
  ds_read_b64_tr_b16 v[94:95], v109 offset:53760
  s_waitcnt lgkmcnt(6)
  v_mfma_f32_16x16x32_bf16 v[20:23], v[76:79], a[96:99], v[20:23]
  ds_read_b64_tr_b16 v[96:97], v110 offset:53248
  v_mfma_f32_16x16x32_bf16 v[28:31], v[76:79], a[100:103], v[28:31]
  ds_read_b64_tr_b16 v[98:99], v110 offset:53760
  v_mfma_f32_16x16x32_bf16 v[24:27], v[80:83], a[96:99], v[24:27]
  ds_read_b64_tr_b16 v[68:69], v107 offset:57344
  v_mfma_f32_16x16x32_bf16 v[32:35], v[80:83], a[100:103], v[32:35]
  ds_read_b64_tr_b16 v[70:71], v107 offset:57856
  s_waitcnt lgkmcnt(6)
  v_mfma_f32_16x16x32_bf16 v[4:7], v[84:87], a[104:107], v[4:7]
  ds_read_b64_tr_b16 v[72:73], v108 offset:57344
  v_mfma_f32_16x16x32_bf16 v[12:15], v[84:87], a[108:111], v[12:15]
  ds_read_b64_tr_b16 v[74:75], v108 offset:57856
  v_mfma_f32_16x16x32_bf16 v[8:11], v[88:91], a[104:107], v[8:11]
  ds_read_b64_tr_b16 v[76:77], v107 offset:61440
  v_mfma_f32_16x16x32_bf16 v[16:19], v[88:91], a[108:111], v[16:19]
  ds_read_b64_tr_b16 v[78:79], v107 offset:61952
  s_waitcnt lgkmcnt(6)
  v_mfma_f32_16x16x32_bf16 v[20:23], v[92:95], a[104:107], v[20:23]
  ds_read_b64_tr_b16 v[80:81], v108 offset:61440
  v_mfma_f32_16x16x32_bf16 v[28:31], v[92:95], a[108:111], v[28:31]
  ds_read_b64_tr_b16 v[82:83], v108 offset:61952
  v_mfma_f32_16x16x32_bf16 v[24:27], v[96:99], a[104:107], v[24:27]
  ds_read_b64_tr_b16 v[84:85], v109 offset:57344
  v_mfma_f32_16x16x32_bf16 v[32:35], v[96:99], a[108:111], v[32:35]
  ds_read_b64_tr_b16 v[86:87], v109 offset:57856
  s_waitcnt lgkmcnt(6)
  v_mfma_f32_16x16x32_bf16 v[4:7], v[68:71], a[112:115], v[4:7]
  ds_read_b64_tr_b16 v[88:89], v110 offset:57344
  v_mfma_f32_16x16x32_bf16 v[12:15], v[68:71], a[116:119], v[12:15]
  ds_read_b64_tr_b16 v[90:91], v110 offset:57856
  v_bfe_u32 v100, v1, 1, 3
  v_lshlrev_b32 v100, 7, v100
  v_and_b32 v101, 1, v1
  v_lshl_add_u32 v100, v101, 2, v100
  s_lshr_b32 s62, s56, 1
  s_lshl_b32 s62, s62, 10
  s_and_b32 s63, s56, 1
  s_lshl_b32 s63, s63, 3
  s_add_u32 s62, s62, s63
  s_add_u32 s62, s62, 10010624
  v_add_u32 v102, s62, v100
  v_add_u32 v115, 16384, v102
  v_add_u32 v116, 49152, v102
  s_lshl_b32 s62, s54, 11
  s_add_u32 s62, s62, 10076160
  v_and_b32 v100, 15, v1
  v_lshlrev_b32 v100, 7, v100
  v_lshrrev_b32 v101, 4, v1
  v_lshl_add_u32 v100, v101, 2, v100
  v_add_u32 v117, s62, v100
  s_cmp_lg_u32 s52, 0
  s_cbranch_scc1 L_ni_QC_kv
  buffer_load_dword v118, v117, s[44:47], 0 offen sc1
L_ni_QC_kv:
  v_mfma_f32_16x16x32_bf16 v[8:11], v[72:75], a[112:115], v[8:11]
  ds_read_b64_tr_b16 v[92:93], v109 offset:61440
  v_mfma_f32_16x16x32_bf16 v[16:19], v[72:75], a[116:119], v[16:19]
  ds_read_b64_tr_b16 v[94:95], v109 offset:61952
  s_waitcnt lgkmcnt(6)
  v_mfma_f32_16x16x32_bf16 v[4:7], v[76:79], a[120:123], v[4:7]
  ds_read_b64_tr_b16 v[96:97], v110 offset:61440
  v_mfma_f32_16x16x32_bf16 v[12:15], v[76:79], a[124:127], v[12:15]
  ds_read_b64_tr_b16 v[98:99], v110 offset:61952
  v_mfma_f32_16x16x32_bf16 v[8:11], v[80:83], a[120:123], v[8:11]
  v_mfma_f32_16x16x32_bf16 v[16:19], v[80:83], a[124:127], v[16:19]
  s_waitcnt lgkmcnt(4)
  v_mfma_f32_16x16x32_bf16 v[20:23], v[84:87], a[112:115], v[20:23]
  v_mfma_f32_16x16x32_bf16 v[28:31], v[84:87], a[116:119], v[28:31]
  v_cvt_pk_bf16_f32 v120, v4, v5
  v_cvt_pk_bf16_f32 v122, v6, v7
  s_nop 1
  v_cvt_pk_bf16_f32 v124, v8, v9
  v_cvt_pk_bf16_f32 v126, v10, v11
  v_mfma_f32_16x16x32_bf16 v[24:27], v[88:91], a[112:115], v[24:27]
  v_mfma_f32_16x16x32_bf16 v[32:35], v[88:91], a[116:119], v[32:35]
  v_lshlrev_b32 v4, 16, v120
  v_and_b32 v5, 0xffff0000, v120
  v_lshlrev_b32 v6, 16, v122
  v_and_b32 v7, 0xffff0000, v122
  s_waitcnt lgkmcnt(0)
  v_mfma_f32_16x16x32_bf16 v[20:23], v[92:95], a[120:123], v[20:23]
  v_mfma_f32_16x16x32_bf16 v[28:31], v[92:95], a[124:127], v[28:31]
  v_lshlrev_b32 v8, 16, v124
  v_and_b32 v9, 0xffff0000, v124
  v_lshlrev_b32 v10, 16, v126
  v_and_b32 v11, 0xffff0000, v126
  v_mfma_f32_16x16x32_bf16 v[24:27], v[96:99], a[120:123], v[24:27]
  v_mfma_f32_16x16x32_bf16 v[32:35], v[96:99], a[124:127], v[32:35]
  v_pk_mul_f32 v[120:121], v[4:5], s[10:11]
  v_pk_mul_f32 v[122:123], v[6:7], s[10:11]
  v_pk_mul_f32 v[124:125], v[8:9], s[10:11]
  v_pk_mul_f32 v[126:127], v[10:11], s[10:11]
  v_exp_f32_e64 v120, v120 clamp
  v_max_f32 v4, s12, v4
  v_exp_f32_e64 v121, v121 clamp
  v_max_f32 v5, s12, v5
  v_exp_f32_e64 v122, v122 clamp
  v_max_f32 v6, s12, v6
  v_exp_f32_e64 v123, v123 clamp
  v_max_f32 v7, s12, v7
  v_exp_f32_e64 v124, v124 clamp
  v_max_f32 v8, s12, v8
  v_exp_f32_e64 v125, v125 clamp
  v_max_f32 v9, s12, v9
  v_exp_f32_e64 v126, v126 clamp
  v_max_f32 v10, s12, v10
  v_exp_f32_e64 v127, v127 clamp
  v_max_f32 v11, s12, v11
  v_add_f32 v4, v4, v120
  v_add_f32 v5, v5, v121
  v_add_f32 v6, v6, v122
  v_add_f32 v7, v7, v123
  v_add_f32 v8, v8, v124
  v_add_f32 v9, v9, v125
  v_add_f32 v10, v10, v126
  v_add_f32 v11, v11, v127
  v_cvt_pk_bf16_f32 v4, v4, v5
  v_cvt_pk_bf16_f32 v5, v6, v7
  v_cvt_pk_bf16_f32 v6, v8, v9
  v_cvt_pk_bf16_f32 v7, v10, v11
  v_cvt_pk_bf16_f32 v120, v12, v13
  v_cvt_pk_bf16_f32 v122, v14, v15
  v_cvt_pk_bf16_f32 v124, v16, v17
  v_cvt_pk_bf16_f32 v126, v18, v19
  v_lshlrev_b32 v12, 16, v120
  v_and_b32 v13, 0xffff0000, v120
  v_lshlrev_b32 v14, 16, v122
  v_and_b32 v15, 0xffff0000, v122
  v_lshlrev_b32 v16, 16, v124
  v_and_b32 v17, 0xffff0000, v124
  v_lshlrev_b32 v18, 16, v126
  v_and_b32 v19, 0xffff0000, v126
  v_pk_mul_f32 v[120:121], v[12:13], s[10:11]
  v_pk_mul_f32 v[122:123], v[14:15], s[10:11]
  v_pk_mul_f32 v[124:125], v[16:17], s[10:11]
  v_pk_mul_f32 v[126:127], v[18:19], s[10:11]
  v_exp_f32_e64 v120, v120 clamp
  v_max_f32 v12, s12, v12
  v_exp_f32_e64 v121, v121 clamp
  v_max_f32 v13, s12, v13
  v_exp_f32_e64 v122, v122 clamp
  v_max_f32 v14, s12, v14
  v_exp_f32_e64 v123, v123 clamp
  v_max_f32 v15, s12, v15
  v_exp_f32_e64 v124, v124 clamp
  v_max_f32 v16, s12, v16
  v_exp_f32_e64 v125, v125 clamp
  v_max_f32 v17, s12, v17
  v_exp_f32_e64 v126, v126 clamp
  v_max_f32 v18, s12, v18
  v_exp_f32_e64 v127, v127 clamp
  v_max_f32 v19, s12, v19
  v_add_f32 v12, v12, v120
  v_add_f32 v13, v13, v121
  v_add_f32 v14, v14, v122
  v_add_f32 v15, v15, v123
  v_add_f32 v16, v16, v124
  v_add_f32 v17, v17, v125
  v_add_f32 v18, v18, v126
  v_add_f32 v19, v19, v127
  v_cvt_pk_bf16_f32 v8, v12, v13
  v_cvt_pk_bf16_f32 v9, v14, v15
  v_cvt_pk_bf16_f32 v10, v16, v17
  v_cvt_pk_bf16_f32 v11, v18, v19
  v_cvt_pk_bf16_f32 v120, v20, v21
  v_cvt_pk_bf16_f32 v122, v22, v23
  v_cvt_pk_bf16_f32 v124, v24, v25
  v_cvt_pk_bf16_f32 v126, v26, v27
  v_lshlrev_b32 v20, 16, v120
  v_and_b32 v21, 0xffff0000, v120
  v_lshlrev_b32 v22, 16, v122
  v_and_b32 v23, 0xffff0000, v122
  v_lshlrev_b32 v24, 16, v124
  v_and_b32 v25, 0xffff0000, v124
  v_lshlrev_b32 v26, 16, v126
  v_and_b32 v27, 0xffff0000, v126
  v_pk_mul_f32 v[120:121], v[20:21], s[10:11]
  v_pk_mul_f32 v[122:123], v[22:23], s[10:11]
  v_pk_mul_f32 v[124:125], v[24:25], s[10:11]
  v_pk_mul_f32 v[126:127], v[26:27], s[10:11]
  v_exp_f32_e64 v120, v120 clamp
  v_max_f32 v20, s12, v20
  v_exp_f32_e64 v121, v121 clamp
  v_max_f32 v21, s12, v21
  v_exp_f32_e64 v122, v122 clamp
  v_max_f32 v22, s12, v22
  v_exp_f32_e64 v123, v123 clamp
  v_max_f32 v23, s12, v23
  v_exp_f32_e64 v124, v124 clamp
  v_max_f32 v24, s12, v24
  v_exp_f32_e64 v125, v125 clamp
  v_max_f32 v25, s12, v25
  v_exp_f32_e64 v126, v126 clamp
  v_max_f32 v26, s12, v26
  v_exp_f32_e64 v127, v127 clamp
  v_max_f32 v27, s12, v27
  v_add_f32 v20, v20, v120
  v_add_f32 v21, v21, v121
  v_add_f32 v22, v22, v122
  v_add_f32 v23, v23, v123
  v_add_f32 v24, v24, v124
  v_add_f32 v25, v25, v125
  v_add_f32 v26, v26, v126
  v_add_f32 v27, v27, v127
  v_cvt_pk_bf16_f32 v12, v20, v21
  v_cvt_pk_bf16_f32 v13, v22, v23
  v_cvt_pk_bf16_f32 v14, v24, v25
  v_cvt_pk_bf16_f32 v15, v26, v27
  v_cvt_pk_bf16_f32 v120, v28, v29
  v_cvt_pk_bf16_f32 v122, v30, v31
  v_cvt_pk_bf16_f32 v124, v32, v33
  v_cvt_pk_bf16_f32 v126, v34, v35
  v_lshlrev_b32 v28, 16, v120
  v_and_b32 v29, 0xffff0000, v120
  v_lshlrev_b32 v30, 16, v122
  v_and_b32 v31, 0xffff0000, v122
  v_lshlrev_b32 v32, 16, v124
  v_and_b32 v33, 0xffff0000, v124
  v_lshlrev_b32 v34, 16, v126
  v_and_b32 v35, 0xffff0000, v126
  v_pk_mul_f32 v[120:121], v[28:29], s[10:11]
  v_pk_mul_f32 v[122:123], v[30:31], s[10:11]
  v_pk_mul_f32 v[124:125], v[32:33], s[10:11]
  v_pk_mul_f32 v[126:127], v[34:35], s[10:11]
  v_exp_f32_e64 v120, v120 clamp
  v_max_f32 v28, s12, v28
  v_exp_f32_e64 v121, v121 clamp
  v_max_f32 v29, s12, v29
  v_exp_f32_e64 v122, v122 clamp
  v_max_f32 v30, s12, v30
  v_exp_f32_e64 v123, v123 clamp
  v_max_f32 v31, s12, v31
  v_exp_f32_e64 v124, v124 clamp
  v_max_f32 v32, s12, v32
  v_exp_f32_e64 v125, v125 clamp
  v_max_f32 v33, s12, v33
  v_exp_f32_e64 v126, v126 clamp
  v_max_f32 v34, s12, v34
  v_exp_f32_e64 v127, v127 clamp
  v_max_f32 v35, s12, v35
  v_add_f32 v28, v28, v120
  v_add_f32 v29, v29, v121
  v_add_f32 v30, v30, v122
  v_add_f32 v31, v31, v123
  v_add_f32 v32, v32, v124
  v_add_f32 v33, v33, v125
  v_add_f32 v34, v34, v126
  v_add_f32 v35, v35, v127
  v_cvt_pk_bf16_f32 v16, v28, v29
  v_cvt_pk_bf16_f32 v17, v30, v31
  v_cvt_pk_bf16_f32 v18, v32, v33
  v_cvt_pk_bf16_f32 v19, v34, v35
  s_cmp_lg_u32 s52, 0
  s_cbranch_scc1 L_nc_QC_kv
  s_waitcnt vmcnt(0)
  v_cmp_ne_u32 vcc, v118, v114
  s_cbranch_vccnz L_slow_QC_kv
L_back_QC_kv:
L_nc_QC_kv:
  s_barrier
  ds_read_b128 a[0:3], v113 offset:57344
  ds_read_b64_tr_b16 a[8:9], v111 offset:0
  ds_read_b64_tr_b16 a[10:11], v111 offset:2048
  ds_read_b128 a[4:7], v113 offset:58368
  ds_read_b64_tr_b16 a[12:13], v112 offset:0
  ds_read_b64_tr_b16 a[14:15], v112 offset:2048
  ds_read_b128 a[16:19], v113 offset:61440
  ds_read_b64_tr_b16 a[24:25], v111 offset:4096
  ds_read_b64_tr_b16 a[26:27], v111 offset:6144
  ds_read_b128 a[20:23], v113 offset:62464
  s_waitcnt lgkmcnt(6)
  v_mfma_f32_16x16x32_bf16 v[52:55], a[8:11], a[0:3], 0
  ds_read_b64_tr_b16 a[28:29], v112 offset:4096
  s_lshl_b32 s5, s54, 13
  s_add_u32 s5, s5, s66
  s_add_u32 s5, s5, 229376
  v_lshlrev_b32 v107, 3, v1
  v_add_u32 v107, 159744, v107
  v_lshrrev_b32 v108, 4, v1
  v_lshlrev_b32 v108, 3, v108
  v_add_u32 v108, 160256, v108
  v_mfma_f32_16x16x32_bf16 v[60:63], a[8:11], a[4:7], 0
  ds_read_b64_tr_b16 a[30:31], v112 offset:6144
  s_waitcnt lgkmcnt(6)
  v_mfma_f32_16x16x32_bf16 v[56:59], a[12:15], a[0:3], 0
  s_barrier
  v_add_u32 v113, 65536, v113
  ds_read_b128 a[32:35], v113 offset:0
  ds_read_b64_tr_b16 a[40:41], v111 offset:8192
  v_mfma_f32_16x16x32_bf16 v[64:67], a[12:15], a[4:7], 0
  ds_read_b64_tr_b16 a[42:43], v111 offset:10240
  ds_read_b128 a[36:39], v113 offset:1024
  s_waitcnt lgkmcnt(6)
  v_mfma_f32_16x16x32_bf16 v[52:55], a[24:27], a[16:19], v[52:55]
  ds_read_b64_tr_b16 a[44:45], v112 offset:8192
  v_mfma_f32_16x16x32_bf16 v[60:63], a[24:27], a[20:23], v[60:63]
  ds_read_b64_tr_b16 a[46:47], v112 offset:10240
  s_waitcnt lgkmcnt(6)
  v_mfma_f32_16x16x32_bf16 v[56:59], a[28:31], a[16:19], v[56:59]
  ds_read_b128 a[0:3], v113 offset:4096
  ds_read_b64_tr_b16 a[8:9], v111 offset:12288
  v_mfma_f32_16x16x32_bf16 v[64:67], a[28:31], a[20:23], v[64:67]
  ds_read_b64_tr_b16 a[10:11], v111 offset:14336
  ds_read_b128 a[4:7], v113 offset:5120
  s_waitcnt lgkmcnt(6)
  v_mfma_f32_16x16x32_bf16 v[52:55], a[40:43], a[32:35], v[52:55]
  ds_read_b64_tr_b16 a[12:13], v112 offset:12288
  v_mfma_f32_16x16x32_bf16 v[60:63], a[40:43], a[36:39], v[60:63]
  ds_read_b64_tr_b16 a[14:15], v112 offset:14336
  s_waitcnt lgkmcnt(6)
  v_mfma_f32_16x16x32_bf16 v[56:59], a[44:47], a[32:35], v[56:59]
  s_barrier
  v_add_u32 v113, 65536, v113
  ds_read_b128 a[16:19], v113 offset:8192
  ds_read_b64_tr_b16 a[24:25], v111 offset:16384
  v_mfma_f32_16x16x32_bf16 v[64:67], a[44:47], a[36:39], v[64:67]
  ds_read_b64_tr_b16 a[26:27], v111 offset:18432
  ds_read_b128 a[20:23], v113 offset:9216
  s_waitcnt lgkmcnt(6)
  v_mfma_f32_16x16x32_bf16 v[52:55], a[8:11], a[0:3], v[52:55]
  ds_read_b64_tr_b16 a[28:29], v112 offset:16384
  v_mfma_f32_16x16x32_bf16 v[60:63], a[8:11], a[4:7], v[60:63]
  ds_read_b64_tr_b16 a[30:31], v112 offset:18432
  s_waitcnt lgkmcnt(6)
  v_mfma_f32_16x16x32_bf16 v[56:59], a[12:15], a[0:3], v[56:59]
  ds_read_b128 a[32:35], v113 offset:12288
  ds_read_b64_tr_b16 a[40:41], v111 offset:20480
  v_mfma_f32_16x16x32_bf16 v[64:67], a[12:15], a[4:7], v[64:67]
  ds_read_b64_tr_b16 a[42:43], v111 offset:22528
  ds_read_b128 a[36:39], v113 offset:13312
  s_waitcnt lgkmcnt(6)
  v_mfma_f32_16x16x32_bf16 v[52:55], a[24:27], a[16:19], v[52:55]
  ds_read_b64_tr_b16 a[44:45], v112 offset:20480
  v_mfma_f32_16x16x32_bf16 v[60:63], a[24:27], a[20:23], v[60:63]
  ds_read_b64_tr_b16 a[46:47], v112 offset:22528
  s_waitcnt lgkmcnt(6)
  v_mfma_f32_16x16x32_bf16 v[56:59], a[28:31], a[16:19], v[56:59]
  s_barrier
  v_add_u32 v113, 4294901760, v113
  ds_read_b128 a[0:3], v113 offset:8192
  ds_read_b64_tr_b16 a[8:9], v111 offset:24576
  ds_read_b64 a[64:65], v107 offset:0
  ds_read_b64 a[66:67], v108 offset:0
  ds_read_b64 a[68:69], v107 offset:1024
  ds_read_b64 a[70:71], v108 offset:1024
  ds_read_b64 a[72:73], v107 offset:2048
  ds_read_b64 a[74:75], v108 offset:2048
  ds_read_b64 a[76:77], v107 offset:3072
  ds_read_b64 a[78:79], v108 offset:3072
  v_mfma_f32_16x16x32_bf16 v[64:67], a[28:31], a[20:23], v[64:67]
  ds_read_b64_tr_b16 a[10:11], v111 offset:26624
  ds_read_b128 a[4:7], v113 offset:9216
  s_waitcnt lgkmcnt(14)
  v_mfma_f32_16x16x32_bf16 v[52:55], a[40:43], a[32:35], v[52:55]
  ds_read_b64_tr_b16 a[12:13], v112 offset:24576
  s_waitcnt lgkmcnt(7)
  v_mfma_f32_16x16x16_bf16 v[68:71], a[64:65], v[4:5], 0
  v_mfma_f32_16x16x16_bf16 v[72:75], a[66:67], v[4:5], 0
  v_mfma_f32_16x16x16_bf16 v[76:79], a[68:69], v[6:7], 0
  v_mfma_f32_16x16x32_bf16 v[60:63], a[40:43], a[36:39], v[60:63]
  ds_read_b64_tr_b16 a[14:15], v112 offset:26624
  v_mfma_f32_16x16x16_bf16 v[80:83], a[70:71], v[6:7], 0
  v_mfma_f32_16x16x16_bf16 v[84:87], a[64:65], v[8:9], 0
  v_mfma_f32_16x16x16_bf16 v[88:91], a[66:67], v[8:9], 0
  v_mfma_f32_16x16x32_bf16 v[56:59], a[44:47], a[32:35], v[56:59]
  ds_read_b128 a[16:19], v113 offset:12288
  ds_read_b64_tr_b16 a[24:25], v111 offset:28672
  v_mfma_f32_16x16x16_bf16 v[92:95], a[68:69], v[10:11], 0
  v_mfma_f32_16x16x16_bf16 v[96:99], a[70:71], v[10:11], 0
  v_mfma_f32_16x16x32_bf16 v[64:67], a[44:47], a[36:39], v[64:67]
  ds_read_b64_tr_b16 a[26:27], v111 offset:30720
  ds_read_b128 a[20:23], v113 offset:13312
  s_waitcnt lgkmcnt(6)
  v_mfma_f32_16x16x32_bf16 v[52:55], a[8:11], a[0:3], v[52:55]
  ds_read_b64_tr_b16 a[28:29], v112 offset:28672
  v_cvt_pk_bf16_f32 v72, v72, v72
  v_cvt_pk_bf16_f32 v73, v68, v69
  v_cvt_pk_bf16_f32 v74, v70, v71
  v_cvt_pk_bf16_f32 v80, v80, v80
  v_cvt_pk_bf16_f32 v81, v76, v77
  v_cvt_pk_bf16_f32 v82, v78, v79
  v_and_b32 v72, 0xffff0000, v72
  v_and_b32 v80, 0xffff0000, v80
  v_mfma_f32_16x16x32_bf16 v[60:63], a[8:11], a[4:7], v[60:63]
  ds_read_b64_tr_b16 a[30:31], v112 offset:30720
  v_add_f32 v72, s12, v72
  v_add_f32 v80, s12, v80
  v_cvt_pk_bf16_f32 v72, v72, v72
  v_cvt_pk_bf16_f32 v80, v80, v80
  v_and_b32 v72, 0xffff0000, v72
  v_and_b32 v80, 0xffff0000, v80
  v_rcp_f32 v72, v72
  s_waitcnt lgkmcnt(6)
  v_mfma_f32_16x16x32_bf16 v[56:59], a[12:15], a[0:3], v[56:59]
  s_barrier
  ds_read_b128 a[32:35], v113 offset:49152
  ds_read_b64_tr_b16 a[40:41], v111 offset:32768
  v_rcp_f32 v80, v80
  v_lshlrev_b32 v68, 16, v73
  v_and_b32 v69, 0xffff0000, v73
  v_lshlrev_b32 v70, 16, v74
  v_and_b32 v71, 0xffff0000, v74
  v_lshlrev_b32 v76, 16, v81
  v_and_b32 v77, 0xffff0000, v81
  v_mfma_f32_16x16x32_bf16 v[64:67], a[12:15], a[4:7], v[64:67]
  ds_read_b64_tr_b16 a[42:43], v111 offset:34816
  ds_read_b128 a[36:39], v113 offset:50176
  v_lshlrev_b32 v78, 16, v82
  v_and_b32 v79, 0xffff0000, v82
  v_mul_f32 v68, v68, v72
  v_mul_f32 v69, v69, v72
  v_mul_f32 v70, v70, v72
  v_mul_f32 v71, v71, v72
  v_mul_f32 v76, v76, v80
  v_mul_f32 v77, v77, v80
  s_waitcnt lgkmcnt(6)
  v_mfma_f32_16x16x32_bf16 v[52:55], a[24:27], a[16:19], v[52:55]
  ds_read_b64_tr_b16 a[44:45], v112 offset:32768
  v_mul_f32 v78, v78, v80
  v_mul_f32 v79, v79, v80
  v_cvt_pk_bf16_f32 v4, v68, v69
  v_cvt_pk_bf16_f32 v5, v70, v71
  v_cvt_pk_bf16_f32 v6, v76, v77
  v_cvt_pk_bf16_f32 v7, v78, v79
  v_mfma_f32_16x16x32_bf16 v[60:63], a[24:27], a[20:23], v[60:63]
  ds_read_b64_tr_b16 a[46:47], v112 offset:34816
  v_mfma_f32_16x16x16_bf16 v[68:71], a[72:73], v[12:13], 0
  v_mfma_f32_16x16x16_bf16 v[72:75], a[74:75], v[12:13], 0
  v_mfma_f32_16x16x16_bf16 v[76:79], a[76:77], v[14:15], 0
  v_mfma_f32_16x16x16_bf16 v[80:83], a[78:79], v[14:15], 0
  s_waitcnt lgkmcnt(6)
  v_mfma_f32_16x16x32_bf16 v[56:59], a[28:31], a[16:19], v[56:59]
  ds_read_b128 a[0:3], v113 offset:53248
  ds_read_b64_tr_b16 a[8:9], v111 offset:36864
  buffer_store_dwordx4 v[4:7], v103, s[44:47], s5 offen offset:0 sc1
  v_cvt_pk_bf16_f32 v88, v88, v88
  v_cvt_pk_bf16_f32 v89, v84, v85
  v_cvt_pk_bf16_f32 v90, v86, v87
  v_cvt_pk_bf16_f32 v96, v96, v96
  v_cvt_pk_bf16_f32 v97, v92, v93
  v_cvt_pk_bf16_f32 v98, v94, v95
  v_mfma_f32_16x16x32_bf16 v[64:67], a[28:31], a[20:23], v[64:67]
  ds_read_b64_tr_b16 a[10:11], v111 offset:38912
  ds_read_b128 a[4:7], v113 offset:54272
  v_and_b32 v88, 0xffff0000, v88
  v_and_b32 v96, 0xffff0000, v96
  v_add_f32 v88, s12, v88
  v_add_f32 v96, s12, v96
  v_cvt_pk_bf16_f32 v88, v88, v88
  v_cvt_pk_bf16_f32 v96, v96, v96
  v_and_b32 v88, 0xffff0000, v88
  v_and_b32 v96, 0xffff0000, v96
  s_waitcnt lgkmcnt(6)
  v_mfma_f32_16x16x32_bf16 v[52:55], a[40:43], a[32:35], v[52:55]
  ds_read_b64_tr_b16 a[12:13], v112 offset:36864
  v_rcp_f32 v88, v88
  v_rcp_f32 v96, v96
  v_lshlrev_b32 v84, 16, v89
  v_and_b32 v85, 0xffff0000, v89
  v_lshlrev_b32 v86, 16, v90
  v_and_b32 v87, 0xffff0000, v90
  v_mfma_f32_16x16x32_bf16 v[60:63], a[40:43], a[36:39], v[60:63]
  ds_read_b64_tr_b16 a[14:15], v112 offset:38912
  v_lshlrev_b32 v92, 16, v97
  v_and_b32 v93, 0xffff0000, v97
  v_lshlrev_b32 v94, 16, v98
  v_and_b32 v95, 0xffff0000, v98
  v_mul_f32 v84, v84, v88
  v_mul_f32 v85, v85, v88
  v_mul_f32 v86, v86, v88
  v_mul_f32 v87, v87, v88
  s_waitcnt lgkmcnt(6)
  v_mfma_f32_16x16x32_bf16 v[56:59], a[44:47], a[32:35], v[56:59]
  s_barrier
  v_add_u32 v113, 4294901760, v113
  ds_read_b128 a[16:19], v113 offset:0
  v_add_u32 v111, 65536, v111
  ds_read_b64_tr_b16 a[24:25], v111 offset:16384
  v_mul_f32 v92, v92, v96
  v_mul_f32 v93, v93, v96
  v_mul_f32 v94, v94, v96
  v_mul_f32 v95, v95, v96
  v_cvt_pk_bf16_f32 v8, v84, v85
  v_cvt_pk_bf16_f32 v9, v86, v87
  v_cvt_pk_bf16_f32 v10, v92, v93
  v_cvt_pk_bf16_f32 v11, v94, v95
  v_mfma_f32_16x16x32_bf16 v[64:67], a[44:47], a[36:39], v[64:67]
  ds_read_b64_tr_b16 a[26:27], v111 offset:18432
  ds_read_b128 a[20:23], v113 offset:1024
  v_mfma_f32_16x16x16_bf16 v[84:87], a[72:73], v[16:17], 0
  v_mfma_f32_16x16x16_bf16 v[88:91], a[74:75], v[16:17], 0
  v_mfma_f32_16x16x16_bf16 v[92:95], a[76:77], v[18:19], 0
  s_waitcnt lgkmcnt(6)
  v_mfma_f32_16x16x32_bf16 v[52:55], a[8:11], a[0:3], v[52:55]
  v_add_u32 v112, 65536, v112
  ds_read_b64_tr_b16 a[28:29], v112 offset:16384
  v_mfma_f32_16x16x16_bf16 v[96:99], a[78:79], v[18:19], 0
  buffer_store_dwordx4 v[8:11], v103, s[44:47], s5 offen offset:1024 sc1
  v_cvt_pk_bf16_f32 v72, v72, v72
  v_cvt_pk_bf16_f32 v73, v68, v69
  v_cvt_pk_bf16_f32 v74, v70, v71
  v_cvt_pk_bf16_f32 v80, v80, v80
  v_mfma_f32_16x16x32_bf16 v[60:63], a[8:11], a[4:7], v[60:63]
  ds_read_b64_tr_b16 a[30:31], v112 offset:18432
  v_cvt_pk_bf16_f32 v81, v76, v77
  v_cvt_pk_bf16_f32 v82, v78, v79
  v_and_b32 v72, 0xffff0000, v72
  v_and_b32 v80, 0xffff0000, v80
  v_add_f32 v72, s12, v72
  v_add_f32 v80, s12, v80
  v_cvt_pk_bf16_f32 v72, v72, v72
  v_cvt_pk_bf16_f32 v80, v80, v80
  s_waitcnt lgkmcnt(6)
  v_mfma_f32_16x16x32_bf16 v[56:59], a[12:15], a[0:3], v[56:59]
  ds_read_b128 a[32:35], v113 offset:4096
  ds_read_b64_tr_b16 a[40:41], v111 offset:20480
  v_and_b32 v72, 0xffff0000, v72
  v_and_b32 v80, 0xffff0000, v80
  v_rcp_f32 v72, v72
  v_rcp_f32 v80, v80
  v_lshlrev_b32 v68, 16, v73
  v_and_b32 v69, 0xffff0000, v73
  v_mfma_f32_16x16x32_bf16 v[64:67], a[12:15], a[4:7], v[64:67]
  ds_read_b64_tr_b16 a[42:43], v111 offset:22528
  ds_read_b128 a[36:39], v113 offset:5120
  v_lshlrev_b32 v70, 16, v74
  v_and_b32 v71, 0xffff0000, v74
  v_lshlrev_b32 v76, 16, v81
  v_and_b32 v77, 0xffff0000, v81
  v_lshlrev_b32 v78, 16, v82
  v_and_b32 v79, 0xffff0000, v82
  v_mul_f32 v68, v68, v72
  v_mul_f32 v69, v69, v72
  s_waitcnt lgkmcnt(6)
  v_mfma_f32_16x16x32_bf16 v[52:55], a[24:27], a[16:19], v[52:55]
  ds_read_b64_tr_b16 a[44:45], v112 offset:20480
  v_mul_f32 v70, v70, v72
  v_mul_f32 v71, v71, v72
  v_mul_f32 v76, v76, v80
  v_mul_f32 v77, v77, v80
  v_mul_f32 v78, v78, v80
  v_mul_f32 v79, v79, v80
  v_cvt_pk_bf16_f32 v12, v68, v69
  v_cvt_pk_bf16_f32 v13, v70, v71
  v_mfma_f32_16x16x32_bf16 v[60:63], a[24:27], a[20:23], v[60:63]
  ds_read_b64_tr_b16 a[46:47], v112 offset:22528
  v_cvt_pk_bf16_f32 v14, v76, v77
  v_cvt_pk_bf16_f32 v15, v78, v79
  s_add_u32 s5, s5, 4096
  buffer_store_dwordx4 v[12:15], v103, s[44:47], s5 offen offset:0 sc1
  v_cvt_pk_bf16_f32 v88, v88, v88
  v_cvt_pk_bf16_f32 v89, v84, v85
  v_cvt_pk_bf16_f32 v90, v86, v87
  s_waitcnt lgkmcnt(6)
  v_mfma_f32_16x16x32_bf16 v[56:59], a[28:31], a[16:19], v[56:59]
  s_barrier
  ds_read_b128 a[0:3], v113 offset:8192
  ds_read_b64_tr_b16 a[8:9], v111 offset:24576
  v_cvt_pk_bf16_f32 v96, v96, v96
  v_cvt_pk_bf16_f32 v97, v92, v93
  v_cvt_pk_bf16_f32 v98, v94, v95
  v_and_b32 v88, 0xffff0000, v88
  v_and_b32 v96, 0xffff0000, v96
  v_add_f32 v88, s12, v88
  v_add_f32 v96, s12, v96
  v_cvt_pk_bf16_f32 v88, v88, v88
  v_mfma_f32_16x16x32_bf16 v[64:67], a[28:31], a[20:23], v[64:67]
  ds_read_b64_tr_b16 a[10:11], v111 offset:26624
  ds_read_b128 a[4:7], v113 offset:9216
  v_cvt_pk_bf16_f32 v96, v96, v96
  v_and_b32 v88, 0xffff0000, v88
  v_and_b32 v96, 0xffff0000, v96
  v_rcp_f32 v88, v88
  v_rcp_f32 v96, v96
  v_lshlrev_b32 v84, 16, v89
  s_waitcnt lgkmcnt(6)
  v_mfma_f32_16x16x32_bf16 v[52:55], a[40:43], a[32:35], v[52:55]
  ds_read_b64_tr_b16 a[12:13], v112 offset:24576
  v_and_b32 v85, 0xffff0000, v89
  v_lshlrev_b32 v86, 16, v90
  v_and_b32 v87, 0xffff0000, v90
  v_lshlrev_b32 v92, 16, v97
  v_and_b32 v93, 0xffff0000, v97
  v_lshlrev_b32 v94, 16, v98
  v_and_b32 v95, 0xffff0000, v98
  v_mul_f32 v84, v84, v88
  v_mfma_f32_16x16x32_bf16 v[60:63], a[40:43], a[36:39], v[60:63]
  ds_read_b64_tr_b16 a[14:15], v112 offset:26624
  v_mul_f32 v85, v85, v88
  v_mul_f32 v86, v86, v88
  v_mul_f32 v87, v87, v88
  v_mul_f32 v92, v92, v96
  v_mul_f32 v93, v93, v96
  v_mul_f32 v94, v94, v96
  v_mul_f32 v95, v95, v96
  v_cvt_pk_bf16_f32 v16, v84, v85
  s_waitcnt lgkmcnt(6)
  v_mfma_f32_16x16x32_bf16 v[56:59], a[44:47], a[32:35], v[56:59]
  ds_read_b128 a[16:19], v113 offset:12288
  ds_read_b64_tr_b16 a[24:25], v111 offset:28672
  v_cvt_pk_bf16_f32 v17, v86, v87
  v_cvt_pk_bf16_f32 v18, v92, v93
  v_cvt_pk_bf16_f32 v19, v94, v95
  buffer_store_dwordx4 v[16:19], v103, s[44:47], s5 offen offset:1024 sc1
  v_mfma_f32_16x16x32_bf16 v[64:67], a[44:47], a[36:39], v[64:67]
  ds_read_b64_tr_b16 a[26:27], v111 offset:30720
  ds_read_b128 a[20:23], v113 offset:13312
  s_waitcnt lgkmcnt(6)
  v_mfma_f32_16x16x32_bf16 v[52:55], a[8:11], a[0:3], v[52:55]
  ds_read_b64_tr_b16 a[28:29], v112 offset:28672
  v_mfma_f32_16x16x32_bf16 v[60:63], a[8:11], a[4:7], v[60:63]
  ds_read_b64_tr_b16 a[30:31], v112 offset:30720
  s_waitcnt lgkmcnt(6)
  v_mfma_f32_16x16x32_bf16 v[56:59], a[12:15], a[0:3], v[56:59]
  s_barrier
  ds_read_b128 a[32:35], v113 offset:16384
  ds_read_b64_tr_b16 a[40:41], v111 offset:32768
  v_mfma_f32_16x16x32_bf16 v[64:67], a[12:15], a[4:7], v[64:67]
  ds_read_b64_tr_b16 a[42:43], v111 offset:34816
  ds_read_b128 a[36:39], v113 offset:17408
  s_waitcnt lgkmcnt(6)
  v_mfma_f32_16x16x32_bf16 v[52:55], a[24:27], a[16:19], v[52:55]
  ds_read_b64_tr_b16 a[44:45], v112 offset:32768
  v_mfma_f32_16x16x32_bf16 v[60:63], a[24:27], a[20:23], v[60:63]
  ds_read_b64_tr_b16 a[46:47], v112 offset:34816
  s_waitcnt lgkmcnt(6)
  v_mfma_f32_16x16x32_bf16 v[56:59], a[28:31], a[16:19], v[56:59]
  ds_read_b128 a[0:3], v113 offset:20480
  ds_read_b64_tr_b16 a[8:9], v111 offset:36864
  v_mfma_f32_16x16x32_bf16 v[64:67], a[28:31], a[20:23], v[64:67]
  ds_read_b64_tr_b16 a[10:11], v111 offset:38912
  ds_read_b128 a[4:7], v113 offset:21504
  s_waitcnt lgkmcnt(6)
  v_mfma_f32_16x16x32_bf16 v[52:55], a[40:43], a[32:35], v[52:55]
  ds_read_b64_tr_b16 a[12:13], v112 offset:36864
  v_mfma_f32_16x16x32_bf16 v[60:63], a[40:43], a[36:39], v[60:63]
  ds_read_b64_tr_b16 a[14:15], v112 offset:38912
  s_waitcnt lgkmcnt(6)
  v_mfma_f32_16x16x32_bf16 v[56:59], a[44:47], a[32:35], v[56:59]
  s_barrier
  ds_read_b128 a[16:19], v113 offset:24576
  v_add_u32 v111, 4294901760, v111
  ds_read_b64_tr_b16 a[24:25], v111 offset:40960
  v_mfma_f32_16x16x32_bf16 v[64:67], a[44:47], a[36:39], v[64:67]
  ds_read_b64_tr_b16 a[26:27], v111 offset:43008
  ds_read_b128 a[20:23], v113 offset:25600
  s_waitcnt lgkmcnt(6)
  v_mfma_f32_16x16x32_bf16 v[52:55], a[8:11], a[0:3], v[52:55]
  v_add_u32 v112, 4294901760, v112
  ds_read_b64_tr_b16 a[28:29], v112 offset:40960
  v_mfma_f32_16x16x32_bf16 v[60:63], a[8:11], a[4:7], v[60:63]
  ds_read_b64_tr_b16 a[30:31], v112 offset:43008
  s_waitcnt lgkmcnt(6)
  v_mfma_f32_16x16x32_bf16 v[56:59], a[12:15], a[0:3], v[56:59]
  ds_read_b128 a[32:35], v113 offset:28672
  ds_read_b64_tr_b16 a[40:41], v111 offset:45056
  v_mfma_f32_16x16x32_bf16 v[64:67], a[12:15], a[4:7], v[64:67]
  ds_read_b64_tr_b16 a[42:43], v111 offset:47104
  ds_read_b128 a[36:39], v113 offset:29696
  s_waitcnt lgkmcnt(6)
  v_mfma_f32_16x16x32_bf16 v[52:55], a[24:27], a[16:19], v[52:55]
  ds_read_b64_tr_b16 a[44:45], v112 offset:45056
  v_mfma_f32_16x16x32_bf16 v[60:63], a[24:27], a[20:23], v[60:63]
  ds_read_b64_tr_b16 a[46:47], v112 offset:47104
  s_waitcnt lgkmcnt(6)
  v_mfma_f32_16x16x32_bf16 v[56:59], a[28:31], a[16:19], v[56:59]
  s_barrier
  s_cmp_lg_u32 s52, 0
  s_cbranch_scc1 L_ni_QC_hk
  buffer_load_dword v118, v115, s[44:47], 0 offen sc1
L_ni_QC_hk:
  ds_read_b128 a[0:3], v113 offset:32768
  ds_read_b64_tr_b16 a[8:9], v111 offset:49152
  v_mfma_f32_16x16x32_bf16 v[64:67], a[28:31], a[20:23], v[64:67]
  ds_read_b64_tr_b16 a[10:11], v111 offset:51200
  ds_read_b128 a[4:7], v113 offset:33792
  s_waitcnt lgkmcnt(6)
  v_mfma_f32_16x16x32_bf16 v[52:55], a[40:43], a[32:35], v[52:55]
  ds_read_b64_tr_b16 a[12:13], v112 offset:49152
  v_mfma_f32_16x16x32_bf16 v[60:63], a[40:43], a[36:39], v[60:63]
  ds_read_b64_tr_b16 a[14:15], v112 offset:51200
  s_waitcnt lgkmcnt(6)
  v_mfma_f32_16x16x32_bf16 v[56:59], a[44:47], a[32:35], v[56:59]
  ds_read_b128 a[16:19], v113 offset:36864
  ds_read_b64_tr_b16 a[24:25], v111 offset:53248
  v_mfma_f32_16x16x32_bf16 v[64:67], a[44:47], a[36:39], v[64:67]
  ds_read_b64_tr_b16 a[26:27], v111 offset:55296
  ds_read_b128 a[20:23], v113 offset:37888
  s_waitcnt lgkmcnt(6)
  v_mfma_f32_16x16x32_bf16 v[52:55], a[8:11], a[0:3], v[52:55]
  ds_read_b64_tr_b16 a[28:29], v112 offset:53248
  v_mfma_f32_16x16x32_bf16 v[60:63], a[8:11], a[4:7], v[60:63]
  ds_read_b64_tr_b16 a[30:31], v112 offset:55296
  s_waitcnt lgkmcnt(6)
  v_mfma_f32_16x16x32_bf16 v[56:59], a[12:15], a[0:3], v[56:59]
  s_barrier
  s_waitcnt vmcnt(0)
  s_lshl_b32 s65, s53, 3
  s_add_u32 s65, s65, s54
  s_lshl_b32 s65, s65, 5
  s_add_u32 s65, s65, s52
  s_lshl_b32 s65, s65, 2
  s_add_u32 s65, s65, 10059776
  s_mov_b64 exec, 1
  buffer_store_dword v114, off, s[44:47], s65 sc1
  s_mov_b64 exec, -1
  ds_read_b128 a[32:35], v113 offset:0
  v_add_u32 v111, 65536, v111
  ds_read_b64_tr_b16 a[40:41], v111 offset:40960
  v_mfma_f32_16x16x32_bf16 v[64:67], a[12:15], a[4:7], v[64:67]
  ds_read_b64_tr_b16 a[42:43], v111 offset:43008
  ds_read_b128 a[36:39], v113 offset:1024
  s_waitcnt lgkmcnt(6)
  v_mfma_f32_16x16x32_bf16 v[52:55], a[24:27], a[16:19], v[52:55]
  v_add_u32 v112, 65536, v112
  ds_read_b64_tr_b16 a[44:45], v112 offset:40960
  v_mfma_f32_16x16x32_bf16 v[60:63], a[24:27], a[20:23], v[60:63]
  ds_read_b64_tr_b16 a[46:47], v112 offset:43008
  s_waitcnt lgkmcnt(6)
  v_mfma_f32_16x16x32_bf16 v[56:59], a[28:31], a[16:19], v[56:59]
  ds_read_b128 a[0:3], v113 offset:4096
  ds_read_b64_tr_b16 a[8:9], v111 offset:45056
  v_mfma_f32_16x16x32_bf16 v[64:67], a[28:31], a[20:23], v[64:67]
  ds_read_b64_tr_b16 a[10:11], v111 offset:47104
  ds_read_b128 a[4:7], v113 offset:5120
  s_waitcnt lgkmcnt(6)
  v_mfma_f32_16x16x32_bf16 v[52:55], a[40:43], a[32:35], v[52:55]
  ds_read_b64_tr_b16 a[12:13], v112 offset:45056
  v_mfma_f32_16x16x32_bf16 v[60:63], a[40:43], a[36:39], v[60:63]
  ds_read_b64_tr_b16 a[14:15], v112 offset:47104
  s_waitcnt lgkmcnt(6)
  v_mfma_f32_16x16x32_bf16 v[56:59], a[44:47], a[32:35], v[56:59]
  s_barrier
  ds_read_b128 a[16:19], v113 offset:8192
  v_add_u32 v111, 65536, v111
  ds_read_b64_tr_b16 a[24:25], v111 offset:0
  v_mfma_f32_16x16x32_bf16 v[64:67], a[44:47], a[36:39], v[64:67]
  ds_read_b64_tr_b16 a[26:27], v111 offset:2048
  ds_read_b128 a[20:23], v113 offset:9216
  s_waitcnt lgkmcnt(6)
  v_mfma_f32_16x16x32_bf16 v[52:55], a[8:11], a[0:3], v[52:55]
  v_add_u32 v112, 65536, v112
  ds_read_b64_tr_b16 a[28:29], v112 offset:0
  v_mfma_f32_16x16x32_bf16 v[60:63], a[8:11], a[4:7], v[60:63]
  ds_read_b64_tr_b16 a[30:31], v112 offset:2048
  s_waitcnt lgkmcnt(6)
  v_mfma_f32_16x16x32_bf16 v[56:59], a[12:15], a[0:3], v[56:59]
  ds_read_b128 a[32:35], v113 offset:12288
  ds_read_b64_tr_b16 a[40:41], v111 offset:4096
  v_mfma_f32_16x16x32_bf16 v[64:67], a[12:15], a[4:7], v[64:67]
  ds_read_b64_tr_b16 a[42:43], v111 offset:6144
  ds_read_b128 a[36:39], v113 offset:13312
  s_waitcnt lgkmcnt(6)
  v_mfma_f32_16x16x32_bf16 v[52:55], a[24:27], a[16:19], v[52:55]
  ds_read_b64_tr_b16 a[44:45], v112 offset:4096
  v_mfma_f32_16x16x32_bf16 v[60:63], a[24:27], a[20:23], v[60:63]
  ds_read_b64_tr_b16 a[46:47], v112 offset:6144
  s_waitcnt lgkmcnt(6)
  v_mfma_f32_16x16x32_bf16 v[56:59], a[28:31], a[16:19], v[56:59]
  s_barrier
  ds_read_b128 a[0:3], v113 offset:16384
  ds_read_b64_tr_b16 a[8:9], v111 offset:16384
  v_mfma_f32_16x16x32_bf16 v[64:67], a[28:31], a[20:23], v[64:67]
  ds_read_b64_tr_b16 a[10:11], v111 offset:18432
  ds_read_b128 a[4:7], v113 offset:17408
  s_waitcnt lgkmcnt(6)
  v_mfma_f32_16x16x32_bf16 v[52:55], a[40:43], a[32:35], v[52:55]
  ds_read_b64_tr_b16 a[12:13], v112 offset:16384
  v_mfma_f32_16x16x32_bf16 v[60:63], a[40:43], a[36:39], v[60:63]
  ds_read_b64_tr_b16 a[14:15], v112 offset:18432
  s_waitcnt lgkmcnt(6)
  v_mfma_f32_16x16x32_bf16 v[56:59], a[44:47], a[32:35], v[56:59]
  ds_read_b128 a[16:19], v113 offset:20480
  ds_read_b64_tr_b16 a[24:25], v111 offset:20480
  v_mfma_f32_16x16x32_bf16 v[64:67], a[44:47], a[36:39], v[64:67]
  ds_read_b64_tr_b16 a[26:27], v111 offset:22528
  ds_read_b128 a[20:23], v113 offset:21504
  s_waitcnt lgkmcnt(6)
  v_mfma_f32_16x16x32_bf16 v[52:55], a[8:11], a[0:3], v[52:55]
  ds_read_b64_tr_b16 a[28:29], v112 offset:20480
  v_mfma_f32_16x16x32_bf16 v[60:63], a[8:11], a[4:7], v[60:63]
  ds_read_b64_tr_b16 a[30:31], v112 offset:22528
  s_waitcnt lgkmcnt(6)
  v_mfma_f32_16x16x32_bf16 v[56:59], a[12:15], a[0:3], v[56:59]
  s_cmp_lg_u32 s52, 0
  s_cbranch_scc1 L_nc_QC_hk
  s_waitcnt vmcnt(1)
  v_cmp_ne_u32 vcc, v118, v114
  s_cbranch_vccnz L_slow_QC_hk
L_back_QC_hk:
L_nc_QC_hk:
  s_barrier
  ds_read_b128 a[32:35], v113 offset:24576
  v_add_u32 v111, 4294901760, v111
  ds_read_b64_tr_b16 a[40:41], v111 offset:57344
  v_mfma_f32_16x16x32_bf16 v[64:67], a[12:15], a[4:7], v[64:67]
  ds_read_b64_tr_b16 a[42:43], v111 offset:59392
  ds_read_b128 a[36:39], v113 offset:25600
  s_waitcnt lgkmcnt(6)
  v_mfma_f32_16x16x32_bf16 v[52:55], a[24:27], a[16:19], v[52:55]
  v_add_u32 v112, 4294901760, v112
  ds_read_b64_tr_b16 a[44:45], v112 offset:57344
  v_mfma_f32_16x16x32_bf16 v[60:63], a[24:27], a[20:23], v[60:63]
  ds_read_b64_tr_b16 a[46:47], v112 offset:59392
  s_waitcnt lgkmcnt(6)
  v_mfma_f32_16x16x32_bf16 v[56:59], a[28:31], a[16:19], v[56:59]
  ds_read_b128 a[0:3], v113 offset:28672
  ds_read_b64_tr_b16 a[8:9], v111 offset:61440
  v_mfma_f32_16x16x32_bf16 v[64:67], a[28:31], a[20:23], v[64:67]
  ds_read_b64_tr_b16 a[10:11], v111 offset:63488
  ds_read_b128 a[4:7], v113 offset:29696
  s_waitcnt lgkmcnt(6)
  v_mfma_f32_16x16x32_bf16 v[52:55], a[40:43], a[32:35], v[52:55]
  ds_read_b64_tr_b16 a[12:13], v112 offset:61440
  v_mfma_f32_16x16x32_bf16 v[60:63], a[40:43], a[36:39], v[60:63]
  ds_read_b64_tr_b16 a[14:15], v112 offset:63488
  s_waitcnt lgkmcnt(6)
  v_mfma_f32_16x16x32_bf16 v[56:59], a[44:47], a[32:35], v[56:59]
  s_barrier
  ds_read_b128 a[16:19], v113 offset:32768
  v_add_u32 v111, 4294901760, v111
  ds_read_b64_tr_b16 a[24:25], v111 offset:57344
  v_mfma_f32_16x16x32_bf16 v[64:67], a[44:47], a[36:39], v[64:67]
  ds_read_b64_tr_b16 a[26:27], v111 offset:59392
  ds_read_b128 a[20:23], v113 offset:33792
  s_waitcnt lgkmcnt(6)
  v_mfma_f32_16x16x32_bf16 v[52:55], a[8:11], a[0:3], v[52:55]
  v_add_u32 v112, 4294901760, v112
  ds_read_b64_tr_b16 a[28:29], v112 offset:57344
  v_mfma_f32_16x16x32_bf16 v[60:63], a[8:11], a[4:7], v[60:63]
  ds_read_b64_tr_b16 a[30:31], v112 offset:59392
  s_waitcnt lgkmcnt(6)
  v_mfma_f32_16x16x32_bf16 v[56:59], a[12:15], a[0:3], v[56:59]
  ds_read_b128 a[32:35], v113 offset:36864
  ds_read_b64_tr_b16 a[40:41], v111 offset:61440
  v_mfma_f32_16x16x32_bf16 v[64:67], a[12:15], a[4:7], v[64:67]
  ds_read_b64_tr_b16 a[42:43], v111 offset:63488
  ds_read_b128 a[36:39], v113 offset:37888
  s_waitcnt lgkmcnt(6)
  v_mfma_f32_16x16x32_bf16 v[52:55], a[24:27], a[16:19], v[52:55]
  ds_read_b64_tr_b16 a[44:45], v112 offset:61440
  v_mfma_f32_16x16x32_bf16 v[60:63], a[24:27], a[20:23], v[60:63]
  ds_read_b64_tr_b16 a[46:47], v112 offset:63488
  s_waitcnt lgkmcnt(6)
  v_mfma_f32_16x16x32_bf16 v[56:59], a[28:31], a[16:19], v[56:59]
  s_barrier
  ds_read_b128 a[0:3], v113 offset:0
  v_add_u32 v111, 65536, v111
  ds_read_b64_tr_b16 a[8:9], v111 offset:0
  v_mfma_f32_16x16x32_bf16 v[64:67], a[28:31], a[20:23], v[64:67]
  ds_read_b64_tr_b16 a[10:11], v111 offset:2048
  ds_read_b128 a[4:7], v113 offset:1024
  s_waitcnt lgkmcnt(6)
  v_mfma_f32_16x16x32_bf16 v[52:55], a[40:43], a[32:35], v[52:55]
  v_add_u32 v112, 65536, v112
  ds_read_b64_tr_b16 a[12:13], v112 offset:0
  v_mfma_f32_16x16x32_bf16 v[60:63], a[40:43], a[36:39], v[60:63]
  ds_read_b64_tr_b16 a[14:15], v112 offset:2048
  s_waitcnt lgkmcnt(6)
  v_mfma_f32_16x16x32_bf16 v[56:59], a[44:47], a[32:35], v[56:59]
  ds_read_b128 a[16:19], v113 offset:4096
  ds_read_b64_tr_b16 a[24:25], v111 offset:4096
  v_mfma_f32_16x16x32_bf16 v[64:67], a[44:47], a[36:39], v[64:67]
  ds_read_b64_tr_b16 a[26:27], v111 offset:6144
  ds_read_b128 a[20:23], v113 offset:5120
  s_waitcnt lgkmcnt(6)
  v_mfma_f32_16x16x32_bf16 v[52:55], a[8:11], a[0:3], v[52:55]
  ds_read_b64_tr_b16 a[28:29], v112 offset:4096
  v_mfma_f32_16x16x32_bf16 v[60:63], a[8:11], a[4:7], v[60:63]
  ds_read_b64_tr_b16 a[30:31], v112 offset:6144
  s_waitcnt lgkmcnt(6)
  v_mfma_f32_16x16x32_bf16 v[56:59], a[12:15], a[0:3], v[56:59]
  s_barrier
  ds_read_b128 a[32:35], v113 offset:8192
  v_add_u32 v111, 65536, v111
  ds_read_b64_tr_b16 a[40:41], v111 offset:8192
  v_mfma_f32_16x16x32_bf16 v[64:67], a[12:15], a[4:7], v[64:67]
  ds_read_b64_tr_b16 a[42:43], v111 offset:10240
  ds_read_b128 a[36:39], v113 offset:9216
  s_waitcnt lgkmcnt(6)
  v_mfma_f32_16x16x32_bf16 v[52:55], a[24:27], a[16:19], v[52:55]
  v_add_u32 v112, 65536, v112
  ds_read_b64_tr_b16 a[44:45], v112 offset:8192
  v_mfma_f32_16x16x32_bf16 v[60:63], a[24:27], a[20:23], v[60:63]
  ds_read_b64_tr_b16 a[46:47], v112 offset:10240
  s_waitcnt lgkmcnt(6)
  v_mfma_f32_16x16x32_bf16 v[56:59], a[28:31], a[16:19], v[56:59]
  ds_read_b128 a[0:3], v113 offset:12288
  ds_read_b64_tr_b16 a[8:9], v111 offset:12288
  v_mfma_f32_16x16x32_bf16 v[64:67], a[28:31], a[20:23], v[64:67]
  ds_read_b64_tr_b16 a[10:11], v111 offset:14336
  ds_read_b128 a[4:7], v113 offset:13312
  s_waitcnt lgkmcnt(6)
  v_mfma_f32_16x16x32_bf16 v[52:55], a[40:43], a[32:35], v[52:55]
  ds_read_b64_tr_b16 a[12:13], v112 offset:12288
  v_mfma_f32_16x16x32_bf16 v[60:63], a[40:43], a[36:39], v[60:63]
  ds_read_b64_tr_b16 a[14:15], v112 offset:14336
  s_waitcnt lgkmcnt(6)
  v_mfma_f32_16x16x32_bf16 v[56:59], a[44:47], a[32:35], v[56:59]
  s_barrier
  ds_read_b128 a[16:19], v113 offset:16384
  v_add_u32 v111, 4294901760, v111
  ds_read_b64_tr_b16 a[24:25], v111 offset:8192
  v_mfma_f32_16x16x32_bf16 v[64:67], a[44:47], a[36:39], v[64:67]
  ds_read_b64_tr_b16 a[26:27], v111 offset:10240
  ds_read_b128 a[20:23], v113 offset:17408
  s_waitcnt lgkmcnt(6)
  v_mfma_f32_16x16x32_bf16 v[52:55], a[8:11], a[0:3], v[52:55]
  v_add_u32 v112, 4294901760, v112
  ds_read_b64_tr_b16 a[28:29], v112 offset:8192
  v_mfma_f32_16x16x32_bf16 v[60:63], a[8:11], a[4:7], v[60:63]
  ds_read_b64_tr_b16 a[30:31], v112 offset:10240
  s_waitcnt lgkmcnt(6)
  v_mfma_f32_16x16x32_bf16 v[56:59], a[12:15], a[0:3], v[56:59]
  ds_read_b128 a[32:35], v113 offset:20480
  ds_read_b64_tr_b16 a[40:41], v111 offset:12288
  v_mfma_f32_16x16x32_bf16 v[64:67], a[12:15], a[4:7], v[64:67]
  ds_read_b64_tr_b16 a[42:43], v111 offset:14336
  ds_read_b128 a[36:39], v113 offset:21504
  s_waitcnt lgkmcnt(6)
  v_mfma_f32_16x16x32_bf16 v[52:55], a[24:27], a[16:19], v[52:55]
  ds_read_b64_tr_b16 a[44:45], v112 offset:12288
  v_mfma_f32_16x16x32_bf16 v[60:63], a[24:27], a[20:23], v[60:63]
  ds_read_b64_tr_b16 a[46:47], v112 offset:14336
  s_waitcnt lgkmcnt(6)
  v_mfma_f32_16x16x32_bf16 v[56:59], a[28:31], a[16:19], v[56:59]
  s_barrier
  ds_read_b128 a[0:3], v113 offset:24576
  ds_read_b64_tr_b16 a[8:9], v111 offset:16384
  v_mfma_f32_16x16x32_bf16 v[64:67], a[28:31], a[20:23], v[64:67]
  ds_read_b64_tr_b16 a[10:11], v111 offset:18432
  ds_read_b128 a[4:7], v113 offset:25600
  s_waitcnt lgkmcnt(6)
  v_mfma_f32_16x16x32_bf16 v[52:55], a[40:43], a[32:35], v[52:55]
  ds_read_b64_tr_b16 a[12:13], v112 offset:16384
  v_mfma_f32_16x16x32_bf16 v[60:63], a[40:43], a[36:39], v[60:63]
  ds_read_b64_tr_b16 a[14:15], v112 offset:18432
  s_waitcnt lgkmcnt(6)
  v_mfma_f32_16x16x32_bf16 v[56:59], a[44:47], a[32:35], v[56:59]
  ds_read_b128 a[16:19], v113 offset:28672
  ds_read_b64_tr_b16 a[24:25], v111 offset:20480
  v_mfma_f32_16x16x32_bf16 v[64:67], a[44:47], a[36:39], v[64:67]
  ds_read_b64_tr_b16 a[26:27], v111 offset:22528
  ds_read_b128 a[20:23], v113 offset:29696
  s_waitcnt lgkmcnt(6)
  v_mfma_f32_16x16x32_bf16 v[52:55], a[8:11], a[0:3], v[52:55]
  ds_read_b64_tr_b16 a[28:29], v112 offset:20480
  v_mfma_f32_16x16x32_bf16 v[60:63], a[8:11], a[4:7], v[60:63]
  ds_read_b64_tr_b16 a[30:31], v112 offset:22528
  s_waitcnt lgkmcnt(6)
  v_mfma_f32_16x16x32_bf16 v[56:59], a[12:15], a[0:3], v[56:59]
  s_barrier
  s_cmp_lg_u32 s52, 0
  s_cbranch_scc1 L_ni_QC_o
  buffer_load_dword v118, v116, s[44:47], 0 offen sc1
L_ni_QC_o:
  ds_read_b128 a[32:35], v113 offset:32768
  ds_read_b64_tr_b16 a[40:41], v111 offset:24576
  v_mfma_f32_16x16x32_bf16 v[64:67], a[12:15], a[4:7], v[64:67]
  ds_read_b64_tr_b16 a[42:43], v111 offset:26624
  ds_read_b128 a[36:39], v113 offset:33792
  s_waitcnt lgkmcnt(6)
  v_mfma_f32_16x16x32_bf16 v[52:55], a[24:27], a[16:19], v[52:55]
  ds_read_b64_tr_b16 a[44:45], v112 offset:24576
  v_mfma_f32_16x16x32_bf16 v[60:63], a[24:27], a[20:23], v[60:63]
  ds_read_b64_tr_b16 a[46:47], v112 offset:26624
  s_waitcnt lgkmcnt(6)
  v_mfma_f32_16x16x32_bf16 v[56:59], a[28:31], a[16:19], v[56:59]
  ds_read_b128 a[0:3], v113 offset:36864
  ds_read_b64_tr_b16 a[8:9], v111 offset:28672
  v_mfma_f32_16x16x32_bf16 v[64:67], a[28:31], a[20:23], v[64:67]
  ds_read_b64_tr_b16 a[10:11], v111 offset:30720
  ds_read_b128 a[4:7], v113 offset:37888
  s_waitcnt lgkmcnt(6)
  v_mfma_f32_16x16x32_bf16 v[52:55], a[40:43], a[32:35], v[52:55]
  ds_read_b64_tr_b16 a[12:13], v112 offset:28672
  v_mfma_f32_16x16x32_bf16 v[60:63], a[40:43], a[36:39], v[60:63]
  ds_read_b64_tr_b16 a[14:15], v112 offset:30720
  s_waitcnt lgkmcnt(6)
  v_mfma_f32_16x16x32_bf16 v[56:59], a[44:47], a[32:35], v[56:59]
  s_barrier
  ds_read_b128 a[16:19], v113 offset:0
  ds_read_b64_tr_b16 a[24:25], v111 offset:32768
  v_mfma_f32_16x16x32_bf16 v[64:67], a[44:47], a[36:39], v[64:67]
  ds_read_b64_tr_b16 a[26:27], v111 offset:34816
  ds_read_b128 a[20:23], v113 offset:1024
  s_waitcnt lgkmcnt(6)
  v_mfma_f32_16x16x32_bf16 v[52:55], a[8:11], a[0:3], v[52:55]
  ds_read_b64_tr_b16 a[28:29], v112 offset:32768
  v_mfma_f32_16x16x32_bf16 v[60:63], a[8:11], a[4:7], v[60:63]
  ds_read_b64_tr_b16 a[30:31], v112 offset:34816
  s_waitcnt lgkmcnt(6)
  v_mfma_f32_16x16x32_bf16 v[56:59], a[12:15], a[0:3], v[56:59]
  ds_read_b128 a[32:35], v113 offset:4096
  ds_read_b64_tr_b16 a[40:41], v111 offset:36864
  v_mfma_f32_16x16x32_bf16 v[64:67], a[12:15], a[4:7], v[64:67]
  ds_read_b64_tr_b16 a[42:43], v111 offset:38912
  ds_read_b128 a[36:39], v113 offset:5120
  s_waitcnt lgkmcnt(6)
  v_mfma_f32_16x16x32_bf16 v[52:55], a[24:27], a[16:19], v[52:55]
  ds_read_b64_tr_b16 a[44:45], v112 offset:36864
  v_mfma_f32_16x16x32_bf16 v[60:63], a[24:27], a[20:23], v[60:63]
  ds_read_b64_tr_b16 a[46:47], v112 offset:38912
  s_waitcnt lgkmcnt(6)
  v_mfma_f32_16x16x32_bf16 v[56:59], a[28:31], a[16:19], v[56:59]
  s_barrier
  ds_read_b128 a[0:3], v113 offset:8192
  v_add_u32 v111, 4294901760, v111
  ds_read_b64_tr_b16 a[8:9], v111 offset:40960
  v_mfma_f32_16x16x32_bf16 v[64:67], a[28:31], a[20:23], v[64:67]
  ds_read_b64_tr_b16 a[10:11], v111 offset:43008
  ds_read_b128 a[4:7], v113 offset:9216
  s_waitcnt lgkmcnt(6)
  v_mfma_f32_16x16x32_bf16 v[52:55], a[40:43], a[32:35], v[52:55]
  v_add_u32 v112, 4294901760, v112
  ds_read_b64_tr_b16 a[12:13], v112 offset:40960
  v_mfma_f32_16x16x32_bf16 v[60:63], a[40:43], a[36:39], v[60:63]
  ds_read_b64_tr_b16 a[14:15], v112 offset:43008
  s_waitcnt lgkmcnt(6)
  v_mfma_f32_16x16x32_bf16 v[56:59], a[44:47], a[32:35], v[56:59]
  ds_read_b128 a[16:19], v113 offset:12288
  ds_read_b64_tr_b16 a[24:25], v111 offset:45056
  v_mfma_f32_16x16x32_bf16 v[64:67], a[44:47], a[36:39], v[64:67]
  ds_read_b64_tr_b16 a[26:27], v111 offset:47104
  ds_read_b128 a[20:23], v113 offset:13312
  s_waitcnt lgkmcnt(6)
  v_mfma_f32_16x16x32_bf16 v[52:55], a[8:11], a[0:3], v[52:55]
  ds_read_b64_tr_b16 a[28:29], v112 offset:45056
  v_mfma_f32_16x16x32_bf16 v[60:63], a[8:11], a[4:7], v[60:63]
  ds_read_b64_tr_b16 a[30:31], v112 offset:47104
  s_waitcnt lgkmcnt(6)
  v_mfma_f32_16x16x32_bf16 v[56:59], a[12:15], a[0:3], v[56:59]
  s_barrier
  ds_read_b128 a[32:35], v113 offset:16384
  ds_read_b64_tr_b16 a[40:41], v111 offset:49152
  v_mfma_f32_16x16x32_bf16 v[64:67], a[12:15], a[4:7], v[64:67]
  ds_read_b64_tr_b16 a[42:43], v111 offset:51200
  ds_read_b128 a[36:39], v113 offset:17408
  s_waitcnt lgkmcnt(6)
  v_mfma_f32_16x16x32_bf16 v[52:55], a[24:27], a[16:19], v[52:55]
  ds_read_b64_tr_b16 a[44:45], v112 offset:49152
  v_mfma_f32_16x16x32_bf16 v[60:63], a[24:27], a[20:23], v[60:63]
  ds_read_b64_tr_b16 a[46:47], v112 offset:51200
  s_waitcnt lgkmcnt(6)
  v_mfma_f32_16x16x32_bf16 v[56:59], a[28:31], a[16:19], v[56:59]
  ds_read_b128 a[0:3], v113 offset:20480
  ds_read_b64_tr_b16 a[8:9], v111 offset:53248
  v_mfma_f32_16x16x32_bf16 v[64:67], a[28:31], a[20:23], v[64:67]
  ds_read_b64_tr_b16 a[10:11], v111 offset:55296
  ds_read_b128 a[4:7], v113 offset:21504
  s_waitcnt lgkmcnt(6)
  v_mfma_f32_16x16x32_bf16 v[52:55], a[40:43], a[32:35], v[52:55]
  ds_read_b64_tr_b16 a[12:13], v112 offset:53248
  v_mfma_f32_16x16x32_bf16 v[60:63], a[40:43], a[36:39], v[60:63]
  ds_read_b64_tr_b16 a[14:15], v112 offset:55296
  s_waitcnt lgkmcnt(6)
  v_mfma_f32_16x16x32_bf16 v[56:59], a[44:47], a[32:35], v[56:59]
  s_barrier
  ds_read_b128 a[16:19], v113 offset:24576
  v_add_u32 v111, 65536, v111
  ds_read_b64_tr_b16 a[24:25], v111 offset:40960
  v_mfma_f32_16x16x32_bf16 v[64:67], a[44:47], a[36:39], v[64:67]
  ds_read_b64_tr_b16 a[26:27], v111 offset:43008
  ds_read_b128 a[20:23], v113 offset:25600
  s_waitcnt lgkmcnt(6)
  v_mfma_f32_16x16x32_bf16 v[52:55], a[8:11], a[0:3], v[52:55]
  v_add_u32 v112, 65536, v112
  ds_read_b64_tr_b16 a[28:29], v112 offset:40960
  v_mfma_f32_16x16x32_bf16 v[60:63], a[8:11], a[4:7], v[60:63]
  ds_read_b64_tr_b16 a[30:31], v112 offset:43008
  s_waitcnt lgkmcnt(6)
  v_mfma_f32_16x16x32_bf16 v[56:59], a[12:15], a[0:3], v[56:59]
  ds_read_b128 a[32:35], v113 offset:28672
  ds_read_b64_tr_b16 a[40:41], v111 offset:45056
  v_mfma_f32_16x16x32_bf16 v[64:67], a[12:15], a[4:7], v[64:67]
  ds_read_b64_tr_b16 a[42:43], v111 offset:47104
  ds_read_b128 a[36:39], v113 offset:29696
  s_waitcnt lgkmcnt(6)
  v_mfma_f32_16x16x32_bf16 v[52:55], a[24:27], a[16:19], v[52:55]
  ds_read_b64_tr_b16 a[44:45], v112 offset:45056
  v_mfma_f32_16x16x32_bf16 v[60:63], a[24:27], a[20:23], v[60:63]
  ds_read_b64_tr_b16 a[46:47], v112 offset:47104
  s_waitcnt lgkmcnt(6)
  v_mfma_f32_16x16x32_bf16 v[56:59], a[28:31], a[16:19], v[56:59]
  s_cmp_lg_u32 s52, 0
  s_cbranch_scc1 L_nc_QC_o
  s_waitcnt vmcnt(0)
  v_cmp_ne_u32 vcc, v118, v114
  s_cbranch_vccnz L_slow_QC_o
L_back_QC_o:
L_nc_QC_o:
  s_barrier
  s_lshl_b32 s62, s56, 1
  s_and_b32 s65, s52, 1
  s_add_u32 s62, s62, s65
  s_lshl_b32 s62, s62, 5
  v_and_b32 v100, 15, v1
  v_add_u32 v100, s62, v100
  v_lshlrev_b32 v101, 3, v100
  s_mov_b32 s62, 9994240
  buffer_load_dwordx2 v[120:121], v101, s[44:47], s62 offen offset:0 sc1
  buffer_load_dwordx2 v[122:123], v101, s[44:47], s62 offen offset:128 sc1
  s_lshl_b32 s62, s57, 1
  s_lshr_b32 s65, s52, 1
  s_add_u32 s62, s62, s65
  s_lshl_b32 s62, s62, 6
  v_lshrrev_b32 v124, 5, v1
  v_lshlrev_b32 v124, 4, v124
  v_lshl_add_u32 v124, v100, 10, v124
  v_bfe_u32 v101, v1, 4, 1
  v_lshl_add_u32 v124, v101, 5, v124
  v_add_u32 v124, s62, v124
  s_mov_b32 s4, 16384
  ds_read_b128 a[0:3], v113 offset:32768
  ds_read_b64_tr_b16 a[8:9], v111 offset:49152
  v_mfma_f32_16x16x32_bf16 v[64:67], a[28:31], a[20:23], v[64:67]
  ds_read_b64_tr_b16 a[10:11], v111 offset:51200
  ds_read_b128 a[4:7], v113 offset:33792
  s_waitcnt lgkmcnt(6)
  v_mfma_f32_16x16x32_bf16 v[52:55], a[40:43], a[32:35], v[52:55]
  ds_read_b64_tr_b16 a[12:13], v112 offset:49152
  v_mfma_f32_16x16x32_bf16 v[60:63], a[40:43], a[36:39], v[60:63]
  ds_read_b64_tr_b16 a[14:15], v112 offset:51200
  s_waitcnt lgkmcnt(6)
  v_mfma_f32_16x16x32_bf16 v[56:59], a[44:47], a[32:35], v[56:59]
  ds_read_b128 a[16:19], v113 offset:36864
  ds_read_b64_tr_b16 a[24:25], v111 offset:53248
  v_mfma_f32_16x16x32_bf16 v[64:67], a[44:47], a[36:39], v[64:67]
  ds_read_b64_tr_b16 a[26:27], v111 offset:55296
  ds_read_b128 a[20:23], v113 offset:37888
  s_waitcnt lgkmcnt(6)
  v_mfma_f32_16x16x32_bf16 v[52:55], a[8:11], a[0:3], v[52:55]
  ds_read_b64_tr_b16 a[28:29], v112 offset:53248
  v_mfma_f32_16x16x32_bf16 v[60:63], a[8:11], a[4:7], v[60:63]
  ds_read_b64_tr_b16 a[30:31], v112 offset:55296
  s_waitcnt lgkmcnt(6)
  v_mfma_f32_16x16x32_bf16 v[56:59], a[12:15], a[0:3], v[56:59]
  s_barrier
  ds_read_b128 a[32:35], v113 offset:0
  v_add_u32 v111, 4294901760, v111
  ds_read_b64_tr_b16 a[40:41], v111 offset:57344
  v_mfma_f32_16x16x32_bf16 v[64:67], a[12:15], a[4:7], v[64:67]
  ds_read_b64_tr_b16 a[42:43], v111 offset:59392
  ds_read_b128 a[36:39], v113 offset:1024
  s_waitcnt lgkmcnt(6)
  v_mfma_f32_16x16x32_bf16 v[52:55], a[24:27], a[16:19], v[52:55]
  v_add_u32 v112, 4294901760, v112
  ds_read_b64_tr_b16 a[44:45], v112 offset:57344
  v_mfma_f32_16x16x32_bf16 v[60:63], a[24:27], a[20:23], v[60:63]
  ds_read_b64_tr_b16 a[46:47], v112 offset:59392
  s_waitcnt lgkmcnt(6)
  v_mfma_f32_16x16x32_bf16 v[56:59], a[28:31], a[16:19], v[56:59]
  ds_read_b128 a[0:3], v113 offset:4096
  ds_read_b64_tr_b16 a[8:9], v111 offset:61440
  v_mfma_f32_16x16x32_bf16 v[64:67], a[28:31], a[20:23], v[64:67]
  ds_read_b64_tr_b16 a[10:11], v111 offset:63488
  ds_read_b128 a[4:7], v113 offset:5120
  s_waitcnt lgkmcnt(6)
  v_mfma_f32_16x16x32_bf16 v[52:55], a[40:43], a[32:35], v[52:55]
  ds_read_b64_tr_b16 a[12:13], v112 offset:61440
  v_mfma_f32_16x16x32_bf16 v[60:63], a[40:43], a[36:39], v[60:63]
  ds_read_b64_tr_b16 a[14:15], v112 offset:63488
  s_waitcnt lgkmcnt(6)
  v_mfma_f32_16x16x32_bf16 v[56:59], a[44:47], a[32:35], v[56:59]
  s_barrier
  ds_read_b128 a[16:19], v113 offset:8192
  v_add_u32 v111, 65536, v111
  ds_read_b64_tr_b16 a[24:25], v111 offset:0
  v_mfma_f32_16x16x32_bf16 v[64:67], a[44:47], a[36:39], v[64:67]
  ds_read_b64_tr_b16 a[26:27], v111 offset:2048
  ds_read_b128 a[20:23], v113 offset:9216
  s_waitcnt lgkmcnt(6)
  v_mfma_f32_16x16x32_bf16 v[52:55], a[8:11], a[0:3], v[52:55]
  v_add_u32 v112, 65536, v112
  ds_read_b64_tr_b16 a[28:29], v112 offset:0
  v_mfma_f32_16x16x32_bf16 v[60:63], a[8:11], a[4:7], v[60:63]
  ds_read_b64_tr_b16 a[30:31], v112 offset:2048
  s_waitcnt lgkmcnt(6)
  v_mfma_f32_16x16x32_bf16 v[56:59], a[12:15], a[0:3], v[56:59]
  ds_read_b128 a[32:35], v113 offset:12288
  ds_read_b64_tr_b16 a[40:41], v111 offset:4096
  v_mfma_f32_16x16x32_bf16 v[64:67], a[12:15], a[4:7], v[64:67]
  ds_read_b64_tr_b16 a[42:43], v111 offset:6144
  ds_read_b128 a[36:39], v113 offset:13312
  s_waitcnt lgkmcnt(6)
  v_mfma_f32_16x16x32_bf16 v[52:55], a[24:27], a[16:19], v[52:55]
  ds_read_b64_tr_b16 a[44:45], v112 offset:4096
  v_mfma_f32_16x16x32_bf16 v[60:63], a[24:27], a[20:23], v[60:63]
  ds_read_b64_tr_b16 a[46:47], v112 offset:6144
  s_waitcnt lgkmcnt(6)
  v_mfma_f32_16x16x32_bf16 v[56:59], a[28:31], a[16:19], v[56:59]
  s_barrier
  ds_read_b128 a[0:3], v113 offset:16384
  ds_read_b64_tr_b16 a[8:9], v111 offset:57344
  v_mfma_f32_16x16x32_bf16 v[64:67], a[28:31], a[20:23], v[64:67]
  ds_read_b64_tr_b16 a[10:11], v111 offset:59392
  ds_read_b128 a[4:7], v113 offset:17408
  s_waitcnt lgkmcnt(6)
  v_mfma_f32_16x16x32_bf16 v[52:55], a[40:43], a[32:35], v[52:55]
  ds_read_b64_tr_b16 a[12:13], v112 offset:57344
  v_mfma_f32_16x16x32_bf16 v[60:63], a[40:43], a[36:39], v[60:63]
  ds_read_b64_tr_b16 a[14:15], v112 offset:59392
  s_waitcnt lgkmcnt(6)
  v_mfma_f32_16x16x32_bf16 v[56:59], a[44:47], a[32:35], v[56:59]
  ds_read_b128 a[16:19], v113 offset:20480
  ds_read_b64_tr_b16 a[24:25], v111 offset:61440
  v_mfma_f32_16x16x32_bf16 v[64:67], a[44:47], a[36:39], v[64:67]
  ds_read_b64_tr_b16 a[26:27], v111 offset:63488
  ds_read_b128 a[20:23], v113 offset:21504
  s_waitcnt lgkmcnt(6)
  v_mfma_f32_16x16x32_bf16 v[52:55], a[8:11], a[0:3], v[52:55]
  ds_read_b64_tr_b16 a[28:29], v112 offset:61440
  v_mfma_f32_16x16x32_bf16 v[60:63], a[8:11], a[4:7], v[60:63]
  ds_read_b64_tr_b16 a[30:31], v112 offset:63488
  s_waitcnt lgkmcnt(6)
  v_mfma_f32_16x16x32_bf16 v[56:59], a[12:15], a[0:3], v[56:59]
  s_barrier
  ds_read_b128 a[32:35], v113 offset:40960
  ds_read_b64_tr_b16 a[40:41], v111 offset:8192
  v_mfma_f32_16x16x32_bf16 v[64:67], a[12:15], a[4:7], v[64:67]
  ds_read_b64_tr_b16 a[42:43], v111 offset:10240
  ds_read_b128 a[36:39], v113 offset:41984
  s_waitcnt lgkmcnt(6)
  v_mfma_f32_16x16x32_bf16 v[52:55], a[24:27], a[16:19], v[52:55]
  ds_read_b64_tr_b16 a[44:45], v112 offset:8192
  v_mfma_f32_16x16x32_bf16 v[60:63], a[24:27], a[20:23], v[60:63]
  ds_read_b64_tr_b16 a[46:47], v112 offset:10240
  s_waitcnt lgkmcnt(6)
  v_mfma_f32_16x16x32_bf16 v[56:59], a[28:31], a[16:19], v[56:59]
  ds_read_b128 a[0:3], v113 offset:45056
  ds_read_b64_tr_b16 a[8:9], v111 offset:12288
  v_mfma_f32_16x16x32_bf16 v[64:67], a[28:31], a[20:23], v[64:67]
  ds_read_b64_tr_b16 a[10:11], v111 offset:14336
  ds_read_b128 a[4:7], v113 offset:46080
  s_waitcnt lgkmcnt(6)
  v_mfma_f32_16x16x32_bf16 v[20:23], a[40:43], a[32:35], 0
  ds_read_b64_tr_b16 a[12:13], v112 offset:12288
  v_mfma_f32_16x16x32_bf16 v[28:31], a[40:43], a[36:39], 0
  ds_read_b64_tr_b16 a[14:15], v112 offset:14336
  s_waitcnt lgkmcnt(6)
  v_mfma_f32_16x16x32_bf16 v[24:27], a[44:47], a[32:35], 0
  s_barrier
  ds_read_b128 a[16:19], v113 offset:49152
  ds_read_b64_tr_b16 a[24:25], v111 offset:16384
  v_mfma_f32_16x16x32_bf16 v[32:35], a[44:47], a[36:39], 0
  ds_read_b64_tr_b16 a[26:27], v111 offset:18432
  ds_read_b128 a[20:23], v113 offset:50176
  s_waitcnt lgkmcnt(6)
  v_mfma_f32_16x16x32_bf16 v[20:23], a[8:11], a[0:3], v[20:23]
  ds_read_b64_tr_b16 a[28:29], v112 offset:16384
  v_mfma_f32_16x16x32_bf16 v[28:31], a[8:11], a[4:7], v[28:31]
  ds_read_b64_tr_b16 a[30:31], v112 offset:18432
  s_waitcnt lgkmcnt(6)
  v_mfma_f32_16x16x32_bf16 v[24:27], a[12:15], a[0:3], v[24:27]
  ds_read_b128 a[32:35], v113 offset:53248
  ds_read_b64_tr_b16 a[40:41], v111 offset:20480
  v_mfma_f32_16x16x32_bf16 v[32:35], a[12:15], a[4:7], v[32:35]
  ds_read_b64_tr_b16 a[42:43], v111 offset:22528
  ds_read_b128 a[36:39], v113 offset:54272
  s_waitcnt lgkmcnt(6)
  v_mfma_f32_16x16x32_bf16 v[20:23], a[24:27], a[16:19], v[20:23]
  ds_read_b64_tr_b16 a[44:45], v112 offset:20480
  v_mfma_f32_16x16x32_bf16 v[28:31], a[24:27], a[20:23], v[28:31]
  ds_read_b64_tr_b16 a[46:47], v112 offset:22528
  s_waitcnt lgkmcnt(6)
  v_mfma_f32_16x16x32_bf16 v[24:27], a[28:31], a[16:19], v[24:27]
  s_barrier
  v_add_u32 v113, 65536, v113
  ds_read_b128 a[0:3], v113 offset:32768
  ds_read_b64_tr_b16 a[8:9], v111 offset:24576
  s_waitcnt vmcnt(0)
  v_mul_f32 v52, v52, v121
  v_mul_f32 v53, v53, v121
  v_mul_f32 v54, v54, v121
  v_mul_f32 v55, v55, v121
  v_mul_f32 v56, v56, v121
  v_mul_f32 v57, v57, v121
  v_mul_f32 v58, v58, v121
  v_mfma_f32_16x16x32_bf16 v[32:35], a[28:31], a[20:23], v[32:35]
  ds_read_b64_tr_b16 a[10:11], v111 offset:26624
  ds_read_b128 a[4:7], v113 offset:33792
  v_mul_f32 v59, v59, v121
  v_mul_f32 v60, v60, v123
  v_mul_f32 v61, v61, v123
  v_mul_f32 v62, v62, v123
  v_mul_f32 v63, v63, v123
  v_mul_f32 v64, v64, v123
  v_mul_f32 v65, v65, v123
  v_mul_f32 v66, v66, v123
  s_waitcnt lgkmcnt(6)
  v_mfma_f32_16x16x32_bf16 v[20:23], a[40:43], a[32:35], v[20:23]
  ds_read_b64_tr_b16 a[12:13], v112 offset:24576
  v_mul_f32 v67, v67, v123
  v_mfma_f32_16x16x32_bf16 v[28:31], a[40:43], a[36:39], v[28:31]
  ds_read_b64_tr_b16 a[14:15], v112 offset:26624
  s_waitcnt lgkmcnt(6)
  v_mfma_f32_16x16x32_bf16 v[24:27], a[44:47], a[32:35], v[24:27]
  ds_read_b128 a[16:19], v113 offset:36864
  ds_read_b64_tr_b16 a[24:25], v111 offset:28672
  v_mfma_f32_16x16x32_bf16 v[32:35], a[44:47], a[36:39], v[32:35]
  ds_read_b64_tr_b16 a[26:27], v111 offset:30720
  ds_read_b128 a[20:23], v113 offset:37888
  s_waitcnt lgkmcnt(6)
  v_mfma_f32_16x16x32_bf16 v[20:23], a[8:11], a[0:3], v[20:23]
  ds_read_b64_tr_b16 a[28:29], v112 offset:28672
  v_mfma_f32_16x16x32_bf16 v[28:31], a[8:11], a[4:7], v[28:31]
  ds_read_b64_tr_b16 a[30:31], v112 offset:30720
  s_waitcnt lgkmcnt(6)
  v_mfma_f32_16x16x32_bf16 v[24:27], a[12:15], a[0:3], v[24:27]
  s_barrier
  v_add_u32 v113, 4294901760, v113
  ds_read_b128 a[32:35], v113 offset:24576
  v_add_u32 v111, 65536, v111
  ds_read_b64_tr_b16 a[40:41], v111 offset:0
  v_mfma_f32_16x16x32_bf16 v[32:35], a[12:15], a[4:7], v[32:35]
  ds_read_b64_tr_b16 a[42:43], v111 offset:2048
  ds_read_b128 a[36:39], v113 offset:25600
  s_waitcnt lgkmcnt(6)
  v_mfma_f32_16x16x32_bf16 v[20:23], a[24:27], a[16:19], v[20:23]
  v_add_u32 v112, 65536, v112
  ds_read_b64_tr_b16 a[44:45], v112 offset:0
  v_mfma_f32_16x16x32_bf16 v[28:31], a[24:27], a[20:23], v[28:31]
  ds_read_b64_tr_b16 a[46:47], v112 offset:2048
  s_waitcnt lgkmcnt(6)
  v_mfma_f32_16x16x32_bf16 v[24:27], a[28:31], a[16:19], v[24:27]
  ds_read_b128 a[0:3], v113 offset:28672
  ds_read_b64_tr_b16 a[8:9], v111 offset:4096
  v_mfma_f32_16x16x32_bf16 v[32:35], a[28:31], a[20:23], v[32:35]
  ds_read_b64_tr_b16 a[10:11], v111 offset:6144
  ds_read_b128 a[4:7], v113 offset:29696
  s_waitcnt lgkmcnt(6)
  v_mfma_f32_16x16x32_bf16 v[20:23], a[40:43], a[32:35], v[20:23]
  ds_read_b64_tr_b16 a[12:13], v112 offset:4096
  v_mfma_f32_16x16x32_bf16 v[28:31], a[40:43], a[36:39], v[28:31]
  ds_read_b64_tr_b16 a[14:15], v112 offset:6144
  s_waitcnt lgkmcnt(6)
  v_mfma_f32_16x16x32_bf16 v[24:27], a[44:47], a[32:35], v[24:27]
  s_barrier
  ds_read_b128 a[16:19], v113 offset:32768
  v_add_u32 v111, 4294901760, v111
  ds_read_b64_tr_b16 a[24:25], v111 offset:40960
  v_mfma_f32_16x16x32_bf16 v[32:35], a[44:47], a[36:39], v[32:35]
  ds_read_b64_tr_b16 a[26:27], v111 offset:43008
  ds_read_b128 a[20:23], v113 offset:33792
  s_waitcnt lgkmcnt(6)
  v_mfma_f32_16x16x32_bf16 v[20:23], a[8:11], a[0:3], v[20:23]
  v_add_u32 v112, 4294901760, v112
  ds_read_b64_tr_b16 a[28:29], v112 offset:40960
  v_mfma_f32_16x16x32_bf16 v[28:31], a[8:11], a[4:7], v[28:31]
  ds_read_b64_tr_b16 a[30:31], v112 offset:43008
  s_waitcnt lgkmcnt(6)
  v_mfma_f32_16x16x32_bf16 v[24:27], a[12:15], a[0:3], v[24:27]
  ds_read_b128 a[32:35], v113 offset:36864
  ds_read_b64_tr_b16 a[40:41], v111 offset:45056
  v_mfma_f32_16x16x32_bf16 v[32:35], a[12:15], a[4:7], v[32:35]
  ds_read_b64_tr_b16 a[42:43], v111 offset:47104
  ds_read_b128 a[36:39], v113 offset:37888
  s_waitcnt lgkmcnt(6)
  v_mfma_f32_16x16x32_bf16 v[20:23], a[24:27], a[16:19], v[20:23]
  ds_read_b64_tr_b16 a[44:45], v112 offset:45056
  v_mfma_f32_16x16x32_bf16 v[28:31], a[24:27], a[20:23], v[28:31]
  ds_read_b64_tr_b16 a[46:47], v112 offset:47104
  s_waitcnt lgkmcnt(6)
  v_mfma_f32_16x16x32_bf16 v[24:27], a[28:31], a[16:19], v[24:27]
  s_barrier
  ds_read_b128 a[0:3], v113 offset:0
  ds_read_b64_tr_b16 a[8:9], v111 offset:49152
  v_mfma_f32_16x16x32_bf16 v[32:35], a[28:31], a[20:23], v[32:35]
  ds_read_b64_tr_b16 a[10:11], v111 offset:51200
  ds_read_b128 a[4:7], v113 offset:1024
  s_waitcnt lgkmcnt(6)
  v_mfma_f32_16x16x32_bf16 v[20:23], a[40:43], a[32:35], v[20:23]
  ds_read_b64_tr_b16 a[12:13], v112 offset:49152
  v_mfma_f32_16x16x32_bf16 v[28:31], a[40:43], a[36:39], v[28:31]
  ds_read_b64_tr_b16 a[14:15], v112 offset:51200
  s_waitcnt lgkmcnt(6)
  v_mfma_f32_16x16x32_bf16 v[24:27], a[44:47], a[32:35], v[24:27]
  ds_read_b128 a[16:19], v113 offset:4096
  ds_read_b64_tr_b16 a[24:25], v111 offset:53248
  v_mfma_f32_16x16x32_bf16 v[32:35], a[44:47], a[36:39], v[32:35]
  ds_read_b64_tr_b16 a[26:27], v111 offset:55296
  ds_read_b128 a[20:23], v113 offset:5120
  s_waitcnt lgkmcnt(6)
  v_mfma_f32_16x16x32_bf16 v[20:23], a[8:11], a[0:3], v[20:23]
  ds_read_b64_tr_b16 a[28:29], v112 offset:53248
  v_mfma_f32_16x16x32_bf16 v[28:31], a[8:11], a[4:7], v[28:31]
  ds_read_b64_tr_b16 a[30:31], v112 offset:55296
  s_waitcnt lgkmcnt(6)
  v_mfma_f32_16x16x32_bf16 v[24:27], a[12:15], a[0:3], v[24:27]
  s_barrier
  ds_read_b128 a[32:35], v113 offset:8192
  v_add_u32 v111, 4294901760, v111
  ds_read_b64_tr_b16 a[40:41], v111 offset:57344
  v_mfma_f32_16x16x32_bf16 v[32:35], a[12:15], a[4:7], v[32:35]
  ds_read_b64_tr_b16 a[42:43], v111 offset:59392
  ds_read_b128 a[36:39], v113 offset:9216
  s_waitcnt lgkmcnt(6)
  v_mfma_f32_16x16x32_bf16 v[20:23], a[24:27], a[16:19], v[20:23]
  v_add_u32 v112, 4294901760, v112
  ds_read_b64_tr_b16 a[44:45], v112 offset:57344
  v_mfma_f32_16x16x32_bf16 v[28:31], a[24:27], a[20:23], v[28:31]
  ds_read_b64_tr_b16 a[46:47], v112 offset:59392
  s_waitcnt lgkmcnt(6)
  v_mfma_f32_16x16x32_bf16 v[24:27], a[28:31], a[16:19], v[24:27]
  ds_read_b128 a[0:3], v113 offset:12288
  ds_read_b64_tr_b16 a[8:9], v111 offset:61440
  v_mfma_f32_16x16x32_bf16 v[32:35], a[28:31], a[20:23], v[32:35]
  ds_read_b64_tr_b16 a[10:11], v111 offset:63488
  ds_read_b128 a[4:7], v113 offset:13312
  s_waitcnt lgkmcnt(6)
  v_mfma_f32_16x16x32_bf16 v[20:23], a[40:43], a[32:35], v[20:23]
  ds_read_b64_tr_b16 a[12:13], v112 offset:61440
  v_mfma_f32_16x16x32_bf16 v[28:31], a[40:43], a[36:39], v[28:31]
  ds_read_b64_tr_b16 a[14:15], v112 offset:63488
  s_waitcnt lgkmcnt(6)
  v_mfma_f32_16x16x32_bf16 v[24:27], a[44:47], a[32:35], v[24:27]
  s_barrier
  ds_read_b128 a[16:19], v113 offset:16384
  v_add_u32 v111, 65536, v111
  ds_read_b64_tr_b16 a[24:25], v111 offset:0
  v_mfma_f32_16x16x32_bf16 v[32:35], a[44:47], a[36:39], v[32:35]
  ds_read_b64_tr_b16 a[26:27], v111 offset:2048
  ds_read_b128 a[20:23], v113 offset:17408
  s_waitcnt lgkmcnt(6)
  v_mfma_f32_16x16x32_bf16 v[20:23], a[8:11], a[0:3], v[20:23]
  v_add_u32 v112, 65536, v112
  ds_read_b64_tr_b16 a[28:29], v112 offset:0
  v_mfma_f32_16x16x32_bf16 v[28:31], a[8:11], a[4:7], v[28:31]
  ds_read_b64_tr_b16 a[30:31], v112 offset:2048
  s_waitcnt lgkmcnt(6)
  v_mfma_f32_16x16x32_bf16 v[24:27], a[12:15], a[0:3], v[24:27]
  ds_read_b128 a[32:35], v113 offset:20480
  ds_read_b64_tr_b16 a[40:41], v111 offset:4096
  v_mfma_f32_16x16x32_bf16 v[32:35], a[12:15], a[4:7], v[32:35]
  ds_read_b64_tr_b16 a[42:43], v111 offset:6144
  ds_read_b128 a[36:39], v113 offset:21504
  s_waitcnt lgkmcnt(6)
  v_mfma_f32_16x16x32_bf16 v[20:23], a[24:27], a[16:19], v[20:23]
  ds_read_b64_tr_b16 a[44:45], v112 offset:4096
  v_mfma_f32_16x16x32_bf16 v[28:31], a[24:27], a[20:23], v[28:31]
  ds_read_b64_tr_b16 a[46:47], v112 offset:6144
  s_waitcnt lgkmcnt(6)
  v_mfma_f32_16x16x32_bf16 v[24:27], a[28:31], a[16:19], v[24:27]
  v_mfma_f32_16x16x32_bf16 v[32:35], a[28:31], a[20:23], v[32:35]
  s_waitcnt lgkmcnt(2)
  v_mfma_f32_16x16x32_bf16 v[20:23], a[40:43], a[32:35], v[20:23]
  v_mfma_f32_16x16x32_bf16 v[28:31], a[40:43], a[36:39], v[28:31]
  s_waitcnt lgkmcnt(0)
  v_mfma_f32_16x16x32_bf16 v[24:27], a[44:47], a[32:35], v[24:27]
  v_mfma_f32_16x16x32_bf16 v[32:35], a[44:47], a[36:39], v[32:35]
  s_nop 3
  v_fma_f32 v20, v20, v120, v52
  v_fma_f32 v21, v21, v120, v53
  v_fma_f32 v22, v22, v120, v54
  v_fma_f32 v23, v23, v120, v55
  v_fma_f32 v24, v24, v120, v56
  v_fma_f32 v25, v25, v120, v57
  v_fma_f32 v26, v26, v120, v58
  v_fma_f32 v27, v27, v120, v59
  v_cvt_pk_bf16_f32 v68, v20, v21
  v_cvt_pk_bf16_f32 v69, v22, v23
  v_cvt_pk_bf16_f32 v70, v24, v25
  v_cvt_pk_bf16_f32 v71, v26, v27
  s_nop 0
  v_permlane16_swap_b32 v68, v70
  v_permlane16_swap_b32 v69, v71
  buffer_store_dwordx4 v[68:71], v124, s[48:51], 0 offen nt
  v_fma_f32 v28, v28, v122, v60
  v_fma_f32 v29, v29, v122, v61
  v_fma_f32 v30, v30, v122, v62
  v_fma_f32 v31, v31, v122, v63
  v_fma_f32 v32, v32, v122, v64
  v_fma_f32 v33, v33, v122, v65
  v_fma_f32 v34, v34, v122, v66
  v_fma_f32 v35, v35, v122, v67
  v_cvt_pk_bf16_f32 v72, v28, v29
  v_cvt_pk_bf16_f32 v73, v30, v31
  v_cvt_pk_bf16_f32 v74, v32, v33
  v_cvt_pk_bf16_f32 v75, v34, v35
  s_nop 0
  v_permlane16_swap_b32 v72, v74
  v_permlane16_swap_b32 v73, v75
  buffer_store_dwordx4 v[72:75], v124, s[48:51], s4 offen nt
  s_endpgm
L_slow_QC_nonce:
  s_mov_b32 s68, 1000000
L_spin_QC_nonce:
  s_sleep 4
  global_load_dword v114, v104, s[20:21] sc1
  s_waitcnt vmcnt(0)
  v_cmp_eq_u32 vcc, 0, v114
  s_cbranch_vccz L_back_QC_nonce
  s_sub_u32 s68, s68, 1
  s_cmp_lg_u32 s68, 0
  s_cbranch_scc1 L_spin_QC_nonce
  s_branch L_back_QC_nonce
L_slow_QC_kv:
  s_mov_b32 s68, 1000000
L_spin_QC_kv:
  s_sleep 4
  buffer_load_dword v118, v117, s[44:47], 0 offen sc1
  s_waitcnt vmcnt(0)
  v_cmp_ne_u32 vcc, v118, v114
  s_cbranch_vccz L_back_QC_kv
  s_sub_u32 s68, s68, 1
  s_cmp_lg_u32 s68, 0
  s_cbranch_scc1 L_spin_QC_kv
  s_branch L_back_QC_kv
L_slow_QC_hk:
  s_mov_b32 s68, 1000000
L_spin_QC_hk:
  s_sleep 4
  buffer_load_dword v118, v115, s[44:47], 0 offen sc1
  s_waitcnt vmcnt(0)
  v_cmp_ne_u32 vcc, v118, v114
  s_cbranch_vccz L_back_QC_hk
  s_sub_u32 s68, s68, 1
  s_cmp_lg_u32 s68, 0
  s_cbranch_scc1 L_spin_QC_hk
  s_branch L_back_QC_hk
L_slow_QC_o:
  s_mov_b32 s68, 1000000
L_spin_QC_o:
  s_sleep 4
  buffer_load_dword v118, v116, s[44:47], 0 offen sc1
  s_waitcnt vmcnt(0)
  v_cmp_ne_u32 vcc, v118, v114
  s_cbranch_vccz L_back_QC_o
  s_sub_u32 s68, s68, 1
  s_cmp_lg_u32 s68, 0
  s_cbranch_scc1 L_spin_QC_o
  s_branch L_back_QC_o
L_QL_rest:
  s_lshr_b32 s58, s2, 6
  s_and_b32 s57, s58, 0
  s_lshr_b32 s62, s2, 3
  s_xor_b32 s57, s57, s62
  s_and_b32 s57, s57, 7
  s_and_b32 s62, s2, 7
  s_lshl2_add_u32 s56, s62, s58
  s_lshl_b32 s60, s52, 11
  s_mul_i32 s61, s52, 3072
  s_sub_u32 s28, s6, 4096
  s_subb_u32 s29, s7, 0
  s_and_b32 s29, s29, 0xffff
  s_mov_b32 s30, 1576960
  s_mov_b32 s31, 0x20000
  s_mov_b32 s36, s14
  s_and_b32 s37, s15, 0xffff
  s_mov_b32 s38, 1835008
  s_mov_b32 s39, 0x20000
  s_mov_b32 s40, s8
  s_and_b32 s41, s9, 0xffff
  s_mov_b32 s42, 524288
  s_mov_b32 s43, 0x20000
  s_mov_b32 s44, s22
  s_and_b32 s45, s23, 0xffff
  s_mov_b32 s46, 10354688
  s_mov_b32 s47, 0x20000
  s_mov_b32 s62, 3072
  v_mad_u32_u24 v5, v17, s62, v16
  s_lshl_b32 s62, s54, 7
  s_add_u32 s62, s62, 4096
  v_add_u32 v92, s62, v5
  v_xor_b32 v93, 64, v92
  v_add_u32 v93, 23552, v93
  v_lshrrev_b32 v5, 3, v1
  v_and_b32 v5, 6, v5
  v_xor_b32 v5, v5, v1
  v_and_b32 v5, 7, v5
  v_lshlrev_b32 v5, 4, v5
  v_lshl_add_u32 v96, v17, 10, v5
  s_lshl_b32 s62, s57, 7
  v_add_u32 v96, s62, v96
  v_add_u32 v97, 7168, v96
  v_add_u32 v98, s60, v88
  v_add_u32 v99, s60, v88
  s_mul_i32 s67, s56, 294912
  s_mul_i32 s62, s58, 1
  s_lshr_b32 s63, s57, 0
  s_mul_i32 s63, s63, 1
  s_add_u32 s62, s62, s63
  s_add_u32 s9, s62, 0
  s_and_b32 s9, s9, 3
  s_lshl_b32 s9, s9, 13
  s_add_u32 s18, s62, 1
  s_and_b32 s18, s18, 3
  s_lshl_b32 s18, s18, 13
  s_add_u32 s19, s62, 2
  s_and_b32 s19, s19, 3
  s_lshl_b32 s19, s19, 13
  s_add_u32 s22, s62, 3
  s_and_b32 s22, s22, 3
  s_lshl_b32 s22, s22, 13
  v_bfe_u32 v4, v1, 1, 3
  v_lshlrev_b32 v4, 7, v4
  v_and_b32 v5, 1, v1
  v_lshl_add_u32 v4, v5, 2, v4
  s_lshr_b32 s62, s56, 1
  s_lshl_b32 s62, s62, 10
  s_and_b32 s63, s56, 1
  s_lshl_b32 s63, s63, 3
  s_add_u32 s62, s62, s63
  s_add_u32 s62, s62, 10010624
  v_add_u32 v100, s62, v4
  v_add_u32 v101, 16384, v100
  v_add_u32 v102, 49152, v100
  s_lshl_b32 s62, s54, 11
  s_add_u32 s62, s62, 10076160
  v_and_b32 v4, 15, v1
  v_lshlrev_b32 v4, 7, v4
  s_lshl_b32 s63, s52, 2
  s_add_u32 s62, s62, s63
  v_add_u32 v103, s62, v4
  s_mov_b32 s13, 0x3f803f80
  v_mov_b32 v104, 163776
  ds_write_b32 v104, v89 offset:0
  ds_write_b32 v104, v89 offset:4
  ds_write_b32 v104, v89 offset:8
  s_lshl_b32 s62, s52, 10
  s_add_u32 s62, s62, 159744
  v_lshlrev_b32 v105, 3, v1
  v_add_u32 v105, s62, v105
  s_waitcnt vmcnt(5)
  s_barrier
  s_waitcnt vmcnt(0)
  v_lshlrev_b32 v40, 16, v36
  v_and_b32 v41, 0xffff0000, v36
  v_lshlrev_b32 v42, 16, v37
  v_and_b32 v43, 0xffff0000, v37
  v_lshlrev_b32 v44, 16, v38
  v_and_b32 v45, 0xffff0000, v38
  v_lshlrev_b32 v46, 16, v39
  v_and_b32 v47, 0xffff0000, v39
  v_lshlrev_b32 v108, 16, v20
  v_and_b32 v109, 0xffff0000, v20
  v_lshlrev_b32 v110, 16, v21
  v_and_b32 v111, 0xffff0000, v21
  v_lshlrev_b32 v112, 16, v22
  v_and_b32 v113, 0xffff0000, v22
  v_lshlrev_b32 v114, 16, v23
  v_and_b32 v115, 0xffff0000, v23
  v_pk_mul_f32 v[108:109], v[108:109], v[40:41]
  v_pk_mul_f32 v[110:111], v[110:111], v[42:43]
  v_pk_mul_f32 v[112:113], v[112:113], v[44:45]
  v_pk_mul_f32 v[114:115], v[114:115], v[46:47]
  v_cvt_pk_bf16_f32 v108, v108, v109
  v_cvt_pk_bf16_f32 v110, v110, v111
  v_cvt_pk_bf16_f32 v112, v112, v113
  v_cvt_pk_bf16_f32 v114, v114, v115
  v_dot2_f32_bf16 v48, v108, s13, 0
  v_dot2_f32_bf16 v48, v110, s13, v48
  v_dot2_f32_bf16 v48, v112, s13, v48
  v_dot2_f32_bf16 v48, v114, s13, v48
  v_lshlrev_b32 v108, 16, v24
  v_and_b32 v109, 0xffff0000, v24
  v_lshlrev_b32 v110, 16, v25
  v_and_b32 v111, 0xffff0000, v25
  v_lshlrev_b32 v112, 16, v26
  v_and_b32 v113, 0xffff0000, v26
  v_lshlrev_b32 v114, 16, v27
  v_and_b32 v115, 0xffff0000, v27
  v_pk_mul_f32 v[108:109], v[108:109], v[40:41]
  v_pk_mul_f32 v[110:111], v[110:111], v[42:43]
  v_pk_mul_f32 v[112:113], v[112:113], v[44:45]
  v_pk_mul_f32 v[114:115], v[114:115], v[46:47]
  v_cvt_pk_bf16_f32 v108, v108, v109
  v_cvt_pk_bf16_f32 v110, v110, v111
  v_cvt_pk_bf16_f32 v112, v112, v113
  v_cvt_pk_bf16_f32 v114, v114, v115
  v_dot2_f32_bf16 v49, v108, s13, 0
  v_dot2_f32_bf16 v49, v110, s13, v49
  v_dot2_f32_bf16 v49, v112, s13, v49
  v_dot2_f32_bf16 v49, v114, s13, v49
  v_lshlrev_b32 v108, 16, v28
  v_and_b32 v109, 0xffff0000, v28
  v_lshlrev_b32 v110, 16, v29
  v_and_b32 v111, 0xffff0000, v29
  v_lshlrev_b32 v112, 16, v30
  v_and_b32 v113, 0xffff0000, v30
  v_lshlrev_b32 v114, 16, v31
  v_and_b32 v115, 0xffff0000, v31
  v_pk_mul_f32 v[108:109], v[108:109], v[40:41]
  v_pk_mul_f32 v[110:111], v[110:111], v[42:43]
  v_pk_mul_f32 v[112:113], v[112:113], v[44:45]
  v_pk_mul_f32 v[114:115], v[114:115], v[46:47]
  v_cvt_pk_bf16_f32 v108, v108, v109
  v_cvt_pk_bf16_f32 v110, v110, v111
  v_cvt_pk_bf16_f32 v112, v112, v113
  v_cvt_pk_bf16_f32 v114, v114, v115
  v_dot2_f32_bf16 v50, v108, s13, 0
  v_dot2_f32_bf16 v50, v110, s13, v50
  v_dot2_f32_bf16 v50, v112, s13, v50
  v_dot2_f32_bf16 v50, v114, s13, v50
  v_lshlrev_b32 v108, 16, v32
  v_and_b32 v109, 0xffff0000, v32
  v_lshlrev_b32 v110, 16, v33
  v_and_b32 v111, 0xffff0000, v33
  v_lshlrev_b32 v112, 16, v34
  v_and_b32 v113, 0xffff0000, v34
  v_lshlrev_b32 v114, 16, v35
  v_and_b32 v115, 0xffff0000, v35
  v_pk_mul_f32 v[108:109], v[108:109], v[40:41]
  v_pk_mul_f32 v[110:111], v[110:111], v[42:43]
  v_pk_mul_f32 v[112:113], v[112:113], v[44:45]
  v_pk_mul_f32 v[114:115], v[114:115], v[46:47]
  v_cvt_pk_bf16_f32 v108, v108, v109
  v_cvt_pk_bf16_f32 v110, v110, v111
  v_cvt_pk_bf16_f32 v112, v112, v113
  v_cvt_pk_bf16_f32 v114, v114, v115
  v_dot2_f32_bf16 v51, v108, s13, 0
  v_dot2_f32_bf16 v51, v110, s13, v51
  v_dot2_f32_bf16 v51, v112, s13, v51
  v_dot2_f32_bf16 v51, v114, s13, v51
  v_permlane32_swap_b32 v48, v49
  s_nop 1
  v_permlane32_swap_b32 v50, v51
  v_add_f32 v48, v48, v49
  v_add_f32 v50, v50, v51
  s_nop 1
  v_permlane16_swap_b32 v48, v50
  v_add_f32 v48, v48, v50
  s_nop 1
  v_add_f32_dpp v48, v48, v48 row_ror:8 row_mask:0xf bank_mask:0xf
  s_nop 1
  v_add_f32_dpp v48, v48, v48 row_ror:4 row_mask:0xf bank_mask:0xf
  s_nop 1
  v_add_f32_dpp v48, v48, v48 row_ror:2 row_mask:0xf bank_mask:0xf
  s_nop 1
  v_add_f32_dpp v48, v48, v48 row_ror:1 row_mask:0xf bank_mask:0xf
  v_cvt_pk_bf16_f32 v48, v48, v48
  v_and_b32 v48, 0xffff0000, v48
  v_mul_f32 v48, 0xbfb8aa3b, v48
  v_exp_f32 v48, v48
  s_nop 0
  v_add_f32 v48, 1.0, v48
  v_rcp_f32 v48, v48
  s_nop 0
  v_cvt_pk_bf16_f32 v48, v48, v48
  v_and_b32 v50, 0xffff0000, v48
  v_sub_f32 v51, 1.0, v50
  v_cvt_pk_bf16_f32 v51, v51, v51
  v_and_b32 v51, 0xffff0000, v51
  v_bfe_u32 v116, v1, 4, 1
  v_lshlrev_b32 v116, 4, v116
  v_lshrrev_b32 v117, 5, v1
  v_lshl_add_u32 v116, v117, 3, v116
  s_lshl_b32 s4, s53, 3
  s_add_u32 s4, s4, s54
  s_lshl_b32 s4, s4, 2
  s_add_u32 s4, s4, s52
  s_lshl_b32 s4, s4, 5
  s_add_u32 s4, s4, 9994240
  s_mov_b32 exec_lo, 0x00010001
  s_mov_b32 exec_hi, 0x00010001
  buffer_store_dwordx2 v[50:51], v116, s[44:47], s4 offen sc1
  s_mov_b64 exec, -1
  s_add_u32 s55, s69, 128
  s_and_b32 s55, s55, 255
  s_add_u32 m0, s59, 32768
  s_mul_i32 s62, s55, 1792
  buffer_load_dwordx4 v8, s[24:27], s55 offen offset:0 lds
  buffer_load_dwordx4 v9, s[24:27], s55 offen offset:1024 lds
  buffer_load_dwordx4 v10, s[24:27], s55 offen offset:2048 lds
  buffer_load_dwordx4 v11, s[24:27], s55 offen offset:3072 lds
  s_add_u32 m0, s59, 49152
  s_nop 0
  buffer_load_dwordx4 v12, s[32:35], s62 offen offset:0 lds
  buffer_load_dwordx4 v13, s[32:35], s62 offen offset:1024 lds
  buffer_load_dwordx4 v14, s[32:35], s62 offen offset:2048 lds
  buffer_load_dwordx4 v15, s[32:35], s62 offen offset:3072 lds
  s_or_b32 s55, s69, 256
  s_add_u32 m0, s59, 65536
  s_mul_i32 s62, s55, 1792
  buffer_load_dwordx4 v8, s[24:27], s55 offen offset:0 lds
  buffer_load_dwordx4 v9, s[24:27], s55 offen offset:1024 lds
  buffer_load_dwordx4 v10, s[24:27], s55 offen offset:2048 lds
  buffer_load_dwordx4 v11, s[24:27], s55 offen offset:3072 lds
  s_add_u32 m0, s59, 81920
  s_nop 0
  buffer_load_dwordx4 v12, s[32:35], s62 offen offset:0 lds
  buffer_load_dwordx4 v13, s[32:35], s62 offen offset:1024 lds
  buffer_load_dwordx4 v14, s[32:35], s62 offen offset:2048 lds
  buffer_load_dwordx4 v15, s[32:35], s62 offen offset:3072 lds
  s_waitcnt vmcnt(8)
  s_barrier
  s_add_u32 s55, s69, 128
  s_and_b32 s55, s55, 255
  s_or_b32 s55, s55, 256
  s_add_u32 m0, s59, 0
  s_mul_i32 s62, s55, 1792
  buffer_load_dwordx4 v8, s[24:27], s55 offen offset:0 lds
  buffer_load_dwordx4 v9, s[24:27], s55 offen offset:1024 lds
  buffer_load_dwordx4 v10, s[24:27], s55 offen offset:2048 lds
  buffer_load_dwordx4 v11, s[24:27], s55 offen offset:3072 lds
  s_add_u32 m0, s59, 98304
  s_nop 0
  buffer_load_dwordx4 v12, s[32:35], s62 offen offset:0 lds
  buffer_load_dwordx4 v13, s[32:35], s62 offen offset:1024 lds
  buffer_load_dwordx4 v14, s[32:35], s62 offen offset:2048 lds
  buffer_load_dwordx4 v15, s[32:35], s62 offen offset:3072 lds
  s_waitcnt vmcnt(8)
  s_barrier
  s_or_b32 s55, s69, 512
  s_add_u32 m0, s59, 16384
  s_mul_i32 s62, s55, 1792
  buffer_load_dwordx4 v8, s[24:27], s55 offen offset:0 lds
  buffer_load_dwordx4 v9, s[24:27], s55 offen offset:1024 lds
  buffer_load_dwordx4 v10, s[24:27], s55 offen offset:2048 lds
  buffer_load_dwordx4 v11, s[24:27], s55 offen offset:3072 lds
  s_add_u32 m0, s59, 32768
  s_nop 0
  buffer_load_dwordx4 v12, s[32:35], s62 offen offset:0 lds
  buffer_load_dwordx4 v13, s[32:35], s62 offen offset:1024 lds
  buffer_load_dwordx4 v14, s[32:35], s62 offen offset:2048 lds
  buffer_load_dwordx4 v15, s[32:35], s62 offen offset:3072 lds
  s_waitcnt vmcnt(8)
  s_barrier
  s_add_u32 s55, s69, 128
  s_and_b32 s55, s55, 255
  s_or_b32 s55, s55, 512
  s_add_u32 m0, s59, 49152
  s_mul_i32 s62, s55, 1792
  buffer_load_dwordx4 v8, s[24:27], s55 offen offset:0 lds
  buffer_load_dwordx4 v9, s[24:27], s55 offen offset:1024 lds
  buffer_load_dwordx4 v10, s[24:27], s55 offen offset:2048 lds
  buffer_load_dwordx4 v11, s[24:27], s55 offen offset:3072 lds
  s_add_u32 m0, s59, 65536
  s_nop 0
  buffer_load_dwordx4 v12, s[32:35], s62 offen offset:0 lds
  buffer_load_dwordx4 v13, s[32:35], s62 offen offset:1024 lds
  buffer_load_dwordx4 v14, s[32:35], s62 offen offset:2048 lds
  buffer_load_dwordx4 v15, s[32:35], s62 offen offset:3072 lds
  s_waitcnt vmcnt(8)
  s_barrier
  s_or_b32 s55, s69, 768
  s_add_u32 m0, s59, 0
  s_mul_i32 s62, s55, 1792
  buffer_load_dwordx4 v8, s[24:27], s55 offen offset:0 lds
  buffer_load_dwordx4 v9, s[24:27], s55 offen offset:1024 lds
  buffer_load_dwordx4 v10, s[24:27], s55 offen offset:2048 lds
  buffer_load_dwordx4 v11, s[24:27], s55 offen offset:3072 lds
  s_add_u32 m0, s59, 81920
  s_nop 0
  buffer_load_dwordx4 v12, s[32:35], s62 offen offset:0 lds
  buffer_load_dwordx4 v13, s[32:35], s62 offen offset:1024 lds
  buffer_load_dwordx4 v14, s[32:35], s62 offen offset:2048 lds
  buffer_load_dwordx4 v15, s[32:35], s62 offen offset:3072 lds
  global_load_dword v118, v89, s[20:21] sc1
  s_waitcnt vmcnt(9)
  s_barrier
  s_add_u32 s55, s69, 128
  s_and_b32 s55, s55, 255
  s_or_b32 s55, s55, 768
  s_add_u32 m0, s59, 16384
  s_mul_i32 s62, s55, 1792
  buffer_load_dwordx4 v8, s[24:27], s55 offen offset:0 lds
  buffer_load_dwordx4 v9, s[24:27], s55 offen offset:1024 lds
  buffer_load_dwordx4 v10, s[24:27], s55 offen offset:2048 lds
  buffer_load_dwordx4 v11, s[24:27], s55 offen offset:3072 lds
  s_add_u32 m0, s59, 98304
  s_nop 0
  buffer_load_dwordx4 v12, s[32:35], s62 offen offset:0 lds
  buffer_load_dwordx4 v13, s[32:35], s62 offen offset:1024 lds
  buffer_load_dwordx4 v14, s[32:35], s62 offen offset:2048 lds
  buffer_load_dwordx4 v15, s[32:35], s62 offen offset:3072 lds
  s_waitcnt vmcnt(9)
  s_waitcnt lgkmcnt(0)
  s_barrier
  s_mov_b32 s55, s69
  s_add_u32 m0, s60, 32768
  s_mul_i32 s62, s55, 1536
  buffer_load_dwordx4 v92, s[28:31], s62 offen offset:0 lds
  buffer_load_dwordx4 v93, s[28:31], s62 offen offset:1024 lds
  s_add_u32 s55, s69, 128
  s_and_b32 s55, s55, 255
  s_add_u32 m0, s60, 40960
  s_mul_i32 s62, s55, 1536
  buffer_load_dwordx4 v92, s[28:31], s62 offen offset:0 lds
  buffer_load_dwordx4 v93, s[28:31], s62 offen offset:1024 lds
  s_or_b32 s55, s69, 256
  s_add_u32 m0, s60, 49152
  s_mul_i32 s62, s55, 1536
  buffer_load_dwordx4 v92, s[28:31], s62 offen offset:0 lds
  buffer_load_dwordx4 v93, s[28:31], s62 offen offset:1024 lds
  s_add_u32 s55, s69, 128
  s_and_b32 s55, s55, 255
  s_or_b32 s55, s55, 256
  s_add_u32 m0, s60, 57344
  s_mul_i32 s62, s55, 1536
  buffer_load_dwordx4 v92, s[28:31], s62 offen offset:0 lds
  buffer_load_dwordx4 v93, s[28:31], s62 offen offset:1024 lds
  s_waitcnt vmcnt(8)
  s_barrier
  s_or_b32 s55, s69, 512
  s_add_u32 m0, s60, 65536
  s_mul_i32 s62, s55, 1536
  buffer_load_dwordx4 v92, s[28:31], s62 offen offset:0 lds
  buffer_load_dwordx4 v93, s[28:31], s62 offen offset:1024 lds
  s_add_u32 s55, s69, 128
  s_and_b32 s55, s55, 255
  s_or_b32 s55, s55, 512
  s_add_u32 m0, s60, 73728
  s_mul_i32 s62, s55, 1536
  buffer_load_dwordx4 v92, s[28:31], s62 offen offset:0 lds
  buffer_load_dwordx4 v93, s[28:31], s62 offen offset:1024 lds
  s_or_b32 s55, s69, 768
  s_add_u32 m0, s60, 114688
  s_mul_i32 s62, s55, 1536
  buffer_load_dwordx4 v92, s[28:31], s62 offen offset:0 lds
  buffer_load_dwordx4 v93, s[28:31], s62 offen offset:1024 lds
  s_add_u32 s55, s69, 128
  s_and_b32 s55, s55, 255
  s_or_b32 s55, s55, 768
  s_add_u32 m0, s60, 122880
  s_mul_i32 s62, s55, 1536
  buffer_load_dwordx4 v92, s[28:31], s62 offen offset:0 lds
  buffer_load_dwordx4 v93, s[28:31], s62 offen offset:1024 lds
  v_cmp_eq_u32 vcc, 0, v118
  s_cbranch_vccnz L_slow_QL_nonce
L_back_QL_nonce:
  s_waitcnt vmcnt(12)
  s_barrier
  s_add_u32 m0, s60, 0
  s_mov_b32 s63, s9
  s_lshl3_add_u32 s63, s63, 0
  buffer_load_dwordx4 v96, s[36:39], s63 offen offset:0 lds
  buffer_load_dwordx4 v97, s[36:39], s63 offen offset:1024 lds
  s_add_u32 m0, s60, 8192
  s_mov_b32 s63, s18
  s_lshl3_add_u32 s63, s63, 0
  buffer_load_dwordx4 v96, s[36:39], s63 offen offset:0 lds
  buffer_load_dwordx4 v97, s[36:39], s63 offen offset:1024 lds
  s_add_u32 m0, s60, 16384
  s_mov_b32 s63, s19
  s_lshl3_add_u32 s63, s63, 0
  buffer_load_dwordx4 v96, s[36:39], s63 offen offset:0 lds
  buffer_load_dwordx4 v97, s[36:39], s63 offen offset:1024 lds
  s_add_u32 m0, s60, 24576
  s_mov_b32 s63, s22
  s_lshl3_add_u32 s63, s63, 0
  buffer_load_dwordx4 v96, s[36:39], s63 offen offset:0 lds
  buffer_load_dwordx4 v97, s[36:39], s63 offen offset:1024 lds
  s_waitcnt vmcnt(16)
  s_barrier
  s_add_u32 m0, s60, 32768
  s_mov_b32 s63, s9
  s_lshl3_add_u32 s63, s63, 262144
  buffer_load_dwordx4 v96, s[36:39], s63 offen offset:0 lds
  buffer_load_dwordx4 v97, s[36:39], s63 offen offset:1024 lds
  s_add_u32 m0, s60, 81920
  s_mov_b32 s63, s18
  s_lshl3_add_u32 s63, s63, 262144
  buffer_load_dwordx4 v96, s[36:39], s63 offen offset:0 lds
  buffer_load_dwordx4 v97, s[36:39], s63 offen offset:1024 lds
  s_add_u32 m0, s60, 90112
  s_mov_b32 s63, s19
  s_lshl3_add_u32 s63, s63, 262144
  buffer_load_dwordx4 v96, s[36:39], s63 offen offset:0 lds
  buffer_load_dwordx4 v97, s[36:39], s63 offen offset:1024 lds
  s_add_u32 m0, s60, 98304
  s_mov_b32 s63, s22
  s_lshl3_add_u32 s63, s63, 262144
  buffer_load_dwordx4 v96, s[36:39], s63 offen offset:0 lds
  buffer_load_dwordx4 v97, s[36:39], s63 offen offset:1024 lds
  s_waitcnt vmcnt(20)
  s_barrier
  s_add_u32 m0, s60, 40960
  s_mov_b32 s63, s9
  s_lshl3_add_u32 s63, s63, 524288
  buffer_load_dwordx4 v96, s[36:39], s63 offen offset:0 lds
  buffer_load_dwordx4 v97, s[36:39], s63 offen offset:1024 lds
  s_add_u32 m0, s60, 49152
  s_mov_b32 s63, s18
  s_lshl3_add_u32 s63, s63, 524288
  buffer_load_dwordx4 v96, s[36:39], s63 offen offset:0 lds
  buffer_load_dwordx4 v97, s[36:39], s63 offen offset:1024 lds
  s_add_u32 m0, s60, 106496
  s_mov_b32 s63, s19
  s_lshl3_add_u32 s63, s63, 524288
  buffer_load_dwordx4 v96, s[36:39], s63 offen offset:0 lds
  buffer_load_dwordx4 v97, s[36:39], s63 offen offset:1024 lds
  s_add_u32 m0, s60, 131072
  s_mov_b32 s63, s22
  s_lshl3_add_u32 s63, s63, 524288
  buffer_load_dwordx4 v96, s[36:39], s63 offen offset:0 lds
  buffer_load_dwordx4 v97, s[36:39], s63 offen offset:1024 lds
  s_waitcnt vmcnt(24)
  s_barrier
  buffer_load_dword v119, v100, s[44:47], 0 offen sc1
  s_waitcnt vmcnt(0)
  v_cmp_ne_u32 vcc, v119, v118
  s_cbranch_vccnz L_slow_QL_hq
L_back_QL_hq:
  s_cmp_lg_u32 s52, 0
  s_cbranch_scc1 L_post_QL_hq
  ds_write_b32 v104, v118 offset:0
L_post_QL_hq:
  s_add_u32 m0, s60, 57344
  s_mov_b32 s64, s9
  s_add_u32 s64, s64, s67
  buffer_load_dwordx4 v98, s[44:47], s64 offen offset:0 sc1 lds
  buffer_load_dwordx4 v98, s[44:47], s64 offen offset:1024 sc1 lds
  s_add_u32 m0, s60, 65536
  s_mov_b32 s64, s18
  s_add_u32 s64, s64, s67
  buffer_load_dwordx4 v98, s[44:47], s64 offen offset:0 sc1 lds
  buffer_load_dwordx4 v98, s[44:47], s64 offen offset:1024 sc1 lds
  s_add_u32 m0, s60, 139264
  s_mov_b32 s64, s19
  s_add_u32 s64, s64, s67
  buffer_load_dwordx4 v98, s[44:47], s64 offen offset:0 sc1 lds
  buffer_load_dwordx4 v98, s[44:47], s64 offen offset:1024 sc1 lds
  s_add_u32 m0, s60, 147456
  s_mov_b32 s63, s9
  s_lshl3_add_u32 s63, s63, 786432
  buffer_load_dwordx4 v96, s[36:39], s63 offen offset:0 lds
  buffer_load_dwordx4 v97, s[36:39], s63 offen offset:1024 lds
  s_waitcnt vmcnt(6)
  s_barrier
  s_lshl_b32 s6, s54, 2
  s_add_u32 s6, s6, s52
  s_lshl_b32 s7, s6, 14
  s_add_u32 s7, s7, 9437184
  s_lshl_b32 s6, s6, 10
  s_add_u32 s6, s6, 9961472
  buffer_load_dwordx4 v[84:87], v88, s[44:47], s6 offen sc1
  s_add_u32 s5, s53, 0
  s_and_b32 s5, s5, 3
  s_lshl_b32 s5, s5, 12
  s_add_u32 s5, s5, s7
  buffer_load_dwordx4 v[20:23], v88, s[44:47], s5 offen offset:0 sc1
  buffer_load_dwordx4 v[24:27], v88, s[44:47], s5 offen offset:1024 sc1
  buffer_load_dwordx4 v[28:31], v88, s[44:47], s5 offen offset:2048 sc1
  buffer_load_dwordx4 v[32:35], v88, s[44:47], s5 offen offset:3072 sc1
  s_add_u32 s5, s53, 1
  s_and_b32 s5, s5, 3
  s_lshl_b32 s5, s5, 12
  s_add_u32 s5, s5, s7
  buffer_load_dwordx4 v[36:39], v88, s[44:47], s5 offen offset:0 sc1
  buffer_load_dwordx4 v[40:43], v88, s[44:47], s5 offen offset:1024 sc1
  buffer_load_dwordx4 v[44:47], v88, s[44:47], s5 offen offset:2048 sc1
  buffer_load_dwordx4 v[48:51], v88, s[44:47], s5 offen offset:3072 sc1
  s_add_u32 s5, s53, 2
  s_and_b32 s5, s5, 3
  s_lshl_b32 s5, s5, 12
  s_add_u32 s5, s5, s7
  buffer_load_dwordx4 v[52:55], v88, s[44:47], s5 offen offset:0 sc1
  buffer_load_dwordx4 v[56:59], v88, s[44:47], s5 offen offset:1024 sc1
  buffer_load_dwordx4 v[60:63], v88, s[44:47], s5 offen offset:2048 sc1
  buffer_load_dwordx4 v[64:67], v88, s[44:47], s5 offen offset:3072 sc1
  s_add_u32 s5, s53, 3
  s_and_b32 s5, s5, 3
  s_lshl_b32 s5, s5, 12
  s_add_u32 s5, s5, s7
  buffer_load_dwordx4 v[68:71], v88, s[44:47], s5 offen offset:0 sc1
  buffer_load_dwordx4 v[72:75], v88, s[44:47], s5 offen offset:1024 sc1
  buffer_load_dwordx4 v[76:79], v88, s[44:47], s5 offen offset:2048 sc1
  buffer_load_dwordx4 v[80:83], v88, s[44:47], s5 offen offset:3072 sc1
  s_add_u32 m0, s60, 73728
  s_mov_b32 s64, s22
  s_add_u32 s64, s64, s67
  buffer_load_dwordx4 v98, s[44:47], s64 offen offset:0 sc1 lds
  buffer_load_dwordx4 v98, s[44:47], s64 offen offset:1024 sc1 lds
  s_waitcnt vmcnt(23)
  s_barrier
  s_add_u32 m0, s60, 114688
  s_mov_b32 s64, s9
  s_add_u32 s64, s64, s67
  s_add_u32 s64, s64, 32768
  buffer_load_dwordx4 v98, s[44:47], s64 offen offset:0 sc1 lds
  buffer_load_dwordx4 v98, s[44:47], s64 offen offset:1024 sc1 lds
  s_add_u32 m0, s60, 122880
  s_mov_b32 s63, s18
  s_lshl3_add_u32 s63, s63, 786432
  buffer_load_dwordx4 v96, s[36:39], s63 offen offset:0 lds
  s_waitcnt vmcnt(21)
  v_add_f32_dpp v84, v84, v84 row_ror:4 row_mask:0xf bank_mask:0xf
  v_add_f32_dpp v85, v85, v85 row_ror:4 row_mask:0xf bank_mask:0xf
  v_add_f32_dpp v86, v86, v86 row_ror:4 row_mask:0xf bank_mask:0xf
  v_add_f32_dpp v87, v87, v87 row_ror:4 row_mask:0xf bank_mask:0xf
  v_add_f32_dpp v84, v84, v84 row_ror:8 row_mask:0xf bank_mask:0xf
  v_add_f32_dpp v85, v85, v85 row_ror:8 row_mask:0xf bank_mask:0xf
  v_add_f32_dpp v86, v86, v86 row_ror:8 row_mask:0xf bank_mask:0xf
  v_add_f32_dpp v87, v87, v87 row_ror:8 row_mask:0xf bank_mask:0xf
  v_mov_b32 v108, v84
  v_mov_b32 v109, v85
  v_mov_b32 v110, v86
  v_mov_b32 v111, v87
  v_permlane16_swap_b32 v108, v84
  v_permlane16_swap_b32 v109, v85
  v_permlane16_swap_b32 v110, v86
  v_permlane16_swap_b32 v111, v87
  v_add_f32 v84, v84, v108
  v_add_f32 v85, v85, v109
  v_add_f32 v86, v86, v110
  buffer_load_dwordx4 v97, s[36:39], s63 offen offset:1024 lds
  v_add_f32 v87, v87, v111
  v_mov_b32 v108, v84
  v_mov_b32 v109, v85
  v_mov_b32 v110, v86
  v_mov_b32 v111, v87
  v_permlane32_swap_b32 v108, v84
  v_permlane32_swap_b32 v109, v85
  v_permlane32_swap_b32 v110, v86
  v_permlane32_swap_b32 v111, v87
  v_add_f32 v84, v84, v108
  v_add_f32 v85, v85, v109
  v_add_f32 v86, v86, v110
  v_add_f32 v87, v87, v111
  v_cvt_pk_bf16_f32 v108, v84, v85
  v_cvt_pk_bf16_f32 v109, v86, v87
  s_mov_b64 exec, 15
  ds_write_b64 v105, v[108:109] offset:512
  s_mov_b64 exec, -1
  s_waitcnt vmcnt(20)
  v_pk_add_f32 v[20:21], v[20:21], v[24:25]
  v_pk_add_f32 v[22:23], v[22:23], v[26:27]
  s_waitcnt vmcnt(18)
  v_pk_add_f32 v[28:29], v[28:29], v[32:33]
  v_pk_add_f32 v[30:31], v[30:31], v[34:35]
  v_pk_add_f32 v[20:21], v[20:21], v[28:29]
  v_pk_add_f32 v[22:23], v[22:23], v[30:31]
  s_waitcnt vmcnt(16)
  v_pk_add_f32 v[36:37], v[36:37], v[40:41]
  v_pk_add_f32 v[38:39], v[38:39], v[42:43]
  v_pk_add_f32 v[20:21], v[20:21], v[36:37]
  v_pk_add_f32 v[22:23], v[22:23], v[38:39]
  s_waitcnt vmcnt(14)
  v_pk_add_f32 v[44:45], v[44:45], v[48:49]
  v_pk_add_f32 v[46:47], v[46:47], v[50:51]
  v_pk_add_f32 v[20:21], v[20:21], v[44:45]
  v_pk_add_f32 v[22:23], v[22:23], v[46:47]
  s_waitcnt vmcnt(12)
  v_pk_add_f32 v[52:53], v[52:53], v[56:57]
  v_pk_add_f32 v[54:55], v[54:55], v[58:59]
  v_pk_add_f32 v[20:21], v[20:21], v[52:53]
  v_pk_add_f32 v[22:23], v[22:23], v[54:55]
  s_waitcnt vmcnt(10)
  v_pk_add_f32 v[60:61], v[60:61], v[64:65]
  v_pk_add_f32 v[62:63], v[62:63], v[66:67]
  v_pk_add_f32 v[20:21], v[20:21], v[60:61]
  v_pk_add_f32 v[22:23], v[22:23], v[62:63]
  s_waitcnt vmcnt(8)
  v_pk_add_f32 v[68:69], v[68:69], v[72:73]
  v_pk_add_f32 v[70:71], v[70:71], v[74:75]
  v_pk_add_f32 v[20:21], v[20:21], v[68:69]
  s_barrier
  s_add_u32 m0, s60, 0
  s_mov_b32 s64, s18
  s_add_u32 s64, s64, s67
  s_add_u32 s64, s64, 32768
  buffer_load_dwordx4 v98, s[44:47], s64 offen offset:0 sc1 lds
  v_pk_add_f32 v[22:23], v[22:23], v[70:71]
  s_waitcnt vmcnt(7)
  v_pk_add_f32 v[76:77], v[76:77], v[80:81]
  v_pk_add_f32 v[78:79], v[78:79], v[82:83]
  v_pk_add_f32 v[20:21], v[20:21], v[76:77]
  v_pk_add_f32 v[22:23], v[22:23], v[78:79]
  v_cvt_pk_bf16_f32 v110, v20, v21
  v_cvt_pk_bf16_f32 v111, v22, v23
  ds_write_b64 v105, v[110:111]
  buffer_load_dwordx4 v98, s[44:47], s64 offen offset:1024 sc1 lds
  s_add_u32 m0, s60, 57344
  s_mov_b32 s63, s19
  s_lshl3_add_u32 s63, s63, 786432
  buffer_load_dwordx4 v96, s[36:39], s63 offen offset:0 lds
  buffer_load_dwordx4 v97, s[36:39], s63 offen offset:1024 lds
  s_waitcnt vmcnt(8)
  s_waitcnt lgkmcnt(0)
  s_barrier
  s_add_u32 m0, s60, 8192
  s_mov_b32 s64, s19
  s_add_u32 s64, s64, s67
  s_add_u32 s64, s64, 32768
  buffer_load_dwordx4 v98, s[44:47], s64 offen offset:0 sc1 lds
  buffer_load_dwordx4 v98, s[44:47], s64 offen offset:1024 sc1 lds
  s_add_u32 m0, s60, 65536
  s_mov_b32 s63, s22
  s_lshl3_add_u32 s63, s63, 786432
  buffer_load_dwordx4 v96, s[36:39], s63 offen offset:0 lds
  buffer_load_dwordx4 v97, s[36:39], s63 offen offset:1024 lds
  s_waitcnt vmcnt(10)
  s_barrier
  s_add_u32 m0, s60, 16384
  s_mov_b32 s64, s22
  s_add_u32 s64, s64, s67
  s_add_u32 s64, s64, 32768
  buffer_load_dwordx4 v98, s[44:47], s64 offen offset:0 sc1 lds
  buffer_load_dwordx4 v98, s[44:47], s64 offen offset:1024 sc1 lds
  s_add_u32 m0, s60, 139264
  s_mov_b32 s63, s9
  s_lshl3_add_u32 s63, s63, 1048576
  buffer_load_dwordx4 v96, s[36:39], s63 offen offset:0 lds
  buffer_load_dwordx4 v97, s[36:39], s63 offen offset:1024 lds
  s_waitcnt vmcnt(10)
  s_barrier
  s_add_u32 m0, s60, 24576
  s_mov_b32 s64, s9
  s_add_u32 s64, s64, s67
  s_add_u32 s64, s64, 65536
  buffer_load_dwordx4 v98, s[44:47], s64 offen offset:0 sc1 lds
  buffer_load_dwordx4 v98, s[44:47], s64 offen offset:1024 sc1 lds
  s_add_u32 m0, s60, 73728
  s_mov_b32 s63, s18
  s_lshl3_add_u32 s63, s63, 1048576
  buffer_load_dwordx4 v96, s[36:39], s63 offen offset:0 lds
  buffer_load_dwordx4 v97, s[36:39], s63 offen offset:1024 lds
  s_waitcnt vmcnt(10)
  s_barrier
  s_add_u32 m0, s60, 32768
  s_mov_b32 s64, s18
  s_add_u32 s64, s64, s67
  s_add_u32 s64, s64, 65536
  buffer_load_dwordx4 v98, s[44:47], s64 offen offset:0 sc1 lds
  buffer_load_dwordx4 v98, s[44:47], s64 offen offset:1024 sc1 lds
  s_waitcnt vmcnt(8)
  s_barrier
  s_add_u32 m0, s60, 0
  s_mov_b32 s64, s19
  s_add_u32 s64, s64, s67
  s_add_u32 s64, s64, 65536
  buffer_load_dwordx4 v98, s[44:47], s64 offen offset:0 sc1 lds
  buffer_load_dwordx4 v98, s[44:47], s64 offen offset:1024 sc1 lds
  s_add_u32 m0, s60, 81920
  s_mov_b32 s63, s19
  s_lshl3_add_u32 s63, s63, 1048576
  buffer_load_dwordx4 v96, s[36:39], s63 offen offset:0 lds
  buffer_load_dwordx4 v97, s[36:39], s63 offen offset:1024 lds
  s_waitcnt vmcnt(8)
  s_barrier
  s_add_u32 m0, s60, 8192
  s_mov_b32 s64, s22
  s_add_u32 s64, s64, s67
  s_add_u32 s64, s64, 65536
  buffer_load_dwordx4 v98, s[44:47], s64 offen offset:0 sc1 lds
  buffer_load_dwordx4 v98, s[44:47], s64 offen offset:1024 sc1 lds
  s_add_u32 m0, s60, 90112
  s_mov_b32 s63, s22
  s_lshl3_add_u32 s63, s63, 1048576
  buffer_load_dwordx4 v96, s[36:39], s63 offen offset:0 lds
  buffer_load_dwordx4 v97, s[36:39], s63 offen offset:1024 lds
  s_waitcnt vmcnt(8)
  s_barrier
  s_add_u32 m0, s60, 16384
  s_mov_b32 s64, s9
  s_add_u32 s64, s64, s67
  s_add_u32 s64, s64, 98304
  buffer_load_dwordx4 v98, s[44:47], s64 offen offset:0 sc1 lds
  buffer_load_dwordx4 v98, s[44:47], s64 offen offset:1024 sc1 lds
  s_add_u32 m0, s60, 98304
  s_mov_b32 s63, s9
  s_lshl3_add_u32 s63, s63, 1310720
  buffer_load_dwordx4 v96, s[36:39], s63 offen offset:0 lds
  buffer_load_dwordx4 v97, s[36:39], s63 offen offset:1024 lds
  s_waitcnt vmcnt(10)
  s_barrier
  s_add_u32 m0, s60, 24576
  s_mov_b32 s64, s18
  s_add_u32 s64, s64, s67
  s_add_u32 s64, s64, 98304
  buffer_load_dwordx4 v98, s[44:47], s64 offen offset:0 sc1 lds
  buffer_load_dwordx4 v98, s[44:47], s64 offen offset:1024 sc1 lds
  s_waitcnt vmcnt(8)
  s_barrier
  s_add_u32 m0, s60, 32768
  s_mov_b32 s64, s19
  s_add_u32 s64, s64, s67
  s_add_u32 s64, s64, 98304
  buffer_load_dwordx4 v98, s[44:47], s64 offen offset:0 sc1 lds
  buffer_load_dwordx4 v98, s[44:47], s64 offen offset:1024 sc1 lds
  s_add_u32 m0, s60, 40960
  s_mov_b32 s63, s18
  s_lshl3_add_u32 s63, s63, 1310720
  buffer_load_dwordx4 v96, s[36:39], s63 offen offset:0 lds
  buffer_load_dwordx4 v97, s[36:39], s63 offen offset:1024 lds
  s_waitcnt vmcnt(8)
  s_barrier
  s_add_u32 m0, s60, 0
  s_mov_b32 s64, s22
  s_add_u32 s64, s64, s67
  s_add_u32 s64, s64, 98304
  buffer_load_dwordx4 v98, s[44:47], s64 offen offset:0 sc1 lds
  buffer_load_dwordx4 v98, s[44:47], s64 offen offset:1024 sc1 lds
  s_add_u32 m0, s60, 49152
  s_mov_b32 s63, s19
  s_lshl3_add_u32 s63, s63, 1310720
  buffer_load_dwordx4 v96, s[36:39], s63 offen offset:0 lds
  buffer_load_dwordx4 v97, s[36:39], s63 offen offset:1024 lds
  s_waitcnt vmcnt(8)
  s_barrier
  s_add_u32 m0, s60, 8192
  s_mov_b32 s64, s9
  s_add_u32 s64, s64, s67
  s_add_u32 s64, s64, 131072
  buffer_load_dwordx4 v98, s[44:47], s64 offen offset:0 sc1 lds
  buffer_load_dwordx4 v98, s[44:47], s64 offen offset:1024 sc1 lds
  s_add_u32 m0, s60, 106496
  s_mov_b32 s63, s22
  s_lshl3_add_u32 s63, s63, 1310720
  buffer_load_dwordx4 v96, s[36:39], s63 offen offset:0 lds
  buffer_load_dwordx4 v97, s[36:39], s63 offen offset:1024 lds
  s_waitcnt vmcnt(10)
  s_barrier
  s_add_u32 m0, s60, 16384
  s_mov_b32 s64, s18
  s_add_u32 s64, s64, s67
  s_add_u32 s64, s64, 131072
  buffer_load_dwordx4 v98, s[44:47], s64 offen offset:0 sc1 lds
  buffer_load_dwordx4 v98, s[44:47], s64 offen offset:1024 sc1 lds
  s_add_u32 m0, s60, 114688
  s_mov_b32 s63, s9
  s_lshl3_add_u32 s63, s63, 1572864
  buffer_load_dwordx4 v96, s[36:39], s63 offen offset:0 lds
  buffer_load_dwordx4 v97, s[36:39], s63 offen offset:1024 lds
  s_waitcnt vmcnt(10)
  s_barrier
  s_add_u32 m0, s60, 24576
  s_mov_b32 s64, s19
  s_add_u32 s64, s64, s67
  s_add_u32 s64, s64, 131072
  buffer_load_dwordx4 v98, s[44:47], s64 offen offset:0 sc1 lds
  buffer_load_dwordx4 v98, s[44:47], s64 offen offset:1024 sc1 lds
  s_waitcnt vmcnt(8)
  s_barrier
  s_add_u32 m0, s60, 32768
  s_mov_b32 s64, s22
  s_add_u32 s64, s64, s67
  s_add_u32 s64, s64, 131072
  buffer_load_dwordx4 v98, s[44:47], s64 offen offset:0 sc1 lds
  buffer_load_dwordx4 v98, s[44:47], s64 offen offset:1024 sc1 lds
  s_add_u32 m0, s60, 57344
  s_mov_b32 s63, s18
  s_lshl3_add_u32 s63, s63, 1572864
  buffer_load_dwordx4 v96, s[36:39], s63 offen offset:0 lds
  buffer_load_dwordx4 v97, s[36:39], s63 offen offset:1024 lds
  s_waitcnt vmcnt(8)
  s_barrier
  s_add_u32 m0, s60, 0
  s_mov_b32 s64, s9
  s_add_u32 s64, s64, s67
  s_add_u32 s64, s64, 163840
  buffer_load_dwordx4 v98, s[44:47], s64 offen offset:0 sc1 lds
  buffer_load_dwordx4 v98, s[44:47], s64 offen offset:1024 sc1 lds
  s_add_u32 m0, s60, 65536
  s_mov_b32 s63, s19
  s_lshl3_add_u32 s63, s63, 1572864
  buffer_load_dwordx4 v96, s[36:39], s63 offen offset:0 lds
  buffer_load_dwordx4 v97, s[36:39], s63 offen offset:1024 lds
  s_waitcnt vmcnt(8)
  s_barrier
  s_add_u32 m0, s60, 8192
  s_mov_b32 s64, s18
  s_add_u32 s64, s64, s67
  s_add_u32 s64, s64, 163840
  buffer_load_dwordx4 v98, s[44:47], s64 offen offset:0 sc1 lds
  buffer_load_dwordx4 v98, s[44:47], s64 offen offset:1024 sc1 lds
  s_add_u32 m0, s60, 122880
  s_mov_b32 s63, s22
  s_lshl3_add_u32 s63, s63, 1572864
  buffer_load_dwordx4 v96, s[36:39], s63 offen offset:0 lds
  buffer_load_dwordx4 v97, s[36:39], s63 offen offset:1024 lds
  s_waitcnt vmcnt(10)
  s_barrier
  s_add_u32 m0, s60, 16384
  s_mov_b32 s64, s19
  s_add_u32 s64, s64, s67
  s_add_u32 s64, s64, 163840
  buffer_load_dwordx4 v98, s[44:47], s64 offen offset:0 sc1 lds
  buffer_load_dwordx4 v98, s[44:47], s64 offen offset:1024 sc1 lds
  s_waitcnt vmcnt(8)
  s_barrier
  s_add_u32 m0, s60, 24576
  s_mov_b32 s64, s22
  s_add_u32 s64, s64, s67
  s_add_u32 s64, s64, 163840
  buffer_load_dwordx4 v98, s[44:47], s64 offen offset:0 sc1 lds
  buffer_load_dwordx4 v98, s[44:47], s64 offen offset:1024 sc1 lds
  s_add_u32 m0, s60, 73728
  s_mov_b32 s63, s9
  s_lshl3_add_u32 s63, s63, 0
  buffer_load_dwordx4 v96, s[40:43], s63 offen offset:0 lds
  buffer_load_dwordx4 v97, s[40:43], s63 offen offset:1024 lds
  s_waitcnt vmcnt(8)
  s_barrier
  s_add_u32 m0, s60, 32768
  s_mov_b32 s64, s9
  s_add_u32 s64, s64, s67
  s_add_u32 s64, s64, 196608
  buffer_load_dwordx4 v98, s[44:47], s64 offen offset:0 sc1 lds
  buffer_load_dwordx4 v98, s[44:47], s64 offen offset:1024 sc1 lds
  s_add_u32 m0, s60, 81920
  s_mov_b32 s63, s18
  s_lshl3_add_u32 s63, s63, 0
  buffer_load_dwordx4 v96, s[40:43], s63 offen offset:0 lds
  buffer_load_dwordx4 v97, s[40:43], s63 offen offset:1024 lds
  s_waitcnt vmcnt(8)
  s_barrier
  s_add_u32 m0, s60, 0
  s_mov_b32 s64, s18
  s_add_u32 s64, s64, s67
  s_add_u32 s64, s64, 196608
  buffer_load_dwordx4 v98, s[44:47], s64 offen offset:0 sc1 lds
  buffer_load_dwordx4 v98, s[44:47], s64 offen offset:1024 sc1 lds
  s_add_u32 m0, s60, 90112
  s_mov_b32 s63, s19
  s_lshl3_add_u32 s63, s63, 0
  buffer_load_dwordx4 v96, s[40:43], s63 offen offset:0 lds
  buffer_load_dwordx4 v97, s[40:43], s63 offen offset:1024 lds
  s_waitcnt vmcnt(10)
  s_barrier
  s_add_u32 m0, s60, 8192
  s_mov_b32 s64, s19
  s_add_u32 s64, s64, s67
  s_add_u32 s64, s64, 196608
  buffer_load_dwordx4 v98, s[44:47], s64 offen offset:0 sc1 lds
  buffer_load_dwordx4 v98, s[44:47], s64 offen offset:1024 sc1 lds
  s_waitcnt vmcnt(8)
  s_barrier
  s_add_u32 m0, s60, 16384
  s_mov_b32 s64, s22
  s_add_u32 s64, s64, s67
  s_add_u32 s64, s64, 196608
  buffer_load_dwordx4 v98, s[44:47], s64 offen offset:0 sc1 lds
  buffer_load_dwordx4 v98, s[44:47], s64 offen offset:1024 sc1 lds
  s_add_u32 m0, s60, 40960
  s_mov_b32 s64, s9
  s_add_u32 s64, s64, s67
  s_add_u32 s64, s64, 229376
  buffer_load_dwordx4 v98, s[44:47], s64 offen offset:0 sc1 lds
  buffer_load_dwordx4 v98, s[44:47], s64 offen offset:1024 sc1 lds
  s_add_u32 m0, s60, 49152
  s_mov_b32 s64, s18
  s_add_u32 s64, s64, s67
  s_add_u32 s64, s64, 229376
  buffer_load_dwordx4 v98, s[44:47], s64 offen offset:0 sc1 lds
  buffer_load_dwordx4 v98, s[44:47], s64 offen offset:1024 sc1 lds
  s_add_u32 m0, s60, 98304
  s_mov_b32 s64, s19
  s_add_u32 s64, s64, s67
  s_add_u32 s64, s64, 229376
  buffer_load_dwordx4 v98, s[44:47], s64 offen offset:0 sc1 lds
  buffer_load_dwordx4 v98, s[44:47], s64 offen offset:1024 sc1 lds
  s_add_u32 m0, s60, 131072
  s_mov_b32 s63, s22
  s_lshl3_add_u32 s63, s63, 0
  buffer_load_dwordx4 v96, s[40:43], s63 offen offset:0 lds
  buffer_load_dwordx4 v97, s[40:43], s63 offen offset:1024 lds
  s_waitcnt vmcnt(14)
  s_barrier
  s_add_u32 m0, s60, 24576
  s_mov_b32 s64, s22
  s_add_u32 s64, s64, s67
  s_add_u32 s64, s64, 229376
  buffer_load_dwordx4 v98, s[44:47], s64 offen offset:0 sc1 lds
  buffer_load_dwordx4 v98, s[44:47], s64 offen offset:1024 sc1 lds
  s_add_u32 m0, s60, 106496
  s_mov_b32 s63, s9
  s_lshl3_add_u32 s63, s63, 262144
  buffer_load_dwordx4 v96, s[40:43], s63 offen offset:0 lds
  buffer_load_dwordx4 v97, s[40:43], s63 offen offset:1024 lds
  s_waitcnt vmcnt(14)
  s_barrier
  s_add_u32 m0, s60, 32768
  s_mov_b32 s64, s9
  s_add_u32 s64, s64, s67
  s_add_u32 s64, s64, 262144
  buffer_load_dwordx4 v98, s[44:47], s64 offen offset:0 sc1 lds
  buffer_load_dwordx4 v98, s[44:47], s64 offen offset:1024 sc1 lds
  s_add_u32 m0, s60, 114688
  s_mov_b32 s63, s18
  s_lshl3_add_u32 s63, s63, 262144
  buffer_load_dwordx4 v96, s[40:43], s63 offen offset:0 lds
  buffer_load_dwordx4 v97, s[40:43], s63 offen offset:1024 lds
  s_waitcnt vmcnt(16)
  s_barrier
  s_add_u32 m0, s60, 0
  s_mov_b32 s64, s18
  s_add_u32 s64, s64, s67
  s_add_u32 s64, s64, 262144
  buffer_load_dwordx4 v98, s[44:47], s64 offen offset:0 sc1 lds
  buffer_load_dwordx4 v98, s[44:47], s64 offen offset:1024 sc1 lds
  s_waitcnt vmcnt(16)
  s_barrier
  s_add_u32 m0, s60, 8192
  s_mov_b32 s64, s19
  s_add_u32 s64, s64, s67
  s_add_u32 s64, s64, 262144
  buffer_load_dwordx4 v98, s[44:47], s64 offen offset:0 sc1 lds
  buffer_load_dwordx4 v98, s[44:47], s64 offen offset:1024 sc1 lds
  s_add_u32 m0, s60, 57344
  s_mov_b32 s63, s19
  s_lshl3_add_u32 s63, s63, 262144
  buffer_load_dwordx4 v96, s[40:43], s63 offen offset:0 lds
  buffer_load_dwordx4 v97, s[40:43], s63 offen offset:1024 lds
  s_waitcnt vmcnt(18)
  s_barrier
  s_add_u32 m0, s60, 16384
  s_mov_b32 s64, s22
  s_add_u32 s64, s64, s67
  s_add_u32 s64, s64, 262144
  buffer_load_dwordx4 v98, s[44:47], s64 offen offset:0 sc1 lds
  buffer_load_dwordx4 v98, s[44:47], s64 offen offset:1024 sc1 lds
  s_add_u32 m0, s60, 65536
  s_mov_b32 s63, s22
  s_lshl3_add_u32 s63, s63, 262144
  buffer_load_dwordx4 v96, s[40:43], s63 offen offset:0 lds
  buffer_load_dwordx4 v97, s[40:43], s63 offen offset:1024 lds
  s_waitcnt vmcnt(20)
  s_barrier
  s_waitcnt vmcnt(16)
  s_barrier
  s_waitcnt vmcnt(12)
  s_barrier
  s_waitcnt vmcnt(8)
  s_barrier
  s_waitcnt vmcnt(4)
  s_barrier
  s_waitcnt vmcnt(0)
  s_barrier
  s_endpgm
L_slow_QL_nonce:
  s_mov_b32 s68, 1000000
L_spin_QL_nonce:
  s_sleep 4
  global_load_dword v118, v89, s[20:21] sc1
  s_waitcnt vmcnt(0)
  v_cmp_eq_u32 vcc, 0, v118
  s_cbranch_vccz L_back_QL_nonce
  s_sub_u32 s68, s68, 1
  s_cmp_lg_u32 s68, 0
  s_cbranch_scc1 L_spin_QL_nonce
  s_branch L_back_QL_nonce
L_slow_QL_hq:
  s_mov_b32 s68, 1000000
  s_cmp_lg_u32 s52, 0
  s_cbranch_scc1 L_lds0_QL_hq
L_spin_QL_hq:
  s_sleep 4
  buffer_load_dword v119, v100, s[44:47], 0 offen sc1
  s_waitcnt vmcnt(0)
  v_cmp_ne_u32 vcc, v119, v118
  s_cbranch_vccz L_back_QL_hq
  s_sub_u32 s68, s68, 1
  s_cmp_lg_u32 s68, 0
  s_cbranch_scc1 L_spin_QL_hq
  s_branch L_back_QL_hq
L_lds0_QL_hq:
  s_lshl_b32 s68, s68, 3
L_lds_QL_hq:
  s_sleep 1
  ds_read_b32 v6, v104 offset:0
  s_waitcnt lgkmcnt(0)
  v_cmp_ne_u32 vcc, v6, v118
  s_cbranch_vccz L_post_QL_hq
  s_sub_u32 s68, s68, 1
  s_cmp_lg_u32 s68, 0
  s_cbranch_scc1 L_lds_QL_hq
  s_branch L_post_QL_hq
L_KVC:
  s_waitcnt lgkmcnt(0)
  s_mov_b32 s44, s22
  s_and_b32 s45, s23, 0xffff
  s_mov_b32 s46, 10354688
  s_mov_b32 s47, 0x20000
  s_mov_b32 s48, s18
  s_and_b32 s49, s19, 0xffff
  s_mov_b32 s50, 2097152
  s_mov_b32 s51, 0x20000
  v_lshlrev_b32 v103, 4, v1
  v_mov_b32 v104, 0
  v_lshrrev_b32 v102, 4, v1
  v_and_b32 v100, 15, v1
  v_lshlrev_b32 v101, 7, v100
  v_add_u32 v101, s59, v101
  v_lshrrev_b32 v100, 1, v100
  v_xor_b32 v100, v100, v102
  v_lshl_add_u32 v105, v100, 4, v101
  v_xor_b32 v106, 64, v105
  v_bfe_u32 v100, v1, 2, 2
  v_lshlrev_b32 v101, 7, v100
  v_lshrrev_b32 v100, 1, v100
  v_lshl_add_u32 v101, v100, 5, v101
  v_and_b32 v100, 3, v1
  v_lshl_add_u32 v101, v100, 3, v101
  v_and_b32 v100, 1, v102
  v_lshl_add_u32 v107, v100, 10, v101
  v_lshl_add_u32 v107, v100, 6, v107
  v_lshl_add_u32 v111, v100, 6, v101
  v_lshl_add_u32 v111, v102, 9, v111
  v_lshrrev_b32 v100, 1, v102
  v_lshl_add_u32 v107, v100, 12, v107
  v_xor_b32 v108, 32, v107
  v_xor_b32 v109, 64, v107
  v_xor_b32 v110, 96, v107
  s_lshr_b32 s62, s52, 1
  s_lshl_b32 s62, s62, 6
  v_xor_b32 v111, s62, v111
  v_xor_b32 v112, 32, v111
  s_and_b32 s62, s52, 1
  s_lshl_b32 s62, s62, 11
  v_add_u32 v113, s62, v103
  s_lshl_b32 s63, s53, 1
  s_lshr_b32 s64, s52, 1
  s_add_u32 s63, s63, s64
  s_mul_i32 s66, s63, 294912
  s_add_u32 s66, s66, s62
  s_mov_b32 s10, 0x3fb8aa3b
  s_mov_b32 s11, 0x3fb8aa3b
  s_mov_b32 s12, 0x358637bd
  s_mov_b32 s13, 0x3f803f80
  s_add_u32 s62, s59, 141312
  v_add_u32 v114, s62, v103
  s_barrier
  ds_read_b128 a[0:3], v105 offset:0
  ds_read_b64_tr_b16 v[68:69], v107 offset:16384
  ds_read_b128 a[4:7], v105 offset:2048
  ds_read_b64_tr_b16 v[70:71], v107 offset:16896
  ds_read_b64_tr_b16 v[72:73], v108 offset:16384
  ds_read_b64_tr_b16 v[74:75], v108 offset:16896
  ds_read_b64_tr_b16 v[76:77], v109 offset:16384
  ds_read_b64_tr_b16 v[78:79], v109 offset:16896
  ds_read_b64_tr_b16 v[80:81], v110 offset:16384
  ds_read_b64_tr_b16 v[82:83], v110 offset:16896
  ds_read_b64_tr_b16 v[84:85], v107 offset:18432
  ds_read_b64_tr_b16 v[86:87], v107 offset:18944
  s_waitcnt lgkmcnt(6)
  v_mfma_f32_16x16x32_bf16 v[4:7], a[0:3], v[68:71], 0
  ds_read_b64_tr_b16 v[88:89], v108 offset:18432
  v_mfma_f32_16x16x32_bf16 v[8:11], a[4:7], v[68:71], 0
  ds_read_b64_tr_b16 v[90:91], v108 offset:18944
  v_mfma_f32_16x16x32_bf16 v[12:15], a[0:3], v[72:75], 0
  ds_read_b64_tr_b16 v[92:93], v109 offset:18432
  v_mfma_f32_16x16x32_bf16 v[16:19], a[4:7], v[72:75], 0
  ds_read_b64_tr_b16 v[94:95], v109 offset:18944
  s_waitcnt lgkmcnt(6)
  v_mfma_f32_16x16x32_bf16 v[20:23], a[0:3], v[76:79], 0
  ds_read_b64_tr_b16 v[96:97], v110 offset:18432
  v_mfma_f32_16x16x32_bf16 v[24:27], a[4:7], v[76:79], 0
  ds_read_b64_tr_b16 v[98:99], v110 offset:18944
  v_mfma_f32_16x16x32_bf16 v[28:31], a[0:3], v[80:83], 0
  ds_read_b128 a[8:11], v106 offset:0
  ds_read_b64_tr_b16 v[68:69], v107 offset:24576
  v_mfma_f32_16x16x32_bf16 v[32:35], a[4:7], v[80:83], 0
  ds_read_b128 a[12:15], v106 offset:2048
  ds_read_b64_tr_b16 v[70:71], v107 offset:25088
  s_waitcnt lgkmcnt(8)
  v_mfma_f32_16x16x32_bf16 v[36:39], a[0:3], v[84:87], 0
  ds_read_b64_tr_b16 v[72:73], v108 offset:24576
  v_mfma_f32_16x16x32_bf16 v[40:43], a[4:7], v[84:87], 0
  ds_read_b64_tr_b16 v[74:75], v108 offset:25088
  v_mfma_f32_16x16x32_bf16 v[44:47], a[0:3], v[88:91], 0
  ds_read_b64_tr_b16 v[76:77], v109 offset:24576
  v_mfma_f32_16x16x32_bf16 v[48:51], a[4:7], v[88:91], 0
  ds_read_b64_tr_b16 v[78:79], v109 offset:25088
  s_waitcnt lgkmcnt(8)
  v_mfma_f32_16x16x32_bf16 v[52:55], a[0:3], v[92:95], 0
  ds_read_b64_tr_b16 v[80:81], v110 offset:24576
  v_mfma_f32_16x16x32_bf16 v[56:59], a[4:7], v[92:95], 0
  ds_read_b64_tr_b16 v[82:83], v110 offset:25088
  v_mfma_f32_16x16x32_bf16 v[60:63], a[0:3], v[96:99], 0
  ds_read_b64_tr_b16 v[84:85], v107 offset:26624
  v_mfma_f32_16x16x32_bf16 v[64:67], a[4:7], v[96:99], 0
  ds_read_b64_tr_b16 v[86:87], v107 offset:27136
  s_waitcnt lgkmcnt(6)
  v_mfma_f32_16x16x32_bf16 v[4:7], a[8:11], v[68:71], v[4:7]
  ds_read_b64_tr_b16 v[88:89], v108 offset:26624
  v_mfma_f32_16x16x32_bf16 v[8:11], a[12:15], v[68:71], v[8:11]
  ds_read_b64_tr_b16 v[90:91], v108 offset:27136
  v_mfma_f32_16x16x32_bf16 v[12:15], a[8:11], v[72:75], v[12:15]
  ds_read_b64_tr_b16 v[92:93], v109 offset:26624
  v_mfma_f32_16x16x32_bf16 v[16:19], a[12:15], v[72:75], v[16:19]
  ds_read_b64_tr_b16 v[94:95], v109 offset:27136
  s_waitcnt lgkmcnt(6)
  v_mfma_f32_16x16x32_bf16 v[20:23], a[8:11], v[76:79], v[20:23]
  ds_read_b64_tr_b16 v[96:97], v110 offset:26624
  v_mfma_f32_16x16x32_bf16 v[24:27], a[12:15], v[76:79], v[24:27]
  ds_read_b64_tr_b16 v[98:99], v110 offset:27136
  v_mfma_f32_16x16x32_bf16 v[28:31], a[8:11], v[80:83], v[28:31]
  s_barrier
  ds_read_b128 a[16:19], v105 offset:32768
  ds_read_b64_tr_b16 v[68:69], v107 offset:49152
  v_mfma_f32_16x16x32_bf16 v[32:35], a[12:15], v[80:83], v[32:35]
  ds_read_b128 a[20:23], v105 offset:34816
  ds_read_b64_tr_b16 v[70:71], v107 offset:49664
  s_waitcnt lgkmcnt(8)
  v_mfma_f32_16x16x32_bf16 v[36:39], a[8:11], v[84:87], v[36:39]
  ds_read_b64_tr_b16 v[72:73], v108 offset:49152
  v_mfma_f32_16x16x32_bf16 v[40:43], a[12:15], v[84:87], v[40:43]
  ds_read_b64_tr_b16 v[74:75], v108 offset:49664
  v_mfma_f32_16x16x32_bf16 v[44:47], a[8:11], v[88:91], v[44:47]
  ds_read_b64_tr_b16 v[76:77], v109 offset:49152
  v_mfma_f32_16x16x32_bf16 v[48:51], a[12:15], v[88:91], v[48:51]
  ds_read_b64_tr_b16 v[78:79], v109 offset:49664
  s_waitcnt lgkmcnt(8)
  v_mfma_f32_16x16x32_bf16 v[52:55], a[8:11], v[92:95], v[52:55]
  ds_read_b64_tr_b16 v[80:81], v110 offset:49152
  v_mfma_f32_16x16x32_bf16 v[56:59], a[12:15], v[92:95], v[56:59]
  ds_read_b64_tr_b16 v[82:83], v110 offset:49664
  v_mfma_f32_16x16x32_bf16 v[60:63], a[8:11], v[96:99], v[60:63]
  ds_read_b64_tr_b16 v[84:85], v107 offset:51200
  v_mfma_f32_16x16x32_bf16 v[64:67], a[12:15], v[96:99], v[64:67]
  ds_read_b64_tr_b16 v[86:87], v107 offset:51712
  s_waitcnt lgkmcnt(6)
  v_mfma_f32_16x16x32_bf16 v[4:7], a[16:19], v[68:71], v[4:7]
  ds_read_b64_tr_b16 v[88:89], v108 offset:51200
  v_mfma_f32_16x16x32_bf16 v[8:11], a[20:23], v[68:71], v[8:11]
  ds_read_b64_tr_b16 v[90:91], v108 offset:51712
  v_mfma_f32_16x16x32_bf16 v[12:15], a[16:19], v[72:75], v[12:15]
  ds_read_b64_tr_b16 v[92:93], v109 offset:51200
  v_mfma_f32_16x16x32_bf16 v[16:19], a[20:23], v[72:75], v[16:19]
  ds_read_b64_tr_b16 v[94:95], v109 offset:51712
  s_waitcnt lgkmcnt(6)
  v_mfma_f32_16x16x32_bf16 v[20:23], a[16:19], v[76:79], v[20:23]
  ds_read_b64_tr_b16 v[96:97], v110 offset:51200
  v_mfma_f32_16x16x32_bf16 v[24:27], a[20:23], v[76:79], v[24:27]
  ds_read_b64_tr_b16 v[98:99], v110 offset:51712
  v_mfma_f32_16x16x32_bf16 v[28:31], a[16:19], v[80:83], v[28:31]
  ds_read_b128 a[24:27], v106 offset:32768
  ds_read_b64_tr_b16 v[68:69], v107 offset:57344
  v_mfma_f32_16x16x32_bf16 v[32:35], a[20:23], v[80:83], v[32:35]
  ds_read_b128 a[28:31], v106 offset:34816
  ds_read_b64_tr_b16 v[70:71], v107 offset:57856
  s_waitcnt lgkmcnt(8)
  v_mfma_f32_16x16x32_bf16 v[36:39], a[16:19], v[84:87], v[36:39]
  ds_read_b64_tr_b16 v[72:73], v108 offset:57344
  v_mfma_f32_16x16x32_bf16 v[40:43], a[20:23], v[84:87], v[40:43]
  ds_read_b64_tr_b16 v[74:75], v108 offset:57856
  v_mfma_f32_16x16x32_bf16 v[44:47], a[16:19], v[88:91], v[44:47]
  ds_read_b64_tr_b16 v[76:77], v109 offset:57344
  v_mfma_f32_16x16x32_bf16 v[48:51], a[20:23], v[88:91], v[48:51]
  ds_read_b64_tr_b16 v[78:79], v109 offset:57856
  s_waitcnt lgkmcnt(8)
  v_mfma_f32_16x16x32_bf16 v[52:55], a[16:19], v[92:95], v[52:55]
  ds_read_b64_tr_b16 v[80:81], v110 offset:57344
  v_mfma_f32_16x16x32_bf16 v[56:59], a[20:23], v[92:95], v[56:59]
  ds_read_b64_tr_b16 v[82:83], v110 offset:57856
  v_mfma_f32_16x16x32_bf16 v[60:63], a[16:19], v[96:99], v[60:63]
  ds_read_b64_tr_b16 v[84:85], v107 offset:59392
  v_mfma_f32_16x16x32_bf16 v[64:67], a[20:23], v[96:99], v[64:67]
  ds_read_b64_tr_b16 v[86:87], v107 offset:59904
  s_waitcnt lgkmcnt(6)
  v_mfma_f32_16x16x32_bf16 v[4:7], a[24:27], v[68:71], v[4:7]
  ds_read_b64_tr_b16 v[88:89], v108 offset:59392
  v_mfma_f32_16x16x32_bf16 v[8:11], a[28:31], v[68:71], v[8:11]
  ds_read_b64_tr_b16 v[90:91], v108 offset:59904
  v_mfma_f32_16x16x32_bf16 v[12:15], a[24:27], v[72:75], v[12:15]
  ds_read_b64_tr_b16 v[92:93], v109 offset:59392
  v_mfma_f32_16x16x32_bf16 v[16:19], a[28:31], v[72:75], v[16:19]
  ds_read_b64_tr_b16 v[94:95], v109 offset:59904
  s_waitcnt lgkmcnt(6)
  v_mfma_f32_16x16x32_bf16 v[20:23], a[24:27], v[76:79], v[20:23]
  ds_read_b64_tr_b16 v[96:97], v110 offset:59392
  v_mfma_f32_16x16x32_bf16 v[24:27], a[28:31], v[76:79], v[24:27]
  ds_read_b64_tr_b16 v[98:99], v110 offset:59904
  v_mfma_f32_16x16x32_bf16 v[28:31], a[24:27], v[80:83], v[28:31]
  s_barrier
  v_add_u32 v105, 65536, v105
  ds_read_b128 a[32:35], v105 offset:0
  v_add_u32 v107, 65536, v107
  ds_read_b64_tr_b16 v[68:69], v107 offset:16384
  v_mfma_f32_16x16x32_bf16 v[32:35], a[28:31], v[80:83], v[32:35]
  ds_read_b128 a[36:39], v105 offset:2048
  ds_read_b64_tr_b16 v[70:71], v107 offset:16896
  s_waitcnt lgkmcnt(8)
  v_mfma_f32_16x16x32_bf16 v[36:39], a[24:27], v[84:87], v[36:39]
  v_add_u32 v108, 65536, v108
  ds_read_b64_tr_b16 v[72:73], v108 offset:16384
  v_mfma_f32_16x16x32_bf16 v[40:43], a[28:31], v[84:87], v[40:43]
  ds_read_b64_tr_b16 v[74:75], v108 offset:16896
  v_mfma_f32_16x16x32_bf16 v[44:47], a[24:27], v[88:91], v[44:47]
  v_add_u32 v109, 65536, v109
  ds_read_b64_tr_b16 v[76:77], v109 offset:16384
  v_mfma_f32_16x16x32_bf16 v[48:51], a[28:31], v[88:91], v[48:51]
  ds_read_b64_tr_b16 v[78:79], v109 offset:16896
  s_waitcnt lgkmcnt(8)
  v_mfma_f32_16x16x32_bf16 v[52:55], a[24:27], v[92:95], v[52:55]
  v_add_u32 v110, 65536, v110
  ds_read_b64_tr_b16 v[80:81], v110 offset:16384
  v_mfma_f32_16x16x32_bf16 v[56:59], a[28:31], v[92:95], v[56:59]
  ds_read_b64_tr_b16 v[82:83], v110 offset:16896
  v_mfma_f32_16x16x32_bf16 v[60:63], a[24:27], v[96:99], v[60:63]
  ds_read_b64_tr_b16 v[84:85], v107 offset:18432
  v_mfma_f32_16x16x32_bf16 v[64:67], a[28:31], v[96:99], v[64:67]
  ds_read_b64_tr_b16 v[86:87], v107 offset:18944
  s_waitcnt lgkmcnt(6)
  v_mfma_f32_16x16x32_bf16 v[4:7], a[32:35], v[68:71], v[4:7]
  ds_read_b64_tr_b16 v[88:89], v108 offset:18432
  v_mfma_f32_16x16x32_bf16 v[8:11], a[36:39], v[68:71], v[8:11]
  ds_read_b64_tr_b16 v[90:91], v108 offset:18944
  v_mfma_f32_16x16x32_bf16 v[12:15], a[32:35], v[72:75], v[12:15]
  ds_read_b64_tr_b16 v[92:93], v109 offset:18432
  v_mfma_f32_16x16x32_bf16 v[16:19], a[36:39], v[72:75], v[16:19]
  ds_read_b64_tr_b16 v[94:95], v109 offset:18944
  s_waitcnt lgkmcnt(6)
  v_mfma_f32_16x16x32_bf16 v[20:23], a[32:35], v[76:79], v[20:23]
  ds_read_b64_tr_b16 v[96:97], v110 offset:18432
  v_mfma_f32_16x16x32_bf16 v[24:27], a[36:39], v[76:79], v[24:27]
  ds_read_b64_tr_b16 v[98:99], v110 offset:18944
  v_mfma_f32_16x16x32_bf16 v[28:31], a[32:35], v[80:83], v[28:31]
  v_add_u32 v106, 65536, v106
  ds_read_b128 a[40:43], v106 offset:0
  ds_read_b64_tr_b16 v[68:69], v107 offset:24576
  v_mfma_f32_16x16x32_bf16 v[32:35], a[36:39], v[80:83], v[32:35]
  ds_read_b128 a[44:47], v106 offset:2048
  ds_read_b64_tr_b16 v[70:71], v107 offset:25088
  s_waitcnt lgkmcnt(8)
  v_mfma_f32_16x16x32_bf16 v[36:39], a[32:35], v[84:87], v[36:39]
  ds_read_b64_tr_b16 v[72:73], v108 offset:24576
  v_mfma_f32_16x16x32_bf16 v[40:43], a[36:39], v[84:87], v[40:43]
  ds_read_b64_tr_b16 v[74:75], v108 offset:25088
  v_mfma_f32_16x16x32_bf16 v[44:47], a[32:35], v[88:91], v[44:47]
  ds_read_b64_tr_b16 v[76:77], v109 offset:24576
  v_mfma_f32_16x16x32_bf16 v[48:51], a[36:39], v[88:91], v[48:51]
  ds_read_b64_tr_b16 v[78:79], v109 offset:25088
  s_waitcnt lgkmcnt(8)
  v_mfma_f32_16x16x32_bf16 v[52:55], a[32:35], v[92:95], v[52:55]
  ds_read_b64_tr_b16 v[80:81], v110 offset:24576
  v_mfma_f32_16x16x32_bf16 v[56:59], a[36:39], v[92:95], v[56:59]
  ds_read_b64_tr_b16 v[82:83], v110 offset:25088
  v_mfma_f32_16x16x32_bf16 v[60:63], a[32:35], v[96:99], v[60:63]
  ds_read_b64_tr_b16 v[84:85], v107 offset:26624
  v_mfma_f32_16x16x32_bf16 v[64:67], a[36:39], v[96:99], v[64:67]
  ds_read_b64_tr_b16 v[86:87], v107 offset:27136
  s_waitcnt lgkmcnt(6)
  v_mfma_f32_16x16x32_bf16 v[4:7], a[40:43], v[68:71], v[4:7]
  ds_read_b64_tr_b16 v[88:89], v108 offset:26624
  v_mfma_f32_16x16x32_bf16 v[8:11], a[44:47], v[68:71], v[8:11]
  ds_read_b64_tr_b16 v[90:91], v108 offset:27136
  v_mfma_f32_16x16x32_bf16 v[12:15], a[40:43], v[72:75], v[12:15]
  ds_read_b64_tr_b16 v[92:93], v109 offset:26624
  v_mfma_f32_16x16x32_bf16 v[16:19], a[44:47], v[72:75], v[16:19]
  ds_read_b64_tr_b16 v[94:95], v109 offset:27136
  s_waitcnt lgkmcnt(6)
  v_mfma_f32_16x16x32_bf16 v[20:23], a[40:43], v[76:79], v[20:23]
  ds_read_b64_tr_b16 v[96:97], v110 offset:26624
  v_mfma_f32_16x16x32_bf16 v[24:27], a[44:47], v[76:79], v[24:27]
  ds_read_b64_tr_b16 v[98:99], v110 offset:27136
  v_mfma_f32_16x16x32_bf16 v[28:31], a[40:43], v[80:83], v[28:31]
  s_barrier
  v_add_u32 v105, 4294901760, v105
  ds_read_b128 a[48:51], v105 offset:0
  ds_read_b64_tr_b16 v[68:69], v107 offset:32768
  v_mfma_f32_16x16x32_bf16 v[32:35], a[44:47], v[80:83], v[32:35]
  ds_read_b128 a[52:55], v105 offset:2048
  ds_read_b64_tr_b16 v[70:71], v107 offset:33280
  s_waitcnt lgkmcnt(8)
  v_mfma_f32_16x16x32_bf16 v[36:39], a[40:43], v[84:87], v[36:39]
  ds_read_b64_tr_b16 v[72:73], v108 offset:32768
  v_mfma_f32_16x16x32_bf16 v[40:43], a[44:47], v[84:87], v[40:43]
  ds_read_b64_tr_b16 v[74:75], v108 offset:33280
  v_mfma_f32_16x16x32_bf16 v[44:47], a[40:43], v[88:91], v[44:47]
  ds_read_b64_tr_b16 v[76:77], v109 offset:32768
  v_mfma_f32_16x16x32_bf16 v[48:51], a[44:47], v[88:91], v[48:51]
  ds_read_b64_tr_b16 v[78:79], v109 offset:33280
  s_waitcnt lgkmcnt(8)
  v_mfma_f32_16x16x32_bf16 v[52:55], a[40:43], v[92:95], v[52:55]
  ds_read_b64_tr_b16 v[80:81], v110 offset:32768
  v_mfma_f32_16x16x32_bf16 v[56:59], a[44:47], v[92:95], v[56:59]
  ds_read_b64_tr_b16 v[82:83], v110 offset:33280
  v_mfma_f32_16x16x32_bf16 v[60:63], a[40:43], v[96:99], v[60:63]
  ds_read_b64_tr_b16 v[84:85], v107 offset:34816
  v_mfma_f32_16x16x32_bf16 v[64:67], a[44:47], v[96:99], v[64:67]
  ds_read_b64_tr_b16 v[86:87], v107 offset:35328
  s_waitcnt lgkmcnt(6)
  v_mfma_f32_16x16x32_bf16 v[4:7], a[48:51], v[68:71], v[4:7]
  ds_read_b64_tr_b16 v[88:89], v108 offset:34816
  v_mfma_f32_16x16x32_bf16 v[8:11], a[52:55], v[68:71], v[8:11]
  ds_read_b64_tr_b16 v[90:91], v108 offset:35328
  v_mfma_f32_16x16x32_bf16 v[12:15], a[48:51], v[72:75], v[12:15]
  ds_read_b64_tr_b16 v[92:93], v109 offset:34816
  v_mfma_f32_16x16x32_bf16 v[16:19], a[52:55], v[72:75], v[16:19]
  ds_read_b64_tr_b16 v[94:95], v109 offset:35328
  s_waitcnt lgkmcnt(6)
  v_mfma_f32_16x16x32_bf16 v[20:23], a[48:51], v[76:79], v[20:23]
  ds_read_b64_tr_b16 v[96:97], v110 offset:34816
  v_mfma_f32_16x16x32_bf16 v[24:27], a[52:55], v[76:79], v[24:27]
  ds_read_b64_tr_b16 v[98:99], v110 offset:35328
  v_mfma_f32_16x16x32_bf16 v[28:31], a[48:51], v[80:83], v[28:31]
  v_add_u32 v106, 4294901760, v106
  ds_read_b128 a[56:59], v106 offset:0
  ds_read_b64_tr_b16 v[68:69], v107 offset:40960
  v_mfma_f32_16x16x32_bf16 v[32:35], a[52:55], v[80:83], v[32:35]
  ds_read_b128 a[60:63], v106 offset:2048
  ds_read_b64_tr_b16 v[70:71], v107 offset:41472
  s_waitcnt lgkmcnt(8)
  v_mfma_f32_16x16x32_bf16 v[36:39], a[48:51], v[84:87], v[36:39]
  ds_read_b64_tr_b16 v[72:73], v108 offset:40960
  v_mfma_f32_16x16x32_bf16 v[40:43], a[52:55], v[84:87], v[40:43]
  ds_read_b64_tr_b16 v[74:75], v108 offset:41472
  v_mfma_f32_16x16x32_bf16 v[44:47], a[48:51], v[88:91], v[44:47]
  ds_read_b64_tr_b16 v[76:77], v109 offset:40960
  v_mfma_f32_16x16x32_bf16 v[48:51], a[52:55], v[88:91], v[48:51]
  ds_read_b64_tr_b16 v[78:79], v109 offset:41472
  s_waitcnt lgkmcnt(8)
  v_mfma_f32_16x16x32_bf16 v[52:55], a[48:51], v[92:95], v[52:55]
  ds_read_b64_tr_b16 v[80:81], v110 offset:40960
  v_mfma_f32_16x16x32_bf16 v[56:59], a[52:55], v[92:95], v[56:59]
  ds_read_b64_tr_b16 v[82:83], v110 offset:41472
  v_mfma_f32_16x16x32_bf16 v[60:63], a[48:51], v[96:99], v[60:63]
  ds_read_b64_tr_b16 v[84:85], v107 offset:43008
  v_mfma_f32_16x16x32_bf16 v[64:67], a[52:55], v[96:99], v[64:67]
  ds_read_b64_tr_b16 v[86:87], v107 offset:43520
  s_waitcnt lgkmcnt(6)
  v_mfma_f32_16x16x32_bf16 v[4:7], a[56:59], v[68:71], v[4:7]
  ds_read_b64_tr_b16 v[88:89], v108 offset:43008
  v_mfma_f32_16x16x32_bf16 v[8:11], a[60:63], v[68:71], v[8:11]
  ds_read_b64_tr_b16 v[90:91], v108 offset:43520
  v_mfma_f32_16x16x32_bf16 v[12:15], a[56:59], v[72:75], v[12:15]
  ds_read_b64_tr_b16 v[92:93], v109 offset:43008
  v_mfma_f32_16x16x32_bf16 v[16:19], a[60:63], v[72:75], v[16:19]
  ds_read_b64_tr_b16 v[94:95], v109 offset:43520
  s_waitcnt lgkmcnt(6)
  v_mfma_f32_16x16x32_bf16 v[20:23], a[56:59], v[76:79], v[20:23]
  ds_read_b64_tr_b16 v[96:97], v110 offset:43008
  v_mfma_f32_16x16x32_bf16 v[24:27], a[60:63], v[76:79], v[24:27]
  ds_read_b64_tr_b16 v[98:99], v110 offset:43520
  v_mfma_f32_16x16x32_bf16 v[28:31], a[56:59], v[80:83], v[28:31]
  s_barrier
  global_load_dword v115, v104, s[20:21] sc1
  ds_read_b128 a[64:67], v105 offset:16384
  v_add_u32 v107, 4294901760, v107
  ds_read_b64_tr_b16 v[68:69], v107 offset:32768
  v_mfma_f32_16x16x32_bf16 v[32:35], a[60:63], v[80:83], v[32:35]
  ds_read_b128 a[68:71], v105 offset:18432
  ds_read_b64_tr_b16 v[70:71], v107 offset:33280
  s_waitcnt lgkmcnt(8)
  v_mfma_f32_16x16x32_bf16 v[36:39], a[56:59], v[84:87], v[36:39]
  v_add_u32 v108, 4294901760, v108
  ds_read_b64_tr_b16 v[72:73], v108 offset:32768
  v_mfma_f32_16x16x32_bf16 v[40:43], a[60:63], v[84:87], v[40:43]
  ds_read_b64_tr_b16 v[74:75], v108 offset:33280
  v_mfma_f32_16x16x32_bf16 v[44:47], a[56:59], v[88:91], v[44:47]
  v_add_u32 v109, 4294901760, v109
  ds_read_b64_tr_b16 v[76:77], v109 offset:32768
  v_mfma_f32_16x16x32_bf16 v[48:51], a[60:63], v[88:91], v[48:51]
  ds_read_b64_tr_b16 v[78:79], v109 offset:33280
  s_waitcnt lgkmcnt(8)
  v_mfma_f32_16x16x32_bf16 v[52:55], a[56:59], v[92:95], v[52:55]
  v_add_u32 v110, 4294901760, v110
  ds_read_b64_tr_b16 v[80:81], v110 offset:32768
  v_mfma_f32_16x16x32_bf16 v[56:59], a[60:63], v[92:95], v[56:59]
  ds_read_b64_tr_b16 v[82:83], v110 offset:33280
  v_mfma_f32_16x16x32_bf16 v[60:63], a[56:59], v[96:99], v[60:63]
  ds_read_b64_tr_b16 v[84:85], v107 offset:34816
  v_mfma_f32_16x16x32_bf16 v[64:67], a[60:63], v[96:99], v[64:67]
  ds_read_b64_tr_b16 v[86:87], v107 offset:35328
  s_waitcnt lgkmcnt(6)
  v_mfma_f32_16x16x32_bf16 v[4:7], a[64:67], v[68:71], v[4:7]
  ds_read_b64_tr_b16 v[88:89], v108 offset:34816
  v_mfma_f32_16x16x32_bf16 v[8:11], a[68:71], v[68:71], v[8:11]
  ds_read_b64_tr_b16 v[90:91], v108 offset:35328
  v_mfma_f32_16x16x32_bf16 v[12:15], a[64:67], v[72:75], v[12:15]
  ds_read_b64_tr_b16 v[92:93], v109 offset:34816
  v_mfma_f32_16x16x32_bf16 v[16:19], a[68:71], v[72:75], v[16:19]
  ds_read_b64_tr_b16 v[94:95], v109 offset:35328
  s_waitcnt lgkmcnt(6)
  v_mfma_f32_16x16x32_bf16 v[20:23], a[64:67], v[76:79], v[20:23]
  ds_read_b64_tr_b16 v[96:97], v110 offset:34816
  v_mfma_f32_16x16x32_bf16 v[24:27], a[68:71], v[76:79], v[24:27]
  ds_read_b64_tr_b16 v[98:99], v110 offset:35328
  v_mfma_f32_16x16x32_bf16 v[28:31], a[64:67], v[80:83], v[28:31]
  ds_read_b128 a[72:75], v106 offset:16384
  ds_read_b64_tr_b16 v[68:69], v107 offset:40960
  v_mfma_f32_16x16x32_bf16 v[32:35], a[68:71], v[80:83], v[32:35]
  ds_read_b128 a[76:79], v106 offset:18432
  ds_read_b64_tr_b16 v[70:71], v107 offset:41472
  s_waitcnt lgkmcnt(8)
  v_mfma_f32_16x16x32_bf16 v[36:39], a[64:67], v[84:87], v[36:39]
  ds_read_b64_tr_b16 v[72:73], v108 offset:40960
  v_mfma_f32_16x16x32_bf16 v[40:43], a[68:71], v[84:87], v[40:43]
  ds_read_b64_tr_b16 v[74:75], v108 offset:41472
  v_mfma_f32_16x16x32_bf16 v[44:47], a[64:67], v[88:91], v[44:47]
  ds_read_b64_tr_b16 v[76:77], v109 offset:40960
  v_mfma_f32_16x16x32_bf16 v[48:51], a[68:71], v[88:91], v[48:51]
  ds_read_b64_tr_b16 v[78:79], v109 offset:41472
  s_waitcnt lgkmcnt(8)
  v_mfma_f32_16x16x32_bf16 v[52:55], a[64:67], v[92:95], v[52:55]
  ds_read_b64_tr_b16 v[80:81], v110 offset:40960
  v_mfma_f32_16x16x32_bf16 v[56:59], a[68:71], v[92:95], v[56:59]
  ds_read_b64_tr_b16 v[82:83], v110 offset:41472
  v_mfma_f32_16x16x32_bf16 v[60:63], a[64:67], v[96:99], v[60:63]
  ds_read_b64_tr_b16 v[84:85], v107 offset:43008
  v_mfma_f32_16x16x32_bf16 v[64:67], a[68:71], v[96:99], v[64:67]
  ds_read_b64_tr_b16 v[86:87], v107 offset:43520
  s_waitcnt lgkmcnt(6)
  v_mfma_f32_16x16x32_bf16 v[4:7], a[72:75], v[68:71], v[4:7]
  ds_read_b64_tr_b16 v[88:89], v108 offset:43008
  v_mfma_f32_16x16x32_bf16 v[8:11], a[76:79], v[68:71], v[8:11]
  ds_read_b64_tr_b16 v[90:91], v108 offset:43520
  v_mfma_f32_16x16x32_bf16 v[12:15], a[72:75], v[72:75], v[12:15]
  ds_read_b64_tr_b16 v[92:93], v109 offset:43008
  v_mfma_f32_16x16x32_bf16 v[16:19], a[76:79], v[72:75], v[16:19]
  ds_read_b64_tr_b16 v[94:95], v109 offset:43520
  s_waitcnt lgkmcnt(6)
  v_mfma_f32_16x16x32_bf16 v[20:23], a[72:75], v[76:79], v[20:23]
  ds_read_b64_tr_b16 v[96:97], v110 offset:43008
  v_mfma_f32_16x16x32_bf16 v[24:27], a[76:79], v[76:79], v[24:27]
  ds_read_b64_tr_b16 v[98:99], v110 offset:43520
  v_mfma_f32_16x16x32_bf16 v[28:31], a[72:75], v[80:83], v[28:31]
  s_barrier
  ds_read_b128 a[80:83], v105 offset:49152
  v_add_u32 v107, 65536, v107
  ds_read_b64_tr_b16 v[68:69], v107 offset:0
  v_mfma_f32_16x16x32_bf16 v[32:35], a[76:79], v[80:83], v[32:35]
  ds_read_b128 a[84:87], v105 offset:51200
  ds_read_b64_tr_b16 v[70:71], v107 offset:512
  s_waitcnt lgkmcnt(8)
  v_mfma_f32_16x16x32_bf16 v[36:39], a[72:75], v[84:87], v[36:39]
  v_add_u32 v108, 65536, v108
  ds_read_b64_tr_b16 v[72:73], v108 offset:0
  v_mfma_f32_16x16x32_bf16 v[40:43], a[76:79], v[84:87], v[40:43]
  ds_read_b64_tr_b16 v[74:75], v108 offset:512
  v_mfma_f32_16x16x32_bf16 v[44:47], a[72:75], v[88:91], v[44:47]
  v_add_u32 v109, 65536, v109
  ds_read_b64_tr_b16 v[76:77], v109 offset:0
  v_mfma_f32_16x16x32_bf16 v[48:51], a[76:79], v[88:91], v[48:51]
  ds_read_b64_tr_b16 v[78:79], v109 offset:512
  s_waitcnt lgkmcnt(8)
  v_mfma_f32_16x16x32_bf16 v[52:55], a[72:75], v[92:95], v[52:55]
  v_add_u32 v110, 65536, v110
  ds_read_b64_tr_b16 v[80:81], v110 offset:0
  v_mfma_f32_16x16x32_bf16 v[56:59], a[76:79], v[92:95], v[56:59]
  ds_read_b64_tr_b16 v[82:83], v110 offset:512
  v_mfma_f32_16x16x32_bf16 v[60:63], a[72:75], v[96:99], v[60:63]
  ds_read_b64_tr_b16 v[84:85], v107 offset:2048
  v_mfma_f32_16x16x32_bf16 v[64:67], a[76:79], v[96:99], v[64:67]
  ds_read_b64_tr_b16 v[86:87], v107 offset:2560
  s_waitcnt lgkmcnt(6)
  v_mfma_f32_16x16x32_bf16 v[4:7], a[80:83], v[68:71], v[4:7]
  ds_read_b64_tr_b16 v[88:89], v108 offset:2048
  v_mfma_f32_16x16x32_bf16 v[8:11], a[84:87], v[68:71], v[8:11]
  ds_read_b64_tr_b16 v[90:91], v108 offset:2560
  v_mfma_f32_16x16x32_bf16 v[12:15], a[80:83], v[72:75], v[12:15]
  ds_read_b64_tr_b16 v[92:93], v109 offset:2048
  v_mfma_f32_16x16x32_bf16 v[16:19], a[84:87], v[72:75], v[16:19]
  ds_read_b64_tr_b16 v[94:95], v109 offset:2560
  s_waitcnt lgkmcnt(6)
  v_mfma_f32_16x16x32_bf16 v[20:23], a[80:83], v[76:79], v[20:23]
  ds_read_b64_tr_b16 v[96:97], v110 offset:2048
  v_mfma_f32_16x16x32_bf16 v[24:27], a[84:87], v[76:79], v[24:27]
  ds_read_b64_tr_b16 v[98:99], v110 offset:2560
  v_mfma_f32_16x16x32_bf16 v[28:31], a[80:83], v[80:83], v[28:31]
  ds_read_b128 a[88:91], v106 offset:49152
  ds_read_b64_tr_b16 v[68:69], v107 offset:8192
  v_mfma_f32_16x16x32_bf16 v[32:35], a[84:87], v[80:83], v[32:35]
  ds_read_b128 a[92:95], v106 offset:51200
  ds_read_b64_tr_b16 v[70:71], v107 offset:8704
  s_waitcnt lgkmcnt(8)
  v_mfma_f32_16x16x32_bf16 v[36:39], a[80:83], v[84:87], v[36:39]
  ds_read_b64_tr_b16 v[72:73], v108 offset:8192
  v_mfma_f32_16x16x32_bf16 v[40:43], a[84:87], v[84:87], v[40:43]
  ds_read_b64_tr_b16 v[74:75], v108 offset:8704
  v_mfma_f32_16x16x32_bf16 v[44:47], a[80:83], v[88:91], v[44:47]
  ds_read_b64_tr_b16 v[76:77], v109 offset:8192
  v_mfma_f32_16x16x32_bf16 v[48:51], a[84:87], v[88:91], v[48:51]
  ds_read_b64_tr_b16 v[78:79], v109 offset:8704
  s_waitcnt lgkmcnt(8)
  v_mfma_f32_16x16x32_bf16 v[52:55], a[80:83], v[92:95], v[52:55]
  ds_read_b64_tr_b16 v[80:81], v110 offset:8192
  v_mfma_f32_16x16x32_bf16 v[56:59], a[84:87], v[92:95], v[56:59]
  ds_read_b64_tr_b16 v[82:83], v110 offset:8704
  v_mfma_f32_16x16x32_bf16 v[60:63], a[80:83], v[96:99], v[60:63]
  ds_read_b64_tr_b16 v[84:85], v107 offset:10240
  v_mfma_f32_16x16x32_bf16 v[64:67], a[84:87], v[96:99], v[64:67]
  ds_read_b64_tr_b16 v[86:87], v107 offset:10752
  s_waitcnt lgkmcnt(6)
  v_mfma_f32_16x16x32_bf16 v[4:7], a[88:91], v[68:71], v[4:7]
  ds_read_b64_tr_b16 v[88:89], v108 offset:10240
  v_mfma_f32_16x16x32_bf16 v[8:11], a[92:95], v[68:71], v[8:11]
  ds_read_b64_tr_b16 v[90:91], v108 offset:10752
  v_mfma_f32_16x16x32_bf16 v[12:15], a[88:91], v[72:75], v[12:15]
  ds_read_b64_tr_b16 v[92:93], v109 offset:10240
  v_mfma_f32_16x16x32_bf16 v[16:19], a[92:95], v[72:75], v[16:19]
  ds_read_b64_tr_b16 v[94:95], v109 offset:10752
  s_waitcnt lgkmcnt(6)
  v_mfma_f32_16x16x32_bf16 v[20:23], a[88:91], v[76:79], v[20:23]
  ds_read_b64_tr_b16 v[96:97], v110 offset:10240
  v_mfma_f32_16x16x32_bf16 v[24:27], a[92:95], v[76:79], v[24:27]
  ds_read_b64_tr_b16 v[98:99], v110 offset:10752
  v_mfma_f32_16x16x32_bf16 v[28:31], a[88:91], v[80:83], v[28:31]
  s_barrier
  ds_read_b128 a[96:99], v105 offset:0
  ds_read_b64_tr_b16 v[68:69], v107 offset:16384
  v_mfma_f32_16x16x32_bf16 v[32:35], a[92:95], v[80:83], v[32:35]
  ds_read_b128 a[100:103], v105 offset:2048
  ds_read_b64_tr_b16 v[70:71], v107 offset:16896
  s_waitcnt lgkmcnt(8)
  v_mfma_f32_16x16x32_bf16 v[36:39], a[88:91], v[84:87], v[36:39]
  ds_read_b64_tr_b16 v[72:73], v108 offset:16384
  v_mfma_f32_16x16x32_bf16 v[40:43], a[92:95], v[84:87], v[40:43]
  ds_read_b64_tr_b16 v[74:75], v108 offset:16896
  v_mfma_f32_16x16x32_bf16 v[44:47], a[88:91], v[88:91], v[44:47]
  ds_read_b128 a[104:107], v106 offset:0
  ds_read_b64_tr_b16 v[76:77], v107 offset:24576
  v_mfma_f32_16x16x32_bf16 v[48:51], a[92:95], v[88:91], v[48:51]
  ds_read_b128 a[108:111], v106 offset:2048
  ds_read_b64_tr_b16 v[78:79], v107 offset:25088
  s_waitcnt lgkmcnt(10)
  v_mfma_f32_16x16x32_bf16 v[52:55], a[88:91], v[92:95], v[52:55]
  ds_read_b64_tr_b16 v[80:81], v108 offset:24576
  v_mfma_f32_16x16x32_bf16 v[56:59], a[92:95], v[92:95], v[56:59]
  ds_read_b64_tr_b16 v[82:83], v108 offset:25088
  v_mfma_f32_16x16x32_bf16 v[60:63], a[88:91], v[96:99], v[60:63]
  s_barrier
  ds_read_b128 a[112:115], v105 offset:16384
  ds_read_b64_tr_b16 v[84:85], v107 offset:32768
  v_mfma_f32_16x16x32_bf16 v[64:67], a[92:95], v[96:99], v[64:67]
  ds_read_b128 a[116:119], v105 offset:18432
  ds_read_b64_tr_b16 v[86:87], v107 offset:33280
  s_waitcnt lgkmcnt(10)
  v_mfma_f32_16x16x32_bf16 v[4:7], a[96:99], v[68:71], v[4:7]
  ds_read_b64_tr_b16 v[88:89], v108 offset:32768
  v_mfma_f32_16x16x32_bf16 v[8:11], a[100:103], v[68:71], v[8:11]
  ds_read_b64_tr_b16 v[90:91], v108 offset:33280
  v_mfma_f32_16x16x32_bf16 v[12:15], a[96:99], v[72:75], v[12:15]
  ds_read_b128 a[120:123], v106 offset:16384
  ds_read_b64_tr_b16 v[92:93], v107 offset:40960
  v_mfma_f32_16x16x32_bf16 v[16:19], a[100:103], v[72:75], v[16:19]
  ds_read_b128 a[124:127], v106 offset:18432
  ds_read_b64_tr_b16 v[94:95], v107 offset:41472
  s_waitcnt lgkmcnt(10)
  v_mfma_f32_16x16x32_bf16 v[4:7], a[104:107], v[76:79], v[4:7]
  ds_read_b64_tr_b16 v[96:97], v108 offset:40960
  v_mfma_f32_16x16x32_bf16 v[8:11], a[108:111], v[76:79], v[8:11]
  ds_read_b64_tr_b16 v[98:99], v108 offset:41472
  v_mfma_f32_16x16x32_bf16 v[12:15], a[104:107], v[80:83], v[12:15]
  ds_read_b64_tr_b16 v[68:69], v109 offset:16384
  v_mfma_f32_16x16x32_bf16 v[16:19], a[108:111], v[80:83], v[16:19]
  ds_read_b64_tr_b16 v[70:71], v109 offset:16896
  s_waitcnt lgkmcnt(8)
  v_mfma_f32_16x16x32_bf16 v[4:7], a[112:115], v[84:87], v[4:7]
  ds_read_b64_tr_b16 v[72:73], v110 offset:16384
  v_mfma_f32_16x16x32_bf16 v[8:11], a[116:119], v[84:87], v[8:11]
  ds_read_b64_tr_b16 v[74:75], v110 offset:16896
  v_mfma_f32_16x16x32_bf16 v[12:15], a[112:115], v[88:91], v[12:15]
  ds_read_b64_tr_b16 v[76:77], v109 offset:24576
  v_mfma_f32_16x16x32_bf16 v[16:19], a[116:119], v[88:91], v[16:19]
  ds_read_b64_tr_b16 v[78:79], v109 offset:25088
  s_waitcnt lgkmcnt(6)
  v_mfma_f32_16x16x32_bf16 v[4:7], a[120:123], v[92:95], v[4:7]
  ds_read_b64_tr_b16 v[80:81], v110 offset:24576
  v_mfma_f32_16x16x32_bf16 v[8:11], a[124:127], v[92:95], v[8:11]
  ds_read_b64_tr_b16 v[82:83], v110 offset:25088
  v_mfma_f32_16x16x32_bf16 v[12:15], a[120:123], v[96:99], v[12:15]
  ds_read_b64_tr_b16 v[84:85], v109 offset:32768
  v_mfma_f32_16x16x32_bf16 v[16:19], a[124:127], v[96:99], v[16:19]
  ds_read_b64_tr_b16 v[86:87], v109 offset:33280
  s_waitcnt lgkmcnt(6)
  v_mfma_f32_16x16x32_bf16 v[20:23], a[96:99], v[68:71], v[20:23]
  ds_read_b64_tr_b16 v[88:89], v110 offset:32768
  v_mfma_f32_16x16x32_bf16 v[24:27], a[100:103], v[68:71], v[24:27]
  ds_read_b64_tr_b16 v[90:91], v110 offset:33280
  v_mfma_f32_16x16x32_bf16 v[28:31], a[96:99], v[72:75], v[28:31]
  ds_read_b64_tr_b16 v[92:93], v109 offset:40960
  v_mfma_f32_16x16x32_bf16 v[32:35], a[100:103], v[72:75], v[32:35]
  ds_read_b64_tr_b16 v[94:95], v109 offset:41472
  v_cvt_pk_bf16_f32 v116, v4, v5
  v_cvt_pk_bf16_f32 v118, v6, v7
  v_cvt_pk_bf16_f32 v120, v8, v9
  v_cvt_pk_bf16_f32 v122, v10, v11
  s_waitcnt lgkmcnt(6)
  v_mfma_f32_16x16x32_bf16 v[20:23], a[104:107], v[76:79], v[20:23]
  ds_read_b64_tr_b16 v[96:97], v110 offset:40960
  v_mfma_f32_16x16x32_bf16 v[24:27], a[108:111], v[76:79], v[24:27]
  ds_read_b64_tr_b16 v[98:99], v110 offset:41472
  v_lshlrev_b32 v4, 16, v116
  v_and_b32 v5, 0xffff0000, v116
  v_lshlrev_b32 v6, 16, v118
  v_and_b32 v7, 0xffff0000, v118
  v_mfma_f32_16x16x32_bf16 v[28:31], a[104:107], v[80:83], v[28:31]
  ds_read_b64_tr_b16 v[68:69], v107 offset:18432
  v_mfma_f32_16x16x32_bf16 v[32:35], a[108:111], v[80:83], v[32:35]
  ds_read_b64_tr_b16 v[70:71], v107 offset:18944
  v_lshlrev_b32 v8, 16, v120
  v_and_b32 v9, 0xffff0000, v120
  v_lshlrev_b32 v10, 16, v122
  v_and_b32 v11, 0xffff0000, v122
  s_waitcnt lgkmcnt(6)
  v_mfma_f32_16x16x32_bf16 v[20:23], a[112:115], v[84:87], v[20:23]
  ds_read_b64_tr_b16 v[72:73], v108 offset:18432
  v_mfma_f32_16x16x32_bf16 v[24:27], a[116:119], v[84:87], v[24:27]
  ds_read_b64_tr_b16 v[74:75], v108 offset:18944
  v_pk_mul_f32 v[116:117], v[4:5], s[10:11]
  v_pk_mul_f32 v[118:119], v[6:7], s[10:11]
  v_pk_mul_f32 v[120:121], v[8:9], s[10:11]
  v_pk_mul_f32 v[122:123], v[10:11], s[10:11]
  v_mfma_f32_16x16x32_bf16 v[28:31], a[112:115], v[88:91], v[28:31]
  ds_read_b64_tr_b16 v[76:77], v107 offset:26624
  v_mfma_f32_16x16x32_bf16 v[32:35], a[116:119], v[88:91], v[32:35]
  ds_read_b64_tr_b16 v[78:79], v107 offset:27136
  v_exp_f32_e64 v116, v116 clamp
  v_max_f32 v4, s12, v4
  s_waitcnt lgkmcnt(6)
  v_mfma_f32_16x16x32_bf16 v[20:23], a[120:123], v[92:95], v[20:23]
  ds_read_b64_tr_b16 v[80:81], v108 offset:26624
  v_mfma_f32_16x16x32_bf16 v[24:27], a[124:127], v[92:95], v[24:27]
  ds_read_b64_tr_b16 v[82:83], v108 offset:27136
  v_exp_f32_e64 v117, v117 clamp
  v_max_f32 v5, s12, v5
  v_mfma_f32_16x16x32_bf16 v[28:31], a[120:123], v[96:99], v[28:31]
  ds_read_b64_tr_b16 v[84:85], v107 offset:34816
  v_mfma_f32_16x16x32_bf16 v[32:35], a[124:127], v[96:99], v[32:35]
  ds_read_b64_tr_b16 v[86:87], v107 offset:35328
  v_exp_f32_e64 v118, v118 clamp
  v_max_f32 v6, s12, v6
  s_waitcnt lgkmcnt(6)
  v_mfma_f32_16x16x32_bf16 v[36:39], a[96:99], v[68:71], v[36:39]
  ds_read_b64_tr_b16 v[88:89], v108 offset:34816
  v_mfma_f32_16x16x32_bf16 v[40:43], a[100:103], v[68:71], v[40:43]
  ds_read_b64_tr_b16 v[90:91], v108 offset:35328
  v_exp_f32_e64 v119, v119 clamp
  v_max_f32 v7, s12, v7
  v_mfma_f32_16x16x32_bf16 v[44:47], a[96:99], v[72:75], v[44:47]
  ds_read_b64_tr_b16 v[92:93], v107 offset:43008
  v_mfma_f32_16x16x32_bf16 v[48:51], a[100:103], v[72:75], v[48:51]
  ds_read_b64_tr_b16 v[94:95], v107 offset:43520
  v_exp_f32_e64 v120, v120 clamp
  v_max_f32 v8, s12, v8
  s_waitcnt lgkmcnt(6)
  v_mfma_f32_16x16x32_bf16 v[36:39], a[104:107], v[76:79], v[36:39]
  ds_read_b64_tr_b16 v[96:97], v108 offset:43008
  v_mfma_f32_16x16x32_bf16 v[40:43], a[108:111], v[76:79], v[40:43]
  ds_read_b64_tr_b16 v[98:99], v108 offset:43520
  v_exp_f32_e64 v121, v121 clamp
  v_max_f32 v9, s12, v9
  v_mfma_f32_16x16x32_bf16 v[44:47], a[104:107], v[80:83], v[44:47]
  ds_read_b64_tr_b16 v[68:69], v109 offset:18432
  v_mfma_f32_16x16x32_bf16 v[48:51], a[108:111], v[80:83], v[48:51]
  ds_read_b64_tr_b16 v[70:71], v109 offset:18944
  v_exp_f32_e64 v122, v122 clamp
  v_max_f32 v10, s12, v10
  s_waitcnt lgkmcnt(6)
  v_mfma_f32_16x16x32_bf16 v[36:39], a[112:115], v[84:87], v[36:39]
  ds_read_b64_tr_b16 v[72:73], v110 offset:18432
  v_mfma_f32_16x16x32_bf16 v[40:43], a[116:119], v[84:87], v[40:43]
  ds_read_b64_tr_b16 v[74:75], v110 offset:18944
  v_exp_f32_e64 v123, v123 clamp
  v_max_f32 v11, s12, v11
  v_add_f32 v4, v4, v116
  v_mfma_f32_16x16x32_bf16 v[44:47], a[112:115], v[88:91], v[44:47]
  ds_read_b64_tr_b16 v[76:77], v109 offset:26624
  v_mfma_f32_16x16x32_bf16 v[48:51], a[116:119], v[88:91], v[48:51]
  ds_read_b64_tr_b16 v[78:79], v109 offset:27136
  v_add_f32 v5, v5, v117
  v_add_f32 v6, v6, v118
  v_add_f32 v7, v7, v119
  v_add_f32 v8, v8, v120
  s_waitcnt lgkmcnt(6)
  v_mfma_f32_16x16x32_bf16 v[36:39], a[120:123], v[92:95], v[36:39]
  ds_read_b64_tr_b16 v[80:81], v110 offset:26624
  v_mfma_f32_16x16x32_bf16 v[40:43], a[124:127], v[92:95], v[40:43]
  ds_read_b64_tr_b16 v[82:83], v110 offset:27136
  v_add_f32 v9, v9, v121
  v_add_f32 v10, v10, v122
  v_add_f32 v11, v11, v123
  v_cvt_pk_bf16_f32 v4, v4, v5
  v_mfma_f32_16x16x32_bf16 v[44:47], a[120:123], v[96:99], v[44:47]
  ds_read_b64_tr_b16 v[84:85], v109 offset:34816
  v_mfma_f32_16x16x32_bf16 v[48:51], a[124:127], v[96:99], v[48:51]
  ds_read_b64_tr_b16 v[86:87], v109 offset:35328
  v_cvt_pk_bf16_f32 v5, v6, v7
  v_cvt_pk_bf16_f32 v6, v8, v9
  v_cvt_pk_bf16_f32 v7, v10, v11
  v_cvt_pk_bf16_f32 v116, v12, v13
  s_waitcnt lgkmcnt(6)
  v_mfma_f32_16x16x32_bf16 v[52:55], a[96:99], v[68:71], v[52:55]
  ds_read_b64_tr_b16 v[88:89], v110 offset:34816
  v_mfma_f32_16x16x32_bf16 v[56:59], a[100:103], v[68:71], v[56:59]
  ds_read_b64_tr_b16 v[90:91], v110 offset:35328
  v_cvt_pk_bf16_f32 v118, v14, v15
  v_cvt_pk_bf16_f32 v120, v16, v17
  v_cvt_pk_bf16_f32 v122, v18, v19
  v_lshlrev_b32 v12, 16, v116
  v_mfma_f32_16x16x32_bf16 v[60:63], a[96:99], v[72:75], v[60:63]
  ds_read_b64_tr_b16 v[92:93], v109 offset:43008
  v_mfma_f32_16x16x32_bf16 v[64:67], a[100:103], v[72:75], v[64:67]
  ds_read_b64_tr_b16 v[94:95], v109 offset:43520
  v_and_b32 v13, 0xffff0000, v116
  v_lshlrev_b32 v14, 16, v118
  v_and_b32 v15, 0xffff0000, v118
  v_lshlrev_b32 v16, 16, v120
  s_waitcnt lgkmcnt(6)
  v_mfma_f32_16x16x32_bf16 v[52:55], a[104:107], v[76:79], v[52:55]
  ds_read_b64_tr_b16 v[96:97], v110 offset:43008
  v_mfma_f32_16x16x32_bf16 v[56:59], a[108:111], v[76:79], v[56:59]
  ds_read_b64_tr_b16 v[98:99], v110 offset:43520
  v_and_b32 v17, 0xffff0000, v120
  v_lshlrev_b32 v18, 16, v122
  v_and_b32 v19, 0xffff0000, v122
  v_pk_mul_f32 v[116:117], v[12:13], s[10:11]
  v_mfma_f32_16x16x32_bf16 v[60:63], a[104:107], v[80:83], v[60:63]
  v_mfma_f32_16x16x32_bf16 v[64:67], a[108:111], v[80:83], v[64:67]
  v_pk_mul_f32 v[118:119], v[14:15], s[10:11]
  v_pk_mul_f32 v[120:121], v[16:17], s[10:11]
  v_pk_mul_f32 v[122:123], v[18:19], s[10:11]
  s_waitcnt lgkmcnt(4)
  v_mfma_f32_16x16x32_bf16 v[52:55], a[112:115], v[84:87], v[52:55]
  v_mfma_f32_16x16x32_bf16 v[56:59], a[116:119], v[84:87], v[56:59]
  v_exp_f32_e64 v116, v116 clamp
  v_max_f32 v12, s12, v12
  v_mfma_f32_16x16x32_bf16 v[60:63], a[112:115], v[88:91], v[60:63]
  v_mfma_f32_16x16x32_bf16 v[64:67], a[116:119], v[88:91], v[64:67]
  v_exp_f32_e64 v117, v117 clamp
  v_max_f32 v13, s12, v13
  s_waitcnt lgkmcnt(0)
  v_mfma_f32_16x16x32_bf16 v[52:55], a[120:123], v[92:95], v[52:55]
  v_mfma_f32_16x16x32_bf16 v[56:59], a[124:127], v[92:95], v[56:59]
  v_exp_f32_e64 v118, v118 clamp
  v_max_f32 v14, s12, v14
  v_mfma_f32_16x16x32_bf16 v[60:63], a[120:123], v[96:99], v[60:63]
  v_mfma_f32_16x16x32_bf16 v[64:67], a[124:127], v[96:99], v[64:67]
  v_exp_f32_e64 v119, v119 clamp
  v_max_f32 v15, s12, v15
  s_barrier
  s_waitcnt vmcnt(0)
  v_cmp_eq_u32 vcc, 0, v115
  s_cbranch_vccnz L_slow_KVC_nonce
L_back_KVC_nonce:
  v_exp_f32_e64 v120, v120 clamp
  v_max_f32 v16, s12, v16
  v_exp_f32_e64 v121, v121 clamp
  v_max_f32 v17, s12, v17
  v_exp_f32_e64 v122, v122 clamp
  v_max_f32 v18, s12, v18
  v_exp_f32_e64 v123, v123 clamp
  v_max_f32 v19, s12, v19
  v_add_f32 v12, v12, v116
  v_add_f32 v13, v13, v117
  v_add_f32 v14, v14, v118
  v_add_f32 v15, v15, v119
  v_add_f32 v16, v16, v120
  v_add_f32 v17, v17, v121
  v_add_f32 v18, v18, v122
  v_add_f32 v19, v19, v123
  v_cvt_pk_bf16_f32 v8, v12, v13
  v_cvt_pk_bf16_f32 v9, v14, v15
  v_cvt_pk_bf16_f32 v10, v16, v17
  v_cvt_pk_bf16_f32 v11, v18, v19
  v_cvt_pk_bf16_f32 v116, v20, v21
  v_cvt_pk_bf16_f32 v118, v22, v23
  v_cvt_pk_bf16_f32 v120, v24, v25
  v_cvt_pk_bf16_f32 v122, v26, v27
  v_lshlrev_b32 v20, 16, v116
  v_and_b32 v21, 0xffff0000, v116
  v_lshlrev_b32 v22, 16, v118
  v_and_b32 v23, 0xffff0000, v118
  v_lshlrev_b32 v24, 16, v120
  v_and_b32 v25, 0xffff0000, v120
  v_lshlrev_b32 v26, 16, v122
  v_and_b32 v27, 0xffff0000, v122
  v_pk_mul_f32 v[116:117], v[20:21], s[10:11]
  v_pk_mul_f32 v[118:119], v[22:23], s[10:11]
  v_pk_mul_f32 v[120:121], v[24:25], s[10:11]
  v_pk_mul_f32 v[122:123], v[26:27], s[10:11]
  v_exp_f32_e64 v116, v116 clamp
  v_max_f32 v20, s12, v20
  v_exp_f32_e64 v117, v117 clamp
  v_max_f32 v21, s12, v21
  v_exp_f32_e64 v118, v118 clamp
  v_max_f32 v22, s12, v22
  v_exp_f32_e64 v119, v119 clamp
  v_max_f32 v23, s12, v23
  v_exp_f32_e64 v120, v120 clamp
  v_max_f32 v24, s12, v24
  v_exp_f32_e64 v121, v121 clamp
  v_max_f32 v25, s12, v25
  v_exp_f32_e64 v122, v122 clamp
  v_max_f32 v26, s12, v26
  v_exp_f32_e64 v123, v123 clamp
  v_max_f32 v27, s12, v27
  v_add_f32 v20, v20, v116
  v_add_f32 v21, v21, v117
  v_add_f32 v22, v22, v118
  v_add_f32 v23, v23, v119
  v_add_f32 v24, v24, v120
  v_add_f32 v25, v25, v121
  v_add_f32 v26, v26, v122
  v_add_f32 v27, v27, v123
  v_cvt_pk_bf16_f32 v12, v20, v21
  v_cvt_pk_bf16_f32 v13, v22, v23
  v_cvt_pk_bf16_f32 v14, v24, v25
  v_cvt_pk_bf16_f32 v15, v26, v27
  v_cvt_pk_bf16_f32 v116, v28, v29
  v_cvt_pk_bf16_f32 v118, v30, v31
  v_cvt_pk_bf16_f32 v120, v32, v33
  v_cvt_pk_bf16_f32 v122, v34, v35
  v_lshlrev_b32 v28, 16, v116
  v_and_b32 v29, 0xffff0000, v116
  v_lshlrev_b32 v30, 16, v118
  v_and_b32 v31, 0xffff0000, v118
  v_lshlrev_b32 v32, 16, v120
  v_and_b32 v33, 0xffff0000, v120
  v_lshlrev_b32 v34, 16, v122
  v_and_b32 v35, 0xffff0000, v122
  v_pk_mul_f32 v[116:117], v[28:29], s[10:11]
  v_pk_mul_f32 v[118:119], v[30:31], s[10:11]
  v_pk_mul_f32 v[120:121], v[32:33], s[10:11]
  v_pk_mul_f32 v[122:123], v[34:35], s[10:11]
  v_exp_f32_e64 v116, v116 clamp
  v_max_f32 v28, s12, v28
  v_exp_f32_e64 v117, v117 clamp
  v_max_f32 v29, s12, v29
  v_exp_f32_e64 v118, v118 clamp
  v_max_f32 v30, s12, v30
  v_exp_f32_e64 v119, v119 clamp
  v_max_f32 v31, s12, v31
  v_exp_f32_e64 v120, v120 clamp
  v_max_f32 v32, s12, v32
  v_exp_f32_e64 v121, v121 clamp
  v_max_f32 v33, s12, v33
  v_exp_f32_e64 v122, v122 clamp
  v_max_f32 v34, s12, v34
  v_exp_f32_e64 v123, v123 clamp
  v_max_f32 v35, s12, v35
  v_add_f32 v28, v28, v116
  v_add_f32 v29, v29, v117
  v_add_f32 v30, v30, v118
  v_add_f32 v31, v31, v119
  v_add_f32 v32, v32, v120
  v_add_f32 v33, v33, v121
  v_add_f32 v34, v34, v122
  v_add_f32 v35, v35, v123
  v_cvt_pk_bf16_f32 v16, v28, v29
  v_cvt_pk_bf16_f32 v17, v30, v31
  v_cvt_pk_bf16_f32 v18, v32, v33
  v_cvt_pk_bf16_f32 v19, v34, v35
  v_cvt_pk_bf16_f32 v36, v36, v37
  v_cvt_pk_bf16_f32 v37, v38, v39
  v_cvt_pk_bf16_f32 v38, v40, v41
  v_cvt_pk_bf16_f32 v39, v42, v43
  v_cvt_pk_bf16_f32 v40, v44, v45
  v_cvt_pk_bf16_f32 v41, v46, v47
  v_cvt_pk_bf16_f32 v42, v48, v49
  v_cvt_pk_bf16_f32 v43, v50, v51
  v_mfma_f32_16x16x32_bf16 v[68:71], v[4:7], v[36:39], 0
  v_cvt_pk_bf16_f32 v44, v52, v53
  v_cvt_pk_bf16_f32 v45, v54, v55
  v_cvt_pk_bf16_f32 v46, v56, v57
  v_cvt_pk_bf16_f32 v47, v58, v59
  v_mfma_f32_16x16x32_bf16 v[72:75], v[8:11], v[40:43], 0
  v_cvt_pk_bf16_f32 v48, v60, v61
  v_cvt_pk_bf16_f32 v49, v62, v63
  v_cvt_pk_bf16_f32 v50, v64, v65
  v_cvt_pk_bf16_f32 v51, v66, v67
  v_mfma_f32_16x16x32_bf16 v[76:79], v[12:15], v[44:47], 0
  v_dot2_f32_bf16 v20, v4, s13, 0
  v_dot2_f32_bf16 v21, v8, s13, 0
  v_dot2_f32_bf16 v22, v12, s13, 0
  v_dot2_f32_bf16 v23, v16, s13, 0
  v_mfma_f32_16x16x32_bf16 v[80:83], v[16:19], v[48:51], 0
  v_dot2_f32_bf16 v20, v5, s13, v20
  v_dot2_f32_bf16 v21, v9, s13, v21
  v_dot2_f32_bf16 v22, v13, s13, v22
  v_dot2_f32_bf16 v23, v17, s13, v23
  v_dot2_f32_bf16 v20, v6, s13, v20
  v_dot2_f32_bf16 v21, v10, s13, v21
  v_dot2_f32_bf16 v22, v14, s13, v22
  v_dot2_f32_bf16 v23, v18, s13, v23
  v_dot2_f32_bf16 v20, v7, s13, v20
  v_dot2_f32_bf16 v21, v11, s13, v21
  v_dot2_f32_bf16 v22, v15, s13, v22
  v_dot2_f32_bf16 v23, v19, s13, v23
  ds_write_b128 v114, v[68:71] offset:0
  ds_write_b128 v114, v[72:75] offset:1024
  ds_write_b128 v114, v[76:79] offset:2048
  ds_write_b128 v114, v[80:83] offset:3072
  s_mul_i32 s62, s52, -3072
  s_add_u32 s62, s62, 16384
  v_add_u32 v114, s62, v114
  ds_write_b128 v114, v[20:23]
  s_waitcnt lgkmcnt(0)
  s_barrier
  v_lshrrev_b32 v100, 5, v1
  v_mul_u32_u24 v101, 1024, v100
  v_sub_u32 v107, v107, v101
  v_sub_u32 v108, v108, v101
  v_sub_u32 v109, v109, v101
  v_sub_u32 v110, v110, v101
  v_mul_u32_u24 v105, 3072, v100
  v_bfe_u32 v100, v1, 4, 1
  v_lshl_add_u32 v105, v100, 9, v105
  v_lshl_add_u32 v105, v100, 5, v105
  v_bfe_u32 v100, v1, 2, 2
  v_lshl_add_u32 v105, v100, 6, v105
  v_and_b32 v100, 3, v1
  v_lshl_add_u32 v105, v100, 3, v105
  v_add_u32 v105, 2048, v105
  v_xor_b32 v106, 32, v105
  v_add_u32 v107, 4294901760, v107
  ds_read_b64_tr_b16 v[68:69], v107 offset:32768
  ds_read_b64_tr_b16 v[70:71], v107 offset:33280
  v_add_u32 v108, 4294901760, v108
  ds_read_b64_tr_b16 v[72:73], v108 offset:32768
  ds_read_b64_tr_b16 v[74:75], v108 offset:33280
  v_add_u32 v109, 4294901760, v109
  ds_read_b64_tr_b16 v[76:77], v109 offset:32768
  ds_read_b64_tr_b16 v[78:79], v109 offset:33280
  v_add_u32 v110, 4294901760, v110
  ds_read_b64_tr_b16 v[80:81], v110 offset:32768
  ds_read_b64_tr_b16 v[82:83], v110 offset:33280
  ds_read_b64_tr_b16 v[84:85], v105 offset:32768
  ds_read_b64_tr_b16 v[86:87], v105 offset:33024
  s_waitcnt lgkmcnt(6)
  v_mfma_f32_16x16x32_bf16 v[4:7], v[68:71], a[0:3], 0
  ds_read_b64_tr_b16 v[88:89], v106 offset:32768
  v_mfma_f32_16x16x32_bf16 v[12:15], v[68:71], a[4:7], 0
  ds_read_b64_tr_b16 v[90:91], v106 offset:33024
  v_mfma_f32_16x16x32_bf16 v[8:11], v[72:75], a[0:3], 0
  ds_read_b64_tr_b16 v[92:93], v107 offset:38912
  v_mfma_f32_16x16x32_bf16 v[16:19], v[72:75], a[4:7], 0
  ds_read_b64_tr_b16 v[94:95], v107 offset:39424
  s_waitcnt lgkmcnt(6)
  v_mfma_f32_16x16x32_bf16 v[20:23], v[76:79], a[0:3], 0
  ds_read_b64_tr_b16 v[96:97], v108 offset:38912
  v_mfma_f32_16x16x32_bf16 v[28:31], v[76:79], a[4:7], 0
  ds_read_b64_tr_b16 v[98:99], v108 offset:39424
  v_mfma_f32_16x16x32_bf16 v[24:27], v[80:83], a[0:3], 0
  ds_read_b64_tr_b16 v[68:69], v109 offset:38912
  v_mfma_f32_16x16x32_bf16 v[32:35], v[80:83], a[4:7], 0
  ds_read_b64_tr_b16 v[70:71], v109 offset:39424
  s_waitcnt lgkmcnt(6)
  v_mfma_f32_16x16x32_bf16 v[36:39], v[84:87], a[0:3], 0
  ds_read_b64_tr_b16 v[72:73], v110 offset:38912
  v_mfma_f32_16x16x32_bf16 v[44:47], v[84:87], a[4:7], 0
  ds_read_b64_tr_b16 v[74:75], v110 offset:39424
  v_mfma_f32_16x16x32_bf16 v[40:43], v[88:91], a[0:3], 0
  ds_read_b64_tr_b16 v[76:77], v105 offset:38912
  v_mfma_f32_16x16x32_bf16 v[48:51], v[88:91], a[4:7], 0
  ds_read_b64_tr_b16 v[78:79], v105 offset:39168
  s_waitcnt lgkmcnt(6)
  v_mfma_f32_16x16x32_bf16 v[4:7], v[92:95], a[8:11], v[4:7]
  ds_read_b64_tr_b16 v[80:81], v106 offset:38912
  v_mfma_f32_16x16x32_bf16 v[12:15], v[92:95], a[12:15], v[12:15]
  ds_read_b64_tr_b16 v[82:83], v106 offset:39168
  v_mfma_f32_16x16x32_bf16 v[8:11], v[96:99], a[8:11], v[8:11]
  ds_read_b64_tr_b16 v[84:85], v107 offset:45056
  v_mfma_f32_16x16x32_bf16 v[16:19], v[96:99], a[12:15], v[16:19]
  ds_read_b64_tr_b16 v[86:87], v107 offset:45568
  s_waitcnt lgkmcnt(6)
  v_mfma_f32_16x16x32_bf16 v[20:23], v[68:71], a[8:11], v[20:23]
  ds_read_b64_tr_b16 v[88:89], v108 offset:45056
  v_mfma_f32_16x16x32_bf16 v[28:31], v[68:71], a[12:15], v[28:31]
  ds_read_b64_tr_b16 v[90:91], v108 offset:45568
  v_mfma_f32_16x16x32_bf16 v[24:27], v[72:75], a[8:11], v[24:27]
  ds_read_b64_tr_b16 v[92:93], v109 offset:45056
  v_mfma_f32_16x16x32_bf16 v[32:35], v[72:75], a[12:15], v[32:35]
  ds_read_b64_tr_b16 v[94:95], v109 offset:45568
  s_waitcnt lgkmcnt(6)
  v_mfma_f32_16x16x32_bf16 v[36:39], v[76:79], a[8:11], v[36:39]
  ds_read_b64_tr_b16 v[96:97], v110 offset:45056
  v_mfma_f32_16x16x32_bf16 v[44:47], v[76:79], a[12:15], v[44:47]
  ds_read_b64_tr_b16 v[98:99], v110 offset:45568
  v_mfma_f32_16x16x32_bf16 v[40:43], v[80:83], a[8:11], v[40:43]
  ds_read_b64_tr_b16 v[68:69], v105 offset:45056
  v_mfma_f32_16x16x32_bf16 v[48:51], v[80:83], a[12:15], v[48:51]
  ds_read_b64_tr_b16 v[70:71], v105 offset:45312
  s_waitcnt lgkmcnt(6)
  v_mfma_f32_16x16x32_bf16 v[4:7], v[84:87], a[16:19], v[4:7]
  ds_read_b64_tr_b16 v[72:73], v106 offset:45056
  v_mfma_f32_16x16x32_bf16 v[12:15], v[84:87], a[20:23], v[12:15]
  ds_read_b64_tr_b16 v[74:75], v106 offset:45312
  v_mfma_f32_16x16x32_bf16 v[8:11], v[88:91], a[16:19], v[8:11]
  ds_read_b64_tr_b16 v[76:77], v107 offset:51200
  v_mfma_f32_16x16x32_bf16 v[16:19], v[88:91], a[20:23], v[16:19]
  ds_read_b64_tr_b16 v[78:79], v107 offset:51712
  s_waitcnt lgkmcnt(6)
  v_mfma_f32_16x16x32_bf16 v[20:23], v[92:95], a[16:19], v[20:23]
  ds_read_b64_tr_b16 v[80:81], v108 offset:51200
  v_mfma_f32_16x16x32_bf16 v[28:31], v[92:95], a[20:23], v[28:31]
  ds_read_b64_tr_b16 v[82:83], v108 offset:51712
  v_mfma_f32_16x16x32_bf16 v[24:27], v[96:99], a[16:19], v[24:27]
  ds_read_b64_tr_b16 v[84:85], v109 offset:51200
  v_mfma_f32_16x16x32_bf16 v[32:35], v[96:99], a[20:23], v[32:35]
  ds_read_b64_tr_b16 v[86:87], v109 offset:51712
  s_waitcnt lgkmcnt(6)
  v_mfma_f32_16x16x32_bf16 v[36:39], v[68:71], a[16:19], v[36:39]
  ds_read_b64_tr_b16 v[88:89], v110 offset:51200
  v_mfma_f32_16x16x32_bf16 v[44:47], v[68:71], a[20:23], v[44:47]
  ds_read_b64_tr_b16 v[90:91], v110 offset:51712
  v_mfma_f32_16x16x32_bf16 v[40:43], v[72:75], a[16:19], v[40:43]
  ds_read_b64_tr_b16 v[92:93], v105 offset:51200
  v_mfma_f32_16x16x32_bf16 v[48:51], v[72:75], a[20:23], v[48:51]
  ds_read_b64_tr_b16 v[94:95], v105 offset:51456
  s_waitcnt lgkmcnt(6)
  v_mfma_f32_16x16x32_bf16 v[4:7], v[76:79], a[24:27], v[4:7]
  ds_read_b64_tr_b16 v[96:97], v106 offset:51200
  v_mfma_f32_16x16x32_bf16 v[12:15], v[76:79], a[28:31], v[12:15]
  ds_read_b64_tr_b16 v[98:99], v106 offset:51456
  v_mfma_f32_16x16x32_bf16 v[8:11], v[80:83], a[24:27], v[8:11]
  v_add_u32 v107, 65536, v107
  ds_read_b64_tr_b16 v[68:69], v107 offset:49152
  v_mfma_f32_16x16x32_bf16 v[16:19], v[80:83], a[28:31], v[16:19]
  ds_read_b64_tr_b16 v[70:71], v107 offset:49664
  s_waitcnt lgkmcnt(6)
  v_mfma_f32_16x16x32_bf16 v[20:23], v[84:87], a[24:27], v[20:23]
  v_add_u32 v108, 65536, v108
  ds_read_b64_tr_b16 v[72:73], v108 offset:49152
  v_mfma_f32_16x16x32_bf16 v[28:31], v[84:87], a[28:31], v[28:31]
  ds_read_b64_tr_b16 v[74:75], v108 offset:49664
  v_mfma_f32_16x16x32_bf16 v[24:27], v[88:91], a[24:27], v[24:27]
  v_add_u32 v109, 65536, v109
  ds_read_b64_tr_b16 v[76:77], v109 offset:49152
  v_mfma_f32_16x16x32_bf16 v[32:35], v[88:91], a[28:31], v[32:35]
  ds_read_b64_tr_b16 v[78:79], v109 offset:49664
  s_waitcnt lgkmcnt(6)
  v_mfma_f32_16x16x32_bf16 v[36:39], v[92:95], a[24:27], v[36:39]
  v_add_u32 v110, 65536, v110
  ds_read_b64_tr_b16 v[80:81], v110 offset:49152
  v_mfma_f32_16x16x32_bf16 v[44:47], v[92:95], a[28:31], v[44:47]
  ds_read_b64_tr_b16 v[82:83], v110 offset:49664
  v_mfma_f32_16x16x32_bf16 v[40:43], v[96:99], a[24:27], v[40:43]
  v_add_u32 v105, 65536, v105
  ds_read_b64_tr_b16 v[84:85], v105 offset:49152
  v_mfma_f32_16x16x32_bf16 v[48:51], v[96:99], a[28:31], v[48:51]
  ds_read_b64_tr_b16 v[86:87], v105 offset:49408
  s_waitcnt lgkmcnt(6)
  v_mfma_f32_16x16x32_bf16 v[4:7], v[68:71], a[32:35], v[4:7]
  v_add_u32 v106, 65536, v106
  ds_read_b64_tr_b16 v[88:89], v106 offset:49152
  v_mfma_f32_16x16x32_bf16 v[12:15], v[68:71], a[36:39], v[12:15]
  ds_read_b64_tr_b16 v[90:91], v106 offset:49408
  v_mfma_f32_16x16x32_bf16 v[8:11], v[72:75], a[32:35], v[8:11]
  ds_read_b64_tr_b16 v[92:93], v107 offset:55296
  v_mfma_f32_16x16x32_bf16 v[16:19], v[72:75], a[36:39], v[16:19]
  ds_read_b64_tr_b16 v[94:95], v107 offset:55808
  s_waitcnt lgkmcnt(6)
  v_mfma_f32_16x16x32_bf16 v[20:23], v[76:79], a[32:35], v[20:23]
  ds_read_b64_tr_b16 v[96:97], v108 offset:55296
  v_mfma_f32_16x16x32_bf16 v[28:31], v[76:79], a[36:39], v[28:31]
  ds_read_b64_tr_b16 v[98:99], v108 offset:55808
  v_mfma_f32_16x16x32_bf16 v[24:27], v[80:83], a[32:35], v[24:27]
  ds_read_b64_tr_b16 v[68:69], v109 offset:55296
  v_mfma_f32_16x16x32_bf16 v[32:35], v[80:83], a[36:39], v[32:35]
  ds_read_b64_tr_b16 v[70:71], v109 offset:55808
  s_waitcnt lgkmcnt(6)
  v_mfma_f32_16x16x32_bf16 v[36:39], v[84:87], a[32:35], v[36:39]
  ds_read_b64_tr_b16 v[72:73], v110 offset:55296
  v_mfma_f32_16x16x32_bf16 v[44:47], v[84:87], a[36:39], v[44:47]
  ds_read_b64_tr_b16 v[74:75], v110 offset:55808
  v_mfma_f32_16x16x32_bf16 v[40:43], v[88:91], a[32:35], v[40:43]
  ds_read_b64_tr_b16 v[76:77], v105 offset:55296
  v_mfma_f32_16x16x32_bf16 v[48:51], v[88:91], a[36:39], v[48:51]
  ds_read_b64_tr_b16 v[78:79], v105 offset:55552
  s_waitcnt lgkmcnt(6)
  v_mfma_f32_16x16x32_bf16 v[4:7], v[92:95], a[40:43], v[4:7]
  ds_read_b64_tr_b16 v[80:81], v106 offset:55296
  v_mfma_f32_16x16x32_bf16 v[12:15], v[92:95], a[44:47], v[12:15]
  ds_read_b64_tr_b16 v[82:83], v106 offset:55552
  v_mfma_f32_16x16x32_bf16 v[8:11], v[96:99], a[40:43], v[8:11]
  v_add_u32 v107, 4294901760, v107
  ds_read_b64_tr_b16 v[84:85], v107 offset:57344
  v_mfma_f32_16x16x32_bf16 v[16:19], v[96:99], a[44:47], v[16:19]
  ds_read_b64_tr_b16 v[86:87], v107 offset:57856
  s_waitcnt lgkmcnt(6)
  v_mfma_f32_16x16x32_bf16 v[20:23], v[68:71], a[40:43], v[20:23]
  v_add_u32 v108, 4294901760, v108
  ds_read_b64_tr_b16 v[88:89], v108 offset:57344
  v_mfma_f32_16x16x32_bf16 v[28:31], v[68:71], a[44:47], v[28:31]
  ds_read_b64_tr_b16 v[90:91], v108 offset:57856
  v_mfma_f32_16x16x32_bf16 v[24:27], v[72:75], a[40:43], v[24:27]
  v_add_u32 v109, 4294901760, v109
  ds_read_b64_tr_b16 v[92:93], v109 offset:57344
  v_mfma_f32_16x16x32_bf16 v[32:35], v[72:75], a[44:47], v[32:35]
  ds_read_b64_tr_b16 v[94:95], v109 offset:57856
  s_waitcnt lgkmcnt(6)
  v_mfma_f32_16x16x32_bf16 v[36:39], v[76:79], a[40:43], v[36:39]
  v_add_u32 v110, 4294901760, v110
  ds_read_b64_tr_b16 v[96:97], v110 offset:57344
  v_mfma_f32_16x16x32_bf16 v[44:47], v[76:79], a[44:47], v[44:47]
  ds_read_b64_tr_b16 v[98:99], v110 offset:57856
  v_mfma_f32_16x16x32_bf16 v[40:43], v[80:83], a[40:43], v[40:43]
  v_add_u32 v105, 4294901760, v105
  ds_read_b64_tr_b16 v[68:69], v105 offset:57344
  v_mfma_f32_16x16x32_bf16 v[48:51], v[80:83], a[44:47], v[48:51]
  ds_read_b64_tr_b16 v[70:71], v105 offset:57600
  s_waitcnt lgkmcnt(6)
  v_mfma_f32_16x16x32_bf16 v[4:7], v[84:87], a[48:51], v[4:7]
  v_add_u32 v106, 4294901760, v106
  ds_read_b64_tr_b16 v[72:73], v106 offset:57344
  v_mfma_f32_16x16x32_bf16 v[12:15], v[84:87], a[52:55], v[12:15]
  ds_read_b64_tr_b16 v[74:75], v106 offset:57600
  v_mfma_f32_16x16x32_bf16 v[8:11], v[88:91], a[48:51], v[8:11]
  ds_read_b64_tr_b16 v[76:77], v107 offset:63488
  v_mfma_f32_16x16x32_bf16 v[16:19], v[88:91], a[52:55], v[16:19]
  ds_read_b64_tr_b16 v[78:79], v107 offset:64000
  s_waitcnt lgkmcnt(6)
  v_mfma_f32_16x16x32_bf16 v[20:23], v[92:95], a[48:51], v[20:23]
  ds_read_b64_tr_b16 v[80:81], v108 offset:63488
  v_mfma_f32_16x16x32_bf16 v[28:31], v[92:95], a[52:55], v[28:31]
  ds_read_b64_tr_b16 v[82:83], v108 offset:64000
  v_mfma_f32_16x16x32_bf16 v[24:27], v[96:99], a[48:51], v[24:27]
  ds_read_b64_tr_b16 v[84:85], v109 offset:63488
  v_mfma_f32_16x16x32_bf16 v[32:35], v[96:99], a[52:55], v[32:35]
  ds_read_b64_tr_b16 v[86:87], v109 offset:64000
  s_waitcnt lgkmcnt(6)
  v_mfma_f32_16x16x32_bf16 v[36:39], v[68:71], a[48:51], v[36:39]
  ds_read_b64_tr_b16 v[88:89], v110 offset:63488
  v_mfma_f32_16x16x32_bf16 v[44:47], v[68:71], a[52:55], v[44:47]
  ds_read_b64_tr_b16 v[90:91], v110 offset:64000
  v_mfma_f32_16x16x32_bf16 v[40:43], v[72:75], a[48:51], v[40:43]
  ds_read_b64_tr_b16 v[92:93], v105 offset:63488
  v_mfma_f32_16x16x32_bf16 v[48:51], v[72:75], a[52:55], v[48:51]
  ds_read_b64_tr_b16 v[94:95], v105 offset:63744
  s_waitcnt lgkmcnt(6)
  v_mfma_f32_16x16x32_bf16 v[4:7], v[76:79], a[56:59], v[4:7]
  ds_read_b64_tr_b16 v[96:97], v106 offset:63488
  v_mfma_f32_16x16x32_bf16 v[12:15], v[76:79], a[60:63], v[12:15]
  ds_read_b64_tr_b16 v[98:99], v106 offset:63744
  v_mfma_f32_16x16x32_bf16 v[8:11], v[80:83], a[56:59], v[8:11]
  s_barrier
  v_add_u32 v107, 65536, v107
  ds_read_b64_tr_b16 v[68:69], v107 offset:4096
  v_mfma_f32_16x16x32_bf16 v[16:19], v[80:83], a[60:63], v[16:19]
  ds_read_b64_tr_b16 v[70:71], v107 offset:4608
  s_waitcnt lgkmcnt(6)
  v_mfma_f32_16x16x32_bf16 v[20:23], v[84:87], a[56:59], v[20:23]
  v_add_u32 v108, 65536, v108
  ds_read_b64_tr_b16 v[72:73], v108 offset:4096
  v_mfma_f32_16x16x32_bf16 v[28:31], v[84:87], a[60:63], v[28:31]
  ds_read_b64_tr_b16 v[74:75], v108 offset:4608
  v_mfma_f32_16x16x32_bf16 v[24:27], v[88:91], a[56:59], v[24:27]
  v_add_u32 v109, 65536, v109
  ds_read_b64_tr_b16 v[76:77], v109 offset:4096
  v_mfma_f32_16x16x32_bf16 v[32:35], v[88:91], a[60:63], v[32:35]
  ds_read_b64_tr_b16 v[78:79], v109 offset:4608
  s_waitcnt lgkmcnt(6)
  v_mfma_f32_16x16x32_bf16 v[36:39], v[92:95], a[56:59], v[36:39]
  v_add_u32 v110, 65536, v110
  ds_read_b64_tr_b16 v[80:81], v110 offset:4096
  v_mfma_f32_16x16x32_bf16 v[44:47], v[92:95], a[60:63], v[44:47]
  ds_read_b64_tr_b16 v[82:83], v110 offset:4608
  v_mfma_f32_16x16x32_bf16 v[40:43], v[96:99], a[56:59], v[40:43]
  v_add_u32 v105, 65536, v105
  ds_read_b64_tr_b16 v[84:85], v105 offset:4096
  v_mfma_f32_16x16x32_bf16 v[48:51], v[96:99], a[60:63], v[48:51]
  ds_read_b64_tr_b16 v[86:87], v105 offset:4352
  s_waitcnt lgkmcnt(6)
  v_mfma_f32_16x16x32_bf16 v[4:7], v[68:71], a[64:67], v[4:7]
  v_add_u32 v106, 65536, v106
  ds_read_b64_tr_b16 v[88:89], v106 offset:4096
  v_mfma_f32_16x16x32_bf16 v[12:15], v[68:71], a[68:71], v[12:15]
  ds_read_b64_tr_b16 v[90:91], v106 offset:4352
  v_mfma_f32_16x16x32_bf16 v[8:11], v[72:75], a[64:67], v[8:11]
  ds_read_b64_tr_b16 v[92:93], v107 offset:10240
  v_mfma_f32_16x16x32_bf16 v[16:19], v[72:75], a[68:71], v[16:19]
  ds_read_b64_tr_b16 v[94:95], v107 offset:10752
  s_waitcnt lgkmcnt(6)
  v_mfma_f32_16x16x32_bf16 v[20:23], v[76:79], a[64:67], v[20:23]
  ds_read_b64_tr_b16 v[96:97], v108 offset:10240
  v_mfma_f32_16x16x32_bf16 v[28:31], v[76:79], a[68:71], v[28:31]
  ds_read_b64_tr_b16 v[98:99], v108 offset:10752
  v_mfma_f32_16x16x32_bf16 v[24:27], v[80:83], a[64:67], v[24:27]
  ds_read_b64_tr_b16 v[68:69], v109 offset:10240
  v_mfma_f32_16x16x32_bf16 v[32:35], v[80:83], a[68:71], v[32:35]
  ds_read_b64_tr_b16 v[70:71], v109 offset:10752
  s_waitcnt lgkmcnt(6)
  v_mfma_f32_16x16x32_bf16 v[36:39], v[84:87], a[64:67], v[36:39]
  ds_read_b64_tr_b16 v[72:73], v110 offset:10240
  v_mfma_f32_16x16x32_bf16 v[44:47], v[84:87], a[68:71], v[44:47]
  ds_read_b64_tr_b16 v[74:75], v110 offset:10752
  v_mfma_f32_16x16x32_bf16 v[40:43], v[88:91], a[64:67], v[40:43]
  ds_read_b64_tr_b16 v[76:77], v105 offset:10240
  v_mfma_f32_16x16x32_bf16 v[48:51], v[88:91], a[68:71], v[48:51]
  ds_read_b64_tr_b16 v[78:79], v105 offset:10496
  s_waitcnt lgkmcnt(6)
  v_mfma_f32_16x16x32_bf16 v[4:7], v[92:95], a[72:75], v[4:7]
  ds_read_b64_tr_b16 v[80:81], v106 offset:10240
  v_mfma_f32_16x16x32_bf16 v[12:15], v[92:95], a[76:79], v[12:15]
  ds_read_b64_tr_b16 v[82:83], v106 offset:10496
  v_mfma_f32_16x16x32_bf16 v[8:11], v[96:99], a[72:75], v[8:11]
  v_add_u32 v107, 4294901760, v107
  ds_read_b64_tr_b16 v[84:85], v107 offset:0
  v_mfma_f32_16x16x32_bf16 v[16:19], v[96:99], a[76:79], v[16:19]
  ds_read_b64_tr_b16 v[86:87], v107 offset:512
  s_waitcnt lgkmcnt(6)
  v_mfma_f32_16x16x32_bf16 v[20:23], v[68:71], a[72:75], v[20:23]
  v_add_u32 v108, 4294901760, v108
  ds_read_b64_tr_b16 v[88:89], v108 offset:0
  v_mfma_f32_16x16x32_bf16 v[28:31], v[68:71], a[76:79], v[28:31]
  ds_read_b64_tr_b16 v[90:91], v108 offset:512
  v_mfma_f32_16x16x32_bf16 v[24:27], v[72:75], a[72:75], v[24:27]
  v_add_u32 v109, 4294901760, v109
  ds_read_b64_tr_b16 v[92:93], v109 offset:0
  v_mfma_f32_16x16x32_bf16 v[32:35], v[72:75], a[76:79], v[32:35]
  ds_read_b64_tr_b16 v[94:95], v109 offset:512
  s_waitcnt lgkmcnt(6)
  v_mfma_f32_16x16x32_bf16 v[36:39], v[76:79], a[72:75], v[36:39]
  v_add_u32 v110, 4294901760, v110
  ds_read_b64_tr_b16 v[96:97], v110 offset:0
  v_mfma_f32_16x16x32_bf16 v[44:47], v[76:79], a[76:79], v[44:47]
  ds_read_b64_tr_b16 v[98:99], v110 offset:512
  v_mfma_f32_16x16x32_bf16 v[40:43], v[80:83], a[72:75], v[40:43]
  v_add_u32 v105, 4294901760, v105
  ds_read_b64_tr_b16 v[68:69], v105 offset:0
  v_mfma_f32_16x16x32_bf16 v[48:51], v[80:83], a[76:79], v[48:51]
  ds_read_b64_tr_b16 v[70:71], v105 offset:256
  s_waitcnt lgkmcnt(6)
  v_mfma_f32_16x16x32_bf16 v[4:7], v[84:87], a[80:83], v[4:7]
  v_add_u32 v106, 4294901760, v106
  ds_read_b64_tr_b16 v[72:73], v106 offset:0
  v_mfma_f32_16x16x32_bf16 v[12:15], v[84:87], a[84:87], v[12:15]
  ds_read_b64_tr_b16 v[74:75], v106 offset:256
  v_mfma_f32_16x16x32_bf16 v[8:11], v[88:91], a[80:83], v[8:11]
  ds_read_b64_tr_b16 v[76:77], v107 offset:6144
  v_mfma_f32_16x16x32_bf16 v[16:19], v[88:91], a[84:87], v[16:19]
  ds_read_b64_tr_b16 v[78:79], v107 offset:6656
  s_waitcnt lgkmcnt(6)
  v_mfma_f32_16x16x32_bf16 v[20:23], v[92:95], a[80:83], v[20:23]
  ds_read_b64_tr_b16 v[80:81], v108 offset:6144
  v_mfma_f32_16x16x32_bf16 v[28:31], v[92:95], a[84:87], v[28:31]
  ds_read_b64_tr_b16 v[82:83], v108 offset:6656
  v_mfma_f32_16x16x32_bf16 v[24:27], v[96:99], a[80:83], v[24:27]
  ds_read_b64_tr_b16 v[84:85], v109 offset:6144
  v_mfma_f32_16x16x32_bf16 v[32:35], v[96:99], a[84:87], v[32:35]
  ds_read_b64_tr_b16 v[86:87], v109 offset:6656
  s_waitcnt lgkmcnt(6)
  v_mfma_f32_16x16x32_bf16 v[36:39], v[68:71], a[80:83], v[36:39]
  ds_read_b64_tr_b16 v[88:89], v110 offset:6144
  v_mfma_f32_16x16x32_bf16 v[44:47], v[68:71], a[84:87], v[44:47]
  ds_read_b64_tr_b16 v[90:91], v110 offset:6656
  v_mfma_f32_16x16x32_bf16 v[40:43], v[72:75], a[80:83], v[40:43]
  ds_read_b64_tr_b16 v[92:93], v105 offset:6144
  v_mfma_f32_16x16x32_bf16 v[48:51], v[72:75], a[84:87], v[48:51]
  ds_read_b64_tr_b16 v[94:95], v105 offset:6400
  s_waitcnt lgkmcnt(6)
  v_mfma_f32_16x16x32_bf16 v[4:7], v[76:79], a[88:91], v[4:7]
  ds_read_b64_tr_b16 v[96:97], v106 offset:6144
  v_mfma_f32_16x16x32_bf16 v[12:15], v[76:79], a[92:95], v[12:15]
  ds_read_b64_tr_b16 v[98:99], v106 offset:6400
  v_mfma_f32_16x16x32_bf16 v[8:11], v[80:83], a[88:91], v[8:11]
  s_barrier
  ds_read_b64_tr_b16 v[68:69], v107 offset:12288
  v_mfma_f32_16x16x32_bf16 v[16:19], v[80:83], a[92:95], v[16:19]
  ds_read_b64_tr_b16 v[70:71], v107 offset:12800
  s_waitcnt lgkmcnt(6)
  v_mfma_f32_16x16x32_bf16 v[20:23], v[84:87], a[88:91], v[20:23]
  ds_read_b64_tr_b16 v[72:73], v108 offset:12288
  v_mfma_f32_16x16x32_bf16 v[28:31], v[84:87], a[92:95], v[28:31]
  ds_read_b64_tr_b16 v[74:75], v108 offset:12800
  v_mfma_f32_16x16x32_bf16 v[24:27], v[88:91], a[88:91], v[24:27]
  ds_read_b64_tr_b16 v[76:77], v109 offset:12288
  v_mfma_f32_16x16x32_bf16 v[32:35], v[88:91], a[92:95], v[32:35]
  ds_read_b64_tr_b16 v[78:79], v109 offset:12800
  s_waitcnt lgkmcnt(6)
  v_mfma_f32_16x16x32_bf16 v[36:39], v[92:95], a[88:91], v[36:39]
  ds_read_b64_tr_b16 v[80:81], v110 offset:12288
  v_mfma_f32_16x16x32_bf16 v[44:47], v[92:95], a[92:95], v[44:47]
  ds_read_b64_tr_b16 v[82:83], v110 offset:12800
  v_mfma_f32_16x16x32_bf16 v[40:43], v[96:99], a[88:91], v[40:43]
  ds_read_b64_tr_b16 v[84:85], v105 offset:12288
  v_mfma_f32_16x16x32_bf16 v[48:51], v[96:99], a[92:95], v[48:51]
  ds_read_b64_tr_b16 v[86:87], v105 offset:12544
  s_waitcnt lgkmcnt(6)
  v_mfma_f32_16x16x32_bf16 v[4:7], v[68:71], a[96:99], v[4:7]
  ds_read_b64_tr_b16 v[88:89], v106 offset:12288
  v_mfma_f32_16x16x32_bf16 v[12:15], v[68:71], a[100:103], v[12:15]
  ds_read_b64_tr_b16 v[90:91], v106 offset:12544
  v_mfma_f32_16x16x32_bf16 v[8:11], v[72:75], a[96:99], v[8:11]
  ds_read_b64_tr_b16 v[92:93], v107 offset:18432
  v_mfma_f32_16x16x32_bf16 v[16:19], v[72:75], a[100:103], v[16:19]
  ds_read_b64_tr_b16 v[94:95], v107 offset:18944
  s_waitcnt lgkmcnt(6)
  v_mfma_f32_16x16x32_bf16 v[20:23], v[76:79], a[96:99], v[20:23]
  ds_read_b64_tr_b16 v[96:97], v108 offset:18432
  v_mfma_f32_16x16x32_bf16 v[28:31], v[76:79], a[100:103], v[28:31]
  ds_read_b64_tr_b16 v[98:99], v108 offset:18944
  v_mfma_f32_16x16x32_bf16 v[24:27], v[80:83], a[96:99], v[24:27]
  ds_read_b64_tr_b16 v[68:69], v109 offset:18432
  v_mfma_f32_16x16x32_bf16 v[32:35], v[80:83], a[100:103], v[32:35]
  ds_read_b64_tr_b16 v[70:71], v109 offset:18944
  s_waitcnt lgkmcnt(6)
  v_mfma_f32_16x16x32_bf16 v[36:39], v[84:87], a[96:99], v[36:39]
  ds_read_b64_tr_b16 v[72:73], v110 offset:18432
  v_mfma_f32_16x16x32_bf16 v[44:47], v[84:87], a[100:103], v[44:47]
  ds_read_b64_tr_b16 v[74:75], v110 offset:18944
  v_mfma_f32_16x16x32_bf16 v[40:43], v[88:91], a[96:99], v[40:43]
  ds_read_b64_tr_b16 v[76:77], v105 offset:18432
  v_mfma_f32_16x16x32_bf16 v[48:51], v[88:91], a[100:103], v[48:51]
  ds_read_b64_tr_b16 v[78:79], v105 offset:18688
  s_waitcnt lgkmcnt(6)
  v_mfma_f32_16x16x32_bf16 v[4:7], v[92:95], a[104:107], v[4:7]
  ds_read_b64_tr_b16 v[80:81], v106 offset:18432
  v_mfma_f32_16x16x32_bf16 v[12:15], v[92:95], a[108:111], v[12:15]
  ds_read_b64_tr_b16 v[82:83], v106 offset:18688
  v_mfma_f32_16x16x32_bf16 v[8:11], v[96:99], a[104:107], v[8:11]
  v_add_u32 v107, 65536, v107
  ds_read_b64_tr_b16 v[84:85], v107 offset:16384
  v_mfma_f32_16x16x32_bf16 v[16:19], v[96:99], a[108:111], v[16:19]
  ds_read_b64_tr_b16 v[86:87], v107 offset:16896
  s_waitcnt lgkmcnt(6)
  v_mfma_f32_16x16x32_bf16 v[20:23], v[68:71], a[104:107], v[20:23]
  v_add_u32 v108, 65536, v108
  ds_read_b64_tr_b16 v[88:89], v108 offset:16384
  v_mfma_f32_16x16x32_bf16 v[28:31], v[68:71], a[108:111], v[28:31]
  ds_read_b64_tr_b16 v[90:91], v108 offset:16896
  v_mfma_f32_16x16x32_bf16 v[24:27], v[72:75], a[104:107], v[24:27]
  ds_read_b64_tr_b16 v[92:93], v107 offset:22528
  v_mfma_f32_16x16x32_bf16 v[32:35], v[72:75], a[108:111], v[32:35]
  ds_read_b64_tr_b16 v[94:95], v107 offset:23040
  s_waitcnt lgkmcnt(6)
  v_mfma_f32_16x16x32_bf16 v[36:39], v[76:79], a[104:107], v[36:39]
  ds_read_b64_tr_b16 v[96:97], v108 offset:22528
  v_mfma_f32_16x16x32_bf16 v[44:47], v[76:79], a[108:111], v[44:47]
  ds_read_b64_tr_b16 v[98:99], v108 offset:23040
  v_mfma_f32_16x16x32_bf16 v[40:43], v[80:83], a[104:107], v[40:43]
  v_add_u32 v109, 65536, v109
  ds_read_b64_tr_b16 v[68:69], v109 offset:16384
  v_mfma_f32_16x16x32_bf16 v[48:51], v[80:83], a[108:111], v[48:51]
  ds_read_b64_tr_b16 v[70:71], v109 offset:16896
  s_waitcnt lgkmcnt(6)
  v_mfma_f32_16x16x32_bf16 v[4:7], v[84:87], a[112:115], v[4:7]
  v_add_u32 v110, 65536, v110
  ds_read_b64_tr_b16 v[72:73], v110 offset:16384
  v_mfma_f32_16x16x32_bf16 v[12:15], v[84:87], a[116:119], v[12:15]
  ds_read_b64_tr_b16 v[74:75], v110 offset:16896
  v_mfma_f32_16x16x32_bf16 v[8:11], v[88:91], a[112:115], v[8:11]
  ds_read_b64_tr_b16 v[76:77], v109 offset:22528
  v_mfma_f32_16x16x32_bf16 v[16:19], v[88:91], a[116:119], v[16:19]
  ds_read_b64_tr_b16 v[78:79], v109 offset:23040
  s_waitcnt lgkmcnt(6)
  v_mfma_f32_16x16x32_bf16 v[4:7], v[92:95], a[120:123], v[4:7]
  ds_read_b64_tr_b16 v[80:81], v110 offset:22528
  v_mfma_f32_16x16x32_bf16 v[12:15], v[92:95], a[124:127], v[12:15]
  ds_read_b64_tr_b16 v[82:83], v110 offset:23040
  v_mfma_f32_16x16x32_bf16 v[8:11], v[96:99], a[120:123], v[8:11]
  v_add_u32 v105, 65536, v105
  ds_read_b64_tr_b16 v[84:85], v105 offset:16384
  v_mfma_f32_16x16x32_bf16 v[16:19], v[96:99], a[124:127], v[16:19]
  ds_read_b64_tr_b16 v[86:87], v105 offset:16640
  s_waitcnt lgkmcnt(6)
  v_mfma_f32_16x16x32_bf16 v[20:23], v[68:71], a[112:115], v[20:23]
  v_add_u32 v106, 65536, v106
  ds_read_b64_tr_b16 v[88:89], v106 offset:16384
  v_mfma_f32_16x16x32_bf16 v[28:31], v[68:71], a[116:119], v[28:31]
  ds_read_b64_tr_b16 v[90:91], v106 offset:16640
  v_cvt_pk_bf16_f32 v4, v4, v5
  v_cvt_pk_bf16_f32 v5, v6, v7
  v_cvt_pk_bf16_f32 v6, v8, v9
  v_cvt_pk_bf16_f32 v7, v10, v11
  v_mfma_f32_16x16x32_bf16 v[24:27], v[72:75], a[112:115], v[24:27]
  ds_read_b64_tr_b16 v[92:93], v105 offset:22528
  v_mfma_f32_16x16x32_bf16 v[32:35], v[72:75], a[116:119], v[32:35]
  ds_read_b64_tr_b16 v[94:95], v105 offset:22784
  v_cvt_pk_bf16_f32 v8, v12, v13
  v_cvt_pk_bf16_f32 v9, v14, v15
  v_cvt_pk_bf16_f32 v10, v16, v17
  v_cvt_pk_bf16_f32 v11, v18, v19
  s_waitcnt lgkmcnt(6)
  v_mfma_f32_16x16x32_bf16 v[20:23], v[76:79], a[120:123], v[20:23]
  ds_read_b64_tr_b16 v[96:97], v106 offset:22528
  v_mfma_f32_16x16x32_bf16 v[28:31], v[76:79], a[124:127], v[28:31]
  ds_read_b64_tr_b16 v[98:99], v106 offset:22784
  v_pk_max_i16 v4, v4, 0
  v_pk_max_i16 v5, v5, 0
  v_pk_max_i16 v6, v6, 0
  v_pk_max_i16 v7, v7, 0
  v_mfma_f32_16x16x32_bf16 v[24:27], v[80:83], a[120:123], v[24:27]
  v_mfma_f32_16x16x32_bf16 v[32:35], v[80:83], a[124:127], v[32:35]
  v_pk_max_i16 v8, v8, 0
  v_pk_max_i16 v9, v9, 0
  v_pk_max_i16 v10, v10, 0
  v_pk_max_i16 v11, v11, 0
  s_waitcnt lgkmcnt(4)
  v_mfma_f32_16x16x32_bf16 v[36:39], v[84:87], a[112:115], v[36:39]
  v_mfma_f32_16x16x32_bf16 v[44:47], v[84:87], a[116:119], v[44:47]
  s_and_b32 s4, s54, 1
  s_lshl_b32 s4, s4, 12
  s_mul_i32 s8, s54, 12288
  s_add_u32 s8, s8, s4
  v_mfma_f32_16x16x32_bf16 v[40:43], v[88:91], a[112:115], v[40:43]
  v_mfma_f32_16x16x32_bf16 v[48:51], v[88:91], a[116:119], v[48:51]
  s_add_u32 s8, s8, s66
  s_add_u32 s8, s8, 131072
  buffer_store_dwordx4 v[4:7], v103, s[44:47], s8 offen offset:0 sc1
  s_waitcnt lgkmcnt(0)
  v_mfma_f32_16x16x32_bf16 v[36:39], v[92:95], a[120:123], v[36:39]
  v_mfma_f32_16x16x32_bf16 v[44:47], v[92:95], a[124:127], v[44:47]
  buffer_store_dwordx4 v[8:11], v103, s[44:47], s8 offen offset:1024 sc1
  v_cvt_pk_bf16_f32 v20, v20, v21
  v_cvt_pk_bf16_f32 v21, v22, v23
  v_mfma_f32_16x16x32_bf16 v[40:43], v[96:99], a[120:123], v[40:43]
  v_mfma_f32_16x16x32_bf16 v[48:51], v[96:99], a[124:127], v[48:51]
  v_cvt_pk_bf16_f32 v22, v24, v25
  v_cvt_pk_bf16_f32 v23, v26, v27
  v_cvt_pk_bf16_f32 v24, v28, v29
  v_cvt_pk_bf16_f32 v25, v30, v31
  v_cvt_pk_bf16_f32 v26, v32, v33
  v_cvt_pk_bf16_f32 v27, v34, v35
  v_pk_max_i16 v20, v20, 0
  v_pk_max_i16 v21, v21, 0
  v_pk_max_i16 v22, v22, 0
  v_pk_max_i16 v23, v23, 0
  v_pk_max_i16 v24, v24, 0
  v_pk_max_i16 v25, v25, 0
  v_pk_max_i16 v26, v26, 0
  v_pk_max_i16 v27, v27, 0
  s_and_b32 s4, s54, 1
  s_lshl_b32 s4, s4, 12
  s_mul_i32 s8, s54, 12288
  s_add_u32 s8, s8, s4
  s_add_u32 s8, s8, s66
  s_add_u32 s8, s8, 135168
  buffer_store_dwordx4 v[20:23], v103, s[44:47], s8 offen offset:0 sc1
  buffer_store_dwordx4 v[24:27], v103, s[44:47], s8 offen offset:1024 sc1
  v_cvt_pk_bf16_f32 v36, v36, v37
  v_cvt_pk_bf16_f32 v37, v38, v39
  v_cvt_pk_bf16_f32 v38, v40, v41
  v_cvt_pk_bf16_f32 v39, v42, v43
  v_cvt_pk_bf16_f32 v40, v44, v45
  v_cvt_pk_bf16_f32 v41, v46, v47
  v_cvt_pk_bf16_f32 v42, v48, v49
  v_cvt_pk_bf16_f32 v43, v50, v51
  v_pk_max_i16 v36, v36, 0
  v_pk_max_i16 v37, v37, 0
  v_pk_max_i16 v38, v38, 0
  v_pk_max_i16 v39, v39, 0
  v_pk_max_i16 v40, v40, 0
  v_pk_max_i16 v41, v41, 0
  v_pk_max_i16 v42, v42, 0
  v_pk_max_i16 v43, v43, 0
  s_and_b32 s4, s54, 1
  s_xor_b32 s4, s4, 1
  s_lshl_b32 s4, s4, 13
  s_mul_i32 s8, s54, 12288
  s_add_u32 s8, s8, s4
  s_add_u32 s8, s8, s66
  s_add_u32 s8, s8, 131072
  buffer_store_dwordx4 v[36:39], v103, s[44:47], s8 offen offset:0 sc1
  buffer_store_dwordx4 v[40:43], v103, s[44:47], s8 offen offset:1024 sc1
  v_bfe_u32 v100, v1, 1, 3
  v_lshlrev_b32 v100, 7, v100
  v_and_b32 v101, 1, v1
  v_lshl_add_u32 v100, v101, 2, v100
  s_lshr_b32 s62, s56, 1
  s_lshl_b32 s62, s62, 10
  s_and_b32 s63, s56, 1
  s_lshl_b32 s63, s63, 3
  s_add_u32 s62, s62, s63
  s_add_u32 s62, s62, 10010624
  v_add_u32 v102, s62, v100
  v_add_u32 v124, 16384, v102
  v_add_u32 v125, 49152, v102
  s_waitcnt vmcnt(0)
  s_lshl_b32 s65, s53, 3
  s_add_u32 s65, s65, s54
  s_lshl_b32 s65, s65, 5
  s_add_u32 s65, s65, s52
  s_lshl_b32 s65, s65, 2
  s_add_u32 s65, s65, 10027008
  s_mov_b64 exec, 1
  buffer_store_dword v115, off, s[44:47], s65 sc1
  s_mov_b64 exec, -1
  s_barrier
  ds_read_b128 a[0:3], v113 offset:40960
  ds_read_b64_tr_b16 a[8:9], v111 offset:24576
  ds_read_b64_tr_b16 a[10:11], v111 offset:26624
  ds_read_b128 a[4:7], v113 offset:41984
  ds_read_b64_tr_b16 a[12:13], v112 offset:24576
  ds_read_b64_tr_b16 a[14:15], v112 offset:26624
  ds_read_b128 a[16:19], v113 offset:45056
  ds_read_b64_tr_b16 a[24:25], v111 offset:28672
  ds_read_b64_tr_b16 a[26:27], v111 offset:30720
  ds_read_b128 a[20:23], v113 offset:46080
  s_waitcnt lgkmcnt(6)
  v_mfma_f32_16x16x32_bf16 v[52:55], a[8:11], a[0:3], 0
  ds_read_b64_tr_b16 a[28:29], v112 offset:28672
  v_mfma_f32_16x16x32_bf16 v[60:63], a[8:11], a[4:7], 0
  ds_read_b64_tr_b16 a[30:31], v112 offset:30720
  s_waitcnt lgkmcnt(6)
  v_mfma_f32_16x16x32_bf16 v[56:59], a[12:15], a[0:3], 0
  s_barrier
  ds_read_b128 a[32:35], v113 offset:49152
  v_add_u32 v111, 65536, v111
  ds_read_b64_tr_b16 a[40:41], v111 offset:28672
  v_mfma_f32_16x16x32_bf16 v[64:67], a[12:15], a[4:7], 0
  ds_read_b64_tr_b16 a[42:43], v111 offset:30720
  ds_read_b128 a[36:39], v113 offset:50176
  s_waitcnt lgkmcnt(6)
  v_mfma_f32_16x16x32_bf16 v[52:55], a[24:27], a[16:19], v[52:55]
  v_add_u32 v112, 65536, v112
  ds_read_b64_tr_b16 a[44:45], v112 offset:28672
  v_mfma_f32_16x16x32_bf16 v[60:63], a[24:27], a[20:23], v[60:63]
  ds_read_b64_tr_b16 a[46:47], v112 offset:30720
  s_waitcnt lgkmcnt(6)
  v_mfma_f32_16x16x32_bf16 v[56:59], a[28:31], a[16:19], v[56:59]
  ds_read_b128 a[0:3], v113 offset:53248
  ds_read_b64_tr_b16 a[8:9], v111 offset:32768
  v_mfma_f32_16x16x32_bf16 v[64:67], a[28:31], a[20:23], v[64:67]
  ds_read_b64_tr_b16 a[10:11], v111 offset:34816
  ds_read_b128 a[4:7], v113 offset:54272
  s_waitcnt lgkmcnt(6)
  v_mfma_f32_16x16x32_bf16 v[52:55], a[40:43], a[32:35], v[52:55]
  ds_read_b64_tr_b16 a[12:13], v112 offset:32768
  v_mfma_f32_16x16x32_bf16 v[60:63], a[40:43], a[36:39], v[60:63]
  ds_read_b64_tr_b16 a[14:15], v112 offset:34816
  s_waitcnt lgkmcnt(6)
  v_mfma_f32_16x16x32_bf16 v[56:59], a[44:47], a[32:35], v[56:59]
  s_barrier
  ds_read_b128 a[16:19], v113 offset:57344
  ds_read_b64_tr_b16 a[24:25], v111 offset:36864
  v_mfma_f32_16x16x32_bf16 v[64:67], a[44:47], a[36:39], v[64:67]
  ds_read_b64_tr_b16 a[26:27], v111 offset:38912
  ds_read_b128 a[20:23], v113 offset:58368
  s_waitcnt lgkmcnt(6)
  v_mfma_f32_16x16x32_bf16 v[52:55], a[8:11], a[0:3], v[52:55]
  ds_read_b64_tr_b16 a[28:29], v112 offset:36864
  v_mfma_f32_16x16x32_bf16 v[60:63], a[8:11], a[4:7], v[60:63]
  ds_read_b64_tr_b16 a[30:31], v112 offset:38912
  s_waitcnt lgkmcnt(6)
  v_mfma_f32_16x16x32_bf16 v[56:59], a[12:15], a[0:3], v[56:59]
  ds_read_b128 a[32:35], v113 offset:61440
  ds_read_b64_tr_b16 a[40:41], v111 offset:40960
  v_mfma_f32_16x16x32_bf16 v[64:67], a[12:15], a[4:7], v[64:67]
  ds_read_b64_tr_b16 a[42:43], v111 offset:43008
  ds_read_b128 a[36:39], v113 offset:62464
  s_waitcnt lgkmcnt(6)
  v_mfma_f32_16x16x32_bf16 v[52:55], a[24:27], a[16:19], v[52:55]
  ds_read_b64_tr_b16 a[44:45], v112 offset:40960
  v_mfma_f32_16x16x32_bf16 v[60:63], a[24:27], a[20:23], v[60:63]
  ds_read_b64_tr_b16 a[46:47], v112 offset:43008
  s_waitcnt lgkmcnt(6)
  v_mfma_f32_16x16x32_bf16 v[56:59], a[28:31], a[16:19], v[56:59]
  s_barrier
  ds_read_b128 a[0:3], v113 offset:0
  ds_read_b64_tr_b16 a[8:9], v111 offset:61440
  v_mfma_f32_16x16x32_bf16 v[64:67], a[28:31], a[20:23], v[64:67]
  ds_read_b64_tr_b16 a[10:11], v111 offset:63488
  ds_read_b128 a[4:7], v113 offset:1024
  s_waitcnt lgkmcnt(6)
  v_mfma_f32_16x16x32_bf16 v[52:55], a[40:43], a[32:35], v[52:55]
  ds_read_b64_tr_b16 a[12:13], v112 offset:61440
  v_mfma_f32_16x16x32_bf16 v[60:63], a[40:43], a[36:39], v[60:63]
  ds_read_b64_tr_b16 a[14:15], v112 offset:63488
  s_waitcnt lgkmcnt(6)
  v_mfma_f32_16x16x32_bf16 v[56:59], a[44:47], a[32:35], v[56:59]
  ds_read_b128 a[16:19], v113 offset:4096
  v_add_u32 v111, 65536, v111
  ds_read_b64_tr_b16 a[24:25], v111 offset:0
  v_mfma_f32_16x16x32_bf16 v[64:67], a[44:47], a[36:39], v[64:67]
  ds_read_b64_tr_b16 a[26:27], v111 offset:2048
  ds_read_b128 a[20:23], v113 offset:5120
  s_waitcnt lgkmcnt(6)
  v_mfma_f32_16x16x32_bf16 v[52:55], a[8:11], a[0:3], v[52:55]
  v_add_u32 v112, 65536, v112
  ds_read_b64_tr_b16 a[28:29], v112 offset:0
  v_mfma_f32_16x16x32_bf16 v[60:63], a[8:11], a[4:7], v[60:63]
  ds_read_b64_tr_b16 a[30:31], v112 offset:2048
  s_waitcnt lgkmcnt(6)
  v_mfma_f32_16x16x32_bf16 v[56:59], a[12:15], a[0:3], v[56:59]
  s_barrier
  ds_read_b128 a[32:35], v113 offset:16384
  v_add_u32 v111, 4294836224, v111
  ds_read_b64_tr_b16 a[40:41], v111 offset:32768
  v_mfma_f32_16x16x32_bf16 v[64:67], a[12:15], a[4:7], v[64:67]
  ds_read_b64_tr_b16 a[42:43], v111 offset:34816
  ds_read_b128 a[36:39], v113 offset:17408
  s_waitcnt lgkmcnt(6)
  v_mfma_f32_16x16x32_bf16 v[52:55], a[24:27], a[16:19], v[52:55]
  v_add_u32 v112, 4294836224, v112
  ds_read_b64_tr_b16 a[44:45], v112 offset:32768
  v_mfma_f32_16x16x32_bf16 v[60:63], a[24:27], a[20:23], v[60:63]
  ds_read_b64_tr_b16 a[46:47], v112 offset:34816
  s_waitcnt lgkmcnt(6)
  v_mfma_f32_16x16x32_bf16 v[56:59], a[28:31], a[16:19], v[56:59]
  ds_read_b128 a[0:3], v113 offset:20480
  ds_read_b64_tr_b16 a[8:9], v111 offset:36864
  v_mfma_f32_16x16x32_bf16 v[64:67], a[28:31], a[20:23], v[64:67]
  ds_read_b64_tr_b16 a[10:11], v111 offset:38912
  ds_read_b128 a[4:7], v113 offset:21504
  s_waitcnt lgkmcnt(6)
  v_mfma_f32_16x16x32_bf16 v[52:55], a[40:43], a[32:35], v[52:55]
  ds_read_b64_tr_b16 a[12:13], v112 offset:36864
  v_mfma_f32_16x16x32_bf16 v[60:63], a[40:43], a[36:39], v[60:63]
  ds_read_b64_tr_b16 a[14:15], v112 offset:38912
  s_waitcnt lgkmcnt(6)
  v_mfma_f32_16x16x32_bf16 v[56:59], a[44:47], a[32:35], v[56:59]
  s_barrier
  ds_read_b128 a[16:19], v113 offset:24576
  v_add_u32 v111, 65536, v111
  ds_read_b64_tr_b16 a[24:25], v111 offset:0
  v_mfma_f32_16x16x32_bf16 v[64:67], a[44:47], a[36:39], v[64:67]
  ds_read_b64_tr_b16 a[26:27], v111 offset:2048
  ds_read_b128 a[20:23], v113 offset:25600
  s_waitcnt lgkmcnt(6)
  v_mfma_f32_16x16x32_bf16 v[52:55], a[8:11], a[0:3], v[52:55]
  v_add_u32 v112, 65536, v112
  ds_read_b64_tr_b16 a[28:29], v112 offset:0
  v_mfma_f32_16x16x32_bf16 v[60:63], a[8:11], a[4:7], v[60:63]
  ds_read_b64_tr_b16 a[30:31], v112 offset:2048
  s_waitcnt lgkmcnt(6)
  v_mfma_f32_16x16x32_bf16 v[56:59], a[12:15], a[0:3], v[56:59]
  ds_read_b128 a[32:35], v113 offset:28672
  ds_read_b64_tr_b16 a[40:41], v111 offset:4096
  v_mfma_f32_16x16x32_bf16 v[64:67], a[12:15], a[4:7], v[64:67]
  ds_read_b64_tr_b16 a[42:43], v111 offset:6144
  ds_read_b128 a[36:39], v113 offset:29696
  s_waitcnt lgkmcnt(6)
  v_mfma_f32_16x16x32_bf16 v[52:55], a[24:27], a[16:19], v[52:55]
  ds_read_b64_tr_b16 a[44:45], v112 offset:4096
  v_mfma_f32_16x16x32_bf16 v[60:63], a[24:27], a[20:23], v[60:63]
  ds_read_b64_tr_b16 a[46:47], v112 offset:6144
  s_waitcnt lgkmcnt(6)
  v_mfma_f32_16x16x32_bf16 v[56:59], a[28:31], a[16:19], v[56:59]
  s_barrier
  ds_read_b128 a[0:3], v113 offset:49152
  ds_read_b64_tr_b16 a[8:9], v111 offset:8192
  v_mfma_f32_16x16x32_bf16 v[64:67], a[28:31], a[20:23], v[64:67]
  ds_read_b64_tr_b16 a[10:11], v111 offset:10240
  ds_read_b128 a[4:7], v113 offset:50176
  s_waitcnt lgkmcnt(6)
  v_mfma_f32_16x16x32_bf16 v[52:55], a[40:43], a[32:35], v[52:55]
  ds_read_b64_tr_b16 a[12:13], v112 offset:8192
  v_mfma_f32_16x16x32_bf16 v[60:63], a[40:43], a[36:39], v[60:63]
  ds_read_b64_tr_b16 a[14:15], v112 offset:10240
  s_waitcnt lgkmcnt(6)
  v_mfma_f32_16x16x32_bf16 v[56:59], a[44:47], a[32:35], v[56:59]
  ds_read_b128 a[16:19], v113 offset:53248
  ds_read_b64_tr_b16 a[24:25], v111 offset:12288
  v_mfma_f32_16x16x32_bf16 v[64:67], a[44:47], a[36:39], v[64:67]
  ds_read_b64_tr_b16 a[26:27], v111 offset:14336
  ds_read_b128 a[20:23], v113 offset:54272
  s_waitcnt lgkmcnt(6)
  v_mfma_f32_16x16x32_bf16 v[52:55], a[8:11], a[0:3], v[52:55]
  ds_read_b64_tr_b16 a[28:29], v112 offset:12288
  v_mfma_f32_16x16x32_bf16 v[60:63], a[8:11], a[4:7], v[60:63]
  ds_read_b64_tr_b16 a[30:31], v112 offset:14336
  s_waitcnt lgkmcnt(6)
  v_mfma_f32_16x16x32_bf16 v[56:59], a[12:15], a[0:3], v[56:59]
  s_barrier
  ds_read_b128 a[32:35], v113 offset:57344
  ds_read_b64_tr_b16 a[40:41], v111 offset:45056
  v_mfma_f32_16x16x32_bf16 v[64:67], a[12:15], a[4:7], v[64:67]
  ds_read_b64_tr_b16 a[42:43], v111 offset:47104
  ds_read_b128 a[36:39], v113 offset:58368
  s_waitcnt lgkmcnt(6)
  v_mfma_f32_16x16x32_bf16 v[52:55], a[24:27], a[16:19], v[52:55]
  ds_read_b64_tr_b16 a[44:45], v112 offset:45056
  v_mfma_f32_16x16x32_bf16 v[60:63], a[24:27], a[20:23], v[60:63]
  ds_read_b64_tr_b16 a[46:47], v112 offset:47104
  s_waitcnt lgkmcnt(6)
  v_mfma_f32_16x16x32_bf16 v[56:59], a[28:31], a[16:19], v[56:59]
  ds_read_b128 a[0:3], v113 offset:61440
  ds_read_b64_tr_b16 a[8:9], v111 offset:49152
  v_mfma_f32_16x16x32_bf16 v[64:67], a[28:31], a[20:23], v[64:67]
  ds_read_b64_tr_b16 a[10:11], v111 offset:51200
  ds_read_b128 a[4:7], v113 offset:62464
  s_waitcnt lgkmcnt(6)
  v_mfma_f32_16x16x32_bf16 v[52:55], a[40:43], a[32:35], v[52:55]
  ds_read_b64_tr_b16 a[12:13], v112 offset:49152
  v_mfma_f32_16x16x32_bf16 v[60:63], a[40:43], a[36:39], v[60:63]
  ds_read_b64_tr_b16 a[14:15], v112 offset:51200
  s_waitcnt lgkmcnt(6)
  v_mfma_f32_16x16x32_bf16 v[56:59], a[44:47], a[32:35], v[56:59]
  s_barrier
  ds_read_b128 a[16:19], v113 offset:0
  v_add_u32 v111, 4294901760, v111
  ds_read_b64_tr_b16 a[24:25], v111 offset:8192
  v_mfma_f32_16x16x32_bf16 v[64:67], a[44:47], a[36:39], v[64:67]
  ds_read_b64_tr_b16 a[26:27], v111 offset:10240
  ds_read_b128 a[20:23], v113 offset:1024
  s_waitcnt lgkmcnt(6)
  v_mfma_f32_16x16x32_bf16 v[52:55], a[8:11], a[0:3], v[52:55]
  v_add_u32 v112, 4294901760, v112
  ds_read_b64_tr_b16 a[28:29], v112 offset:8192
  v_mfma_f32_16x16x32_bf16 v[60:63], a[8:11], a[4:7], v[60:63]
  ds_read_b64_tr_b16 a[30:31], v112 offset:10240
  s_waitcnt lgkmcnt(6)
  v_mfma_f32_16x16x32_bf16 v[56:59], a[12:15], a[0:3], v[56:59]
  ds_read_b128 a[32:35], v113 offset:4096
  ds_read_b64_tr_b16 a[40:41], v111 offset:12288
  v_mfma_f32_16x16x32_bf16 v[64:67], a[12:15], a[4:7], v[64:67]
  ds_read_b64_tr_b16 a[42:43], v111 offset:14336
  ds_read_b128 a[36:39], v113 offset:5120
  s_waitcnt lgkmcnt(6)
  v_mfma_f32_16x16x32_bf16 v[52:55], a[24:27], a[16:19], v[52:55]
  ds_read_b64_tr_b16 a[44:45], v112 offset:12288
  v_mfma_f32_16x16x32_bf16 v[60:63], a[24:27], a[20:23], v[60:63]
  ds_read_b64_tr_b16 a[46:47], v112 offset:14336
  s_waitcnt lgkmcnt(6)
  v_mfma_f32_16x16x32_bf16 v[56:59], a[28:31], a[16:19], v[56:59]
  s_barrier
  s_cmp_lg_u32 s52, 0
  s_cbranch_scc1 L_ni_KVC_hk
  buffer_load_dword v127, v124, s[44:47], 0 offen sc1
L_ni_KVC_hk:
  ds_read_b128 a[0:3], v113 offset:16384
  v_add_u32 v111, 65536, v111
  ds_read_b64_tr_b16 a[8:9], v111 offset:16384
  v_mfma_f32_16x16x32_bf16 v[64:67], a[28:31], a[20:23], v[64:67]
  ds_read_b64_tr_b16 a[10:11], v111 offset:18432
  ds_read_b128 a[4:7], v113 offset:17408
  s_waitcnt lgkmcnt(6)
  v_mfma_f32_16x16x32_bf16 v[52:55], a[40:43], a[32:35], v[52:55]
  v_add_u32 v112, 65536, v112
  ds_read_b64_tr_b16 a[12:13], v112 offset:16384
  v_mfma_f32_16x16x32_bf16 v[60:63], a[40:43], a[36:39], v[60:63]
  ds_read_b64_tr_b16 a[14:15], v112 offset:18432
  s_waitcnt lgkmcnt(6)
  v_mfma_f32_16x16x32_bf16 v[56:59], a[44:47], a[32:35], v[56:59]
  ds_read_b128 a[16:19], v113 offset:20480
  ds_read_b64_tr_b16 a[24:25], v111 offset:20480
  v_mfma_f32_16x16x32_bf16 v[64:67], a[44:47], a[36:39], v[64:67]
  ds_read_b64_tr_b16 a[26:27], v111 offset:22528
  ds_read_b128 a[20:23], v113 offset:21504
  s_waitcnt lgkmcnt(6)
  v_mfma_f32_16x16x32_bf16 v[52:55], a[8:11], a[0:3], v[52:55]
  ds_read_b64_tr_b16 a[28:29], v112 offset:20480
  v_mfma_f32_16x16x32_bf16 v[60:63], a[8:11], a[4:7], v[60:63]
  ds_read_b64_tr_b16 a[30:31], v112 offset:22528
  s_waitcnt lgkmcnt(6)
  v_mfma_f32_16x16x32_bf16 v[56:59], a[12:15], a[0:3], v[56:59]
  s_barrier
  ds_read_b128 a[32:35], v113 offset:24576
  v_add_u32 v111, 4294901760, v111
  ds_read_b64_tr_b16 a[40:41], v111 offset:40960
  v_mfma_f32_16x16x32_bf16 v[64:67], a[12:15], a[4:7], v[64:67]
  ds_read_b64_tr_b16 a[42:43], v111 offset:43008
  ds_read_b128 a[36:39], v113 offset:25600
  s_waitcnt lgkmcnt(6)
  v_mfma_f32_16x16x32_bf16 v[52:55], a[24:27], a[16:19], v[52:55]
  v_add_u32 v112, 4294901760, v112
  ds_read_b64_tr_b16 a[44:45], v112 offset:40960
  v_mfma_f32_16x16x32_bf16 v[60:63], a[24:27], a[20:23], v[60:63]
  ds_read_b64_tr_b16 a[46:47], v112 offset:43008
  s_waitcnt lgkmcnt(6)
  v_mfma_f32_16x16x32_bf16 v[56:59], a[28:31], a[16:19], v[56:59]
  ds_read_b128 a[0:3], v113 offset:28672
  ds_read_b64_tr_b16 a[8:9], v111 offset:45056
  v_mfma_f32_16x16x32_bf16 v[64:67], a[28:31], a[20:23], v[64:67]
  ds_read_b64_tr_b16 a[10:11], v111 offset:47104
  ds_read_b128 a[4:7], v113 offset:29696
  s_waitcnt lgkmcnt(6)
  v_mfma_f32_16x16x32_bf16 v[52:55], a[40:43], a[32:35], v[52:55]
  ds_read_b64_tr_b16 a[12:13], v112 offset:45056
  v_mfma_f32_16x16x32_bf16 v[60:63], a[40:43], a[36:39], v[60:63]
  ds_read_b64_tr_b16 a[14:15], v112 offset:47104
  s_waitcnt lgkmcnt(6)
  v_mfma_f32_16x16x32_bf16 v[56:59], a[44:47], a[32:35], v[56:59]
  s_barrier
  ds_read_b128 a[16:19], v113 offset:49152
  v_add_u32 v111, 65536, v111
  ds_read_b64_tr_b16 a[24:25], v111 offset:24576
  v_mfma_f32_16x16x32_bf16 v[64:67], a[44:47], a[36:39], v[64:67]
  ds_read_b64_tr_b16 a[26:27], v111 offset:26624
  ds_read_b128 a[20:23], v113 offset:50176
  s_waitcnt lgkmcnt(6)
  v_mfma_f32_16x16x32_bf16 v[52:55], a[8:11], a[0:3], v[52:55]
  v_add_u32 v112, 65536, v112
  ds_read_b64_tr_b16 a[28:29], v112 offset:24576
  v_mfma_f32_16x16x32_bf16 v[60:63], a[8:11], a[4:7], v[60:63]
  ds_read_b64_tr_b16 a[30:31], v112 offset:26624
  s_waitcnt lgkmcnt(6)
  v_mfma_f32_16x16x32_bf16 v[56:59], a[12:15], a[0:3], v[56:59]
  ds_read_b128 a[32:35], v113 offset:53248
  ds_read_b64_tr_b16 a[40:41], v111 offset:28672
  v_mfma_f32_16x16x32_bf16 v[64:67], a[12:15], a[4:7], v[64:67]
  ds_read_b64_tr_b16 a[42:43], v111 offset:30720
  ds_read_b128 a[36:39], v113 offset:54272
  s_waitcnt lgkmcnt(6)
  v_mfma_f32_16x16x32_bf16 v[52:55], a[24:27], a[16:19], v[52:55]
  ds_read_b64_tr_b16 a[44:45], v112 offset:28672
  v_mfma_f32_16x16x32_bf16 v[60:63], a[24:27], a[20:23], v[60:63]
  ds_read_b64_tr_b16 a[46:47], v112 offset:30720
  s_waitcnt lgkmcnt(6)
  v_mfma_f32_16x16x32_bf16 v[56:59], a[28:31], a[16:19], v[56:59]
  s_barrier
  ds_read_b128 a[0:3], v113 offset:57344
  ds_read_b64_tr_b16 a[8:9], v111 offset:32768
  v_mfma_f32_16x16x32_bf16 v[64:67], a[28:31], a[20:23], v[64:67]
  ds_read_b64_tr_b16 a[10:11], v111 offset:34816
  ds_read_b128 a[4:7], v113 offset:58368
  s_waitcnt lgkmcnt(6)
  v_mfma_f32_16x16x32_bf16 v[52:55], a[40:43], a[32:35], v[52:55]
  ds_read_b64_tr_b16 a[12:13], v112 offset:32768
  v_mfma_f32_16x16x32_bf16 v[60:63], a[40:43], a[36:39], v[60:63]
  ds_read_b64_tr_b16 a[14:15], v112 offset:34816
  s_waitcnt lgkmcnt(6)
  v_mfma_f32_16x16x32_bf16 v[56:59], a[44:47], a[32:35], v[56:59]
  ds_read_b128 a[16:19], v113 offset:61440
  ds_read_b64_tr_b16 a[24:25], v111 offset:36864
  v_mfma_f32_16x16x32_bf16 v[64:67], a[44:47], a[36:39], v[64:67]
  ds_read_b64_tr_b16 a[26:27], v111 offset:38912
  ds_read_b128 a[20:23], v113 offset:62464
  s_waitcnt lgkmcnt(6)
  v_mfma_f32_16x16x32_bf16 v[52:55], a[8:11], a[0:3], v[52:55]
  ds_read_b64_tr_b16 a[28:29], v112 offset:36864
  v_mfma_f32_16x16x32_bf16 v[60:63], a[8:11], a[4:7], v[60:63]
  ds_read_b64_tr_b16 a[30:31], v112 offset:38912
  s_waitcnt lgkmcnt(6)
  v_mfma_f32_16x16x32_bf16 v[56:59], a[12:15], a[0:3], v[56:59]
  s_cmp_lg_u32 s52, 0
  s_cbranch_scc1 L_nc_KVC_hk
  s_waitcnt vmcnt(0)
  v_cmp_ne_u32 vcc, v127, v115
  s_cbranch_vccnz L_slow_KVC_hk
L_back_KVC_hk:
L_nc_KVC_hk:
  s_barrier
  ds_read_b128 a[32:35], v113 offset:0
  ds_read_b64_tr_b16 a[40:41], v111 offset:53248
  v_mfma_f32_16x16x32_bf16 v[64:67], a[12:15], a[4:7], v[64:67]
  ds_read_b64_tr_b16 a[42:43], v111 offset:55296
  ds_read_b128 a[36:39], v113 offset:1024
  s_waitcnt lgkmcnt(6)
  v_mfma_f32_16x16x32_bf16 v[52:55], a[24:27], a[16:19], v[52:55]
  ds_read_b64_tr_b16 a[44:45], v112 offset:53248
  v_mfma_f32_16x16x32_bf16 v[60:63], a[24:27], a[20:23], v[60:63]
  ds_read_b64_tr_b16 a[46:47], v112 offset:55296
  s_waitcnt lgkmcnt(6)
  v_mfma_f32_16x16x32_bf16 v[56:59], a[28:31], a[16:19], v[56:59]
  ds_read_b128 a[0:3], v113 offset:4096
  ds_read_b64_tr_b16 a[8:9], v111 offset:57344
  v_mfma_f32_16x16x32_bf16 v[64:67], a[28:31], a[20:23], v[64:67]
  ds_read_b64_tr_b16 a[10:11], v111 offset:59392
  ds_read_b128 a[4:7], v113 offset:5120
  s_waitcnt lgkmcnt(6)
  v_mfma_f32_16x16x32_bf16 v[52:55], a[40:43], a[32:35], v[52:55]
  ds_read_b64_tr_b16 a[12:13], v112 offset:57344
  v_mfma_f32_16x16x32_bf16 v[60:63], a[40:43], a[36:39], v[60:63]
  ds_read_b64_tr_b16 a[14:15], v112 offset:59392
  s_waitcnt lgkmcnt(6)
  v_mfma_f32_16x16x32_bf16 v[56:59], a[44:47], a[32:35], v[56:59]
  s_barrier
  ds_read_b128 a[16:19], v113 offset:16384
  v_add_u32 v111, 4294901760, v111
  ds_read_b64_tr_b16 a[24:25], v111 offset:32768
  v_mfma_f32_16x16x32_bf16 v[64:67], a[44:47], a[36:39], v[64:67]
  ds_read_b64_tr_b16 a[26:27], v111 offset:34816
  ds_read_b128 a[20:23], v113 offset:17408
  s_waitcnt lgkmcnt(6)
  v_mfma_f32_16x16x32_bf16 v[52:55], a[8:11], a[0:3], v[52:55]
  v_add_u32 v112, 4294901760, v112
  ds_read_b64_tr_b16 a[28:29], v112 offset:32768
  v_mfma_f32_16x16x32_bf16 v[60:63], a[8:11], a[4:7], v[60:63]
  ds_read_b64_tr_b16 a[30:31], v112 offset:34816
  s_waitcnt lgkmcnt(6)
  v_mfma_f32_16x16x32_bf16 v[56:59], a[12:15], a[0:3], v[56:59]
  ds_read_b128 a[32:35], v113 offset:20480
  ds_read_b64_tr_b16 a[40:41], v111 offset:36864
  v_mfma_f32_16x16x32_bf16 v[64:67], a[12:15], a[4:7], v[64:67]
  ds_read_b64_tr_b16 a[42:43], v111 offset:38912
  ds_read_b128 a[36:39], v113 offset:21504
  s_waitcnt lgkmcnt(6)
  v_mfma_f32_16x16x32_bf16 v[52:55], a[24:27], a[16:19], v[52:55]
  ds_read_b64_tr_b16 a[44:45], v112 offset:36864
  v_mfma_f32_16x16x32_bf16 v[60:63], a[24:27], a[20:23], v[60:63]
  ds_read_b64_tr_b16 a[46:47], v112 offset:38912
  s_waitcnt lgkmcnt(6)
  v_mfma_f32_16x16x32_bf16 v[56:59], a[28:31], a[16:19], v[56:59]
  s_barrier
  ds_read_b128 a[0:3], v113 offset:24576
  v_add_u32 v111, 65536, v111
  ds_read_b64_tr_b16 a[8:9], v111 offset:0
  v_mfma_f32_16x16x32_bf16 v[64:67], a[28:31], a[20:23], v[64:67]
  ds_read_b64_tr_b16 a[10:11], v111 offset:2048
  ds_read_b128 a[4:7], v113 offset:25600
  s_waitcnt lgkmcnt(6)
  v_mfma_f32_16x16x32_bf16 v[52:55], a[40:43], a[32:35], v[52:55]
  v_add_u32 v112, 65536, v112
  ds_read_b64_tr_b16 a[12:13], v112 offset:0
  v_mfma_f32_16x16x32_bf16 v[60:63], a[40:43], a[36:39], v[60:63]
  ds_read_b64_tr_b16 a[14:15], v112 offset:2048
  s_waitcnt lgkmcnt(6)
  v_mfma_f32_16x16x32_bf16 v[56:59], a[44:47], a[32:35], v[56:59]
  ds_read_b128 a[16:19], v113 offset:28672
  ds_read_b64_tr_b16 a[24:25], v111 offset:4096
  v_mfma_f32_16x16x32_bf16 v[64:67], a[44:47], a[36:39], v[64:67]
  ds_read_b64_tr_b16 a[26:27], v111 offset:6144
  ds_read_b128 a[20:23], v113 offset:29696
  s_waitcnt lgkmcnt(6)
  v_mfma_f32_16x16x32_bf16 v[52:55], a[8:11], a[0:3], v[52:55]
  ds_read_b64_tr_b16 a[28:29], v112 offset:4096
  v_mfma_f32_16x16x32_bf16 v[60:63], a[8:11], a[4:7], v[60:63]
  ds_read_b64_tr_b16 a[30:31], v112 offset:6144
  s_waitcnt lgkmcnt(6)
  v_mfma_f32_16x16x32_bf16 v[56:59], a[12:15], a[0:3], v[56:59]
  s_barrier
  ds_read_b128 a[32:35], v113 offset:49152
  ds_read_b64_tr_b16 a[40:41], v111 offset:8192
  v_mfma_f32_16x16x32_bf16 v[64:67], a[12:15], a[4:7], v[64:67]
  ds_read_b64_tr_b16 a[42:43], v111 offset:10240
  ds_read_b128 a[36:39], v113 offset:50176
  s_waitcnt lgkmcnt(6)
  v_mfma_f32_16x16x32_bf16 v[52:55], a[24:27], a[16:19], v[52:55]
  ds_read_b64_tr_b16 a[44:45], v112 offset:8192
  v_mfma_f32_16x16x32_bf16 v[60:63], a[24:27], a[20:23], v[60:63]
  ds_read_b64_tr_b16 a[46:47], v112 offset:10240
  s_waitcnt lgkmcnt(6)
  v_mfma_f32_16x16x32_bf16 v[56:59], a[28:31], a[16:19], v[56:59]
  ds_read_b128 a[0:3], v113 offset:53248
  ds_read_b64_tr_b16 a[8:9], v111 offset:12288
  v_mfma_f32_16x16x32_bf16 v[64:67], a[28:31], a[20:23], v[64:67]
  ds_read_b64_tr_b16 a[10:11], v111 offset:14336
  ds_read_b128 a[4:7], v113 offset:54272
  s_waitcnt lgkmcnt(6)
  v_mfma_f32_16x16x32_bf16 v[52:55], a[40:43], a[32:35], v[52:55]
  ds_read_b64_tr_b16 a[12:13], v112 offset:12288
  v_mfma_f32_16x16x32_bf16 v[60:63], a[40:43], a[36:39], v[60:63]
  ds_read_b64_tr_b16 a[14:15], v112 offset:14336
  s_waitcnt lgkmcnt(6)
  v_mfma_f32_16x16x32_bf16 v[56:59], a[44:47], a[32:35], v[56:59]
  s_barrier
  ds_read_b128 a[16:19], v113 offset:57344
  v_add_u32 v111, 4294901760, v111
  ds_read_b64_tr_b16 a[24:25], v111 offset:8192
  v_mfma_f32_16x16x32_bf16 v[64:67], a[44:47], a[36:39], v[64:67]
  ds_read_b64_tr_b16 a[26:27], v111 offset:10240
  ds_read_b128 a[20:23], v113 offset:58368
  s_waitcnt lgkmcnt(6)
  v_mfma_f32_16x16x32_bf16 v[52:55], a[8:11], a[0:3], v[52:55]
  v_add_u32 v112, 4294901760, v112
  ds_read_b64_tr_b16 a[28:29], v112 offset:8192
  v_mfma_f32_16x16x32_bf16 v[60:63], a[8:11], a[4:7], v[60:63]
  ds_read_b64_tr_b16 a[30:31], v112 offset:10240
  s_waitcnt lgkmcnt(6)
  v_mfma_f32_16x16x32_bf16 v[56:59], a[12:15], a[0:3], v[56:59]
  ds_read_b128 a[32:35], v113 offset:61440
  ds_read_b64_tr_b16 a[40:41], v111 offset:12288
  v_mfma_f32_16x16x32_bf16 v[64:67], a[12:15], a[4:7], v[64:67]
  ds_read_b64_tr_b16 a[42:43], v111 offset:14336
  ds_read_b128 a[36:39], v113 offset:62464
  s_waitcnt lgkmcnt(6)
  v_mfma_f32_16x16x32_bf16 v[52:55], a[24:27], a[16:19], v[52:55]
  ds_read_b64_tr_b16 a[44:45], v112 offset:12288
  v_mfma_f32_16x16x32_bf16 v[60:63], a[24:27], a[20:23], v[60:63]
  ds_read_b64_tr_b16 a[46:47], v112 offset:14336
  s_waitcnt lgkmcnt(6)
  v_mfma_f32_16x16x32_bf16 v[56:59], a[28:31], a[16:19], v[56:59]
  s_barrier
  ds_read_b128 a[0:3], v113 offset:0
  v_add_u32 v111, 65536, v111
  ds_read_b64_tr_b16 a[8:9], v111 offset:16384
  v_mfma_f32_16x16x32_bf16 v[64:67], a[28:31], a[20:23], v[64:67]
  ds_read_b64_tr_b16 a[10:11], v111 offset:18432
  ds_read_b128 a[4:7], v113 offset:1024
  s_waitcnt lgkmcnt(6)
  v_mfma_f32_16x16x32_bf16 v[52:55], a[40:43], a[32:35], v[52:55]
  v_add_u32 v112, 65536, v112
  ds_read_b64_tr_b16 a[12:13], v112 offset:16384
  v_mfma_f32_16x16x32_bf16 v[60:63], a[40:43], a[36:39], v[60:63]
  ds_read_b64_tr_b16 a[14:15], v112 offset:18432
  s_waitcnt lgkmcnt(6)
  v_mfma_f32_16x16x32_bf16 v[56:59], a[44:47], a[32:35], v[56:59]
  ds_read_b128 a[16:19], v113 offset:4096
  ds_read_b64_tr_b16 a[24:25], v111 offset:20480
  v_mfma_f32_16x16x32_bf16 v[64:67], a[44:47], a[36:39], v[64:67]
  ds_read_b64_tr_b16 a[26:27], v111 offset:22528
  ds_read_b128 a[20:23], v113 offset:5120
  s_waitcnt lgkmcnt(6)
  v_mfma_f32_16x16x32_bf16 v[52:55], a[8:11], a[0:3], v[52:55]
  ds_read_b64_tr_b16 a[28:29], v112 offset:20480
  v_mfma_f32_16x16x32_bf16 v[60:63], a[8:11], a[4:7], v[60:63]
  ds_read_b64_tr_b16 a[30:31], v112 offset:22528
  s_waitcnt lgkmcnt(6)
  v_mfma_f32_16x16x32_bf16 v[56:59], a[12:15], a[0:3], v[56:59]
  s_barrier
  s_cmp_lg_u32 s52, 0
  s_cbranch_scc1 L_ni_KVC_o
  buffer_load_dword v127, v125, s[44:47], 0 offen sc1
L_ni_KVC_o:
  ds_read_b128 a[32:35], v113 offset:16384
  v_add_u32 v111, 4294901760, v111
  ds_read_b64_tr_b16 a[40:41], v111 offset:40960
  v_mfma_f32_16x16x32_bf16 v[64:67], a[12:15], a[4:7], v[64:67]
  ds_read_b64_tr_b16 a[42:43], v111 offset:43008
  ds_read_b128 a[36:39], v113 offset:17408
  s_waitcnt lgkmcnt(6)
  v_mfma_f32_16x16x32_bf16 v[52:55], a[24:27], a[16:19], v[52:55]
  v_add_u32 v112, 4294901760, v112
  ds_read_b64_tr_b16 a[44:45], v112 offset:40960
  v_mfma_f32_16x16x32_bf16 v[60:63], a[24:27], a[20:23], v[60:63]
  ds_read_b64_tr_b16 a[46:47], v112 offset:43008
  s_waitcnt lgkmcnt(6)
  v_mfma_f32_16x16x32_bf16 v[56:59], a[28:31], a[16:19], v[56:59]
  ds_read_b128 a[0:3], v113 offset:20480
  ds_read_b64_tr_b16 a[8:9], v111 offset:45056
  v_mfma_f32_16x16x32_bf16 v[64:67], a[28:31], a[20:23], v[64:67]
  ds_read_b64_tr_b16 a[10:11], v111 offset:47104
  ds_read_b128 a[4:7], v113 offset:21504
  s_waitcnt lgkmcnt(6)
  v_mfma_f32_16x16x32_bf16 v[52:55], a[40:43], a[32:35], v[52:55]
  ds_read_b64_tr_b16 a[12:13], v112 offset:45056
  v_mfma_f32_16x16x32_bf16 v[60:63], a[40:43], a[36:39], v[60:63]
  ds_read_b64_tr_b16 a[14:15], v112 offset:47104
  s_waitcnt lgkmcnt(6)
  v_mfma_f32_16x16x32_bf16 v[56:59], a[44:47], a[32:35], v[56:59]
  s_barrier
  ds_read_b128 a[16:19], v113 offset:24576
  v_add_u32 v111, 65536, v111
  ds_read_b64_tr_b16 a[24:25], v111 offset:24576
  v_mfma_f32_16x16x32_bf16 v[64:67], a[44:47], a[36:39], v[64:67]
  ds_read_b64_tr_b16 a[26:27], v111 offset:26624
  ds_read_b128 a[20:23], v113 offset:25600
  s_waitcnt lgkmcnt(6)
  v_mfma_f32_16x16x32_bf16 v[52:55], a[8:11], a[0:3], v[52:55]
  v_add_u32 v112, 65536, v112
  ds_read_b64_tr_b16 a[28:29], v112 offset:24576
  v_mfma_f32_16x16x32_bf16 v[60:63], a[8:11], a[4:7], v[60:63]
  ds_read_b64_tr_b16 a[30:31], v112 offset:26624
  s_waitcnt lgkmcnt(6)
  v_mfma_f32_16x16x32_bf16 v[56:59], a[12:15], a[0:3], v[56:59]
  ds_read_b128 a[32:35], v113 offset:28672
  ds_read_b64_tr_b16 a[40:41], v111 offset:28672
  v_mfma_f32_16x16x32_bf16 v[64:67], a[12:15], a[4:7], v[64:67]
  ds_read_b64_tr_b16 a[42:43], v111 offset:30720
  ds_read_b128 a[36:39], v113 offset:29696
  s_waitcnt lgkmcnt(6)
  v_mfma_f32_16x16x32_bf16 v[52:55], a[24:27], a[16:19], v[52:55]
  ds_read_b64_tr_b16 a[44:45], v112 offset:28672
  v_mfma_f32_16x16x32_bf16 v[60:63], a[24:27], a[20:23], v[60:63]
  ds_read_b64_tr_b16 a[46:47], v112 offset:30720
  s_waitcnt lgkmcnt(6)
  v_mfma_f32_16x16x32_bf16 v[56:59], a[28:31], a[16:19], v[56:59]
  s_barrier
  ds_read_b128 a[0:3], v113 offset:49152
  ds_read_b64_tr_b16 a[8:9], v111 offset:32768
  v_mfma_f32_16x16x32_bf16 v[64:67], a[28:31], a[20:23], v[64:67]
  ds_read_b64_tr_b16 a[10:11], v111 offset:34816
  ds_read_b128 a[4:7], v113 offset:50176
  s_waitcnt lgkmcnt(6)
  v_mfma_f32_16x16x32_bf16 v[52:55], a[40:43], a[32:35], v[52:55]
  ds_read_b64_tr_b16 a[12:13], v112 offset:32768
  v_mfma_f32_16x16x32_bf16 v[60:63], a[40:43], a[36:39], v[60:63]
  ds_read_b64_tr_b16 a[14:15], v112 offset:34816
  s_waitcnt lgkmcnt(6)
  v_mfma_f32_16x16x32_bf16 v[56:59], a[44:47], a[32:35], v[56:59]
  ds_read_b128 a[16:19], v113 offset:53248
  ds_read_b64_tr_b16 a[24:25], v111 offset:36864
  v_mfma_f32_16x16x32_bf16 v[64:67], a[44:47], a[36:39], v[64:67]
  ds_read_b64_tr_b16 a[26:27], v111 offset:38912
  ds_read_b128 a[20:23], v113 offset:54272
  s_waitcnt lgkmcnt(6)
  v_mfma_f32_16x16x32_bf16 v[52:55], a[8:11], a[0:3], v[52:55]
  ds_read_b64_tr_b16 a[28:29], v112 offset:36864
  v_mfma_f32_16x16x32_bf16 v[60:63], a[8:11], a[4:7], v[60:63]
  ds_read_b64_tr_b16 a[30:31], v112 offset:38912
  s_waitcnt lgkmcnt(6)
  v_mfma_f32_16x16x32_bf16 v[56:59], a[12:15], a[0:3], v[56:59]
  s_barrier
  ds_read_b128 a[32:35], v113 offset:8192
  ds_read_b64_tr_b16 a[40:41], v111 offset:40960
  v_mfma_f32_16x16x32_bf16 v[64:67], a[12:15], a[4:7], v[64:67]
  ds_read_b64_tr_b16 a[42:43], v111 offset:43008
  ds_read_b128 a[36:39], v113 offset:9216
  s_waitcnt lgkmcnt(6)
  v_mfma_f32_16x16x32_bf16 v[52:55], a[24:27], a[16:19], v[52:55]
  ds_read_b64_tr_b16 a[44:45], v112 offset:40960
  v_mfma_f32_16x16x32_bf16 v[60:63], a[24:27], a[20:23], v[60:63]
  ds_read_b64_tr_b16 a[46:47], v112 offset:43008
  s_waitcnt lgkmcnt(6)
  v_mfma_f32_16x16x32_bf16 v[56:59], a[28:31], a[16:19], v[56:59]
  ds_read_b128 a[0:3], v113 offset:12288
  ds_read_b64_tr_b16 a[8:9], v111 offset:45056
  v_mfma_f32_16x16x32_bf16 v[64:67], a[28:31], a[20:23], v[64:67]
  ds_read_b64_tr_b16 a[10:11], v111 offset:47104
  ds_read_b128 a[4:7], v113 offset:13312
  s_waitcnt lgkmcnt(6)
  v_mfma_f32_16x16x32_bf16 v[52:55], a[40:43], a[32:35], v[52:55]
  ds_read_b64_tr_b16 a[12:13], v112 offset:45056
  v_mfma_f32_16x16x32_bf16 v[60:63], a[40:43], a[36:39], v[60:63]
  ds_read_b64_tr_b16 a[14:15], v112 offset:47104
  s_waitcnt lgkmcnt(6)
  v_mfma_f32_16x16x32_bf16 v[56:59], a[44:47], a[32:35], v[56:59]
  s_barrier
  ds_read_b128 a[16:19], v113 offset:0
  v_add_u32 v111, 4294901760, v111
  ds_read_b64_tr_b16 a[24:25], v111 offset:32768
  v_mfma_f32_16x16x32_bf16 v[64:67], a[44:47], a[36:39], v[64:67]
  ds_read_b64_tr_b16 a[26:27], v111 offset:34816
  ds_read_b128 a[20:23], v113 offset:1024
  s_waitcnt lgkmcnt(6)
  v_mfma_f32_16x16x32_bf16 v[52:55], a[8:11], a[0:3], v[52:55]
  v_add_u32 v112, 4294901760, v112
  ds_read_b64_tr_b16 a[28:29], v112 offset:32768
  v_mfma_f32_16x16x32_bf16 v[60:63], a[8:11], a[4:7], v[60:63]
  ds_read_b64_tr_b16 a[30:31], v112 offset:34816
  s_waitcnt lgkmcnt(6)
  v_mfma_f32_16x16x32_bf16 v[56:59], a[12:15], a[0:3], v[56:59]
  ds_read_b128 a[32:35], v113 offset:4096
  ds_read_b64_tr_b16 a[40:41], v111 offset:36864
  v_mfma_f32_16x16x32_bf16 v[64:67], a[12:15], a[4:7], v[64:67]
  ds_read_b64_tr_b16 a[42:43], v111 offset:38912
  ds_read_b128 a[36:39], v113 offset:5120
  s_waitcnt lgkmcnt(6)
  v_mfma_f32_16x16x32_bf16 v[52:55], a[24:27], a[16:19], v[52:55]
  ds_read_b64_tr_b16 a[44:45], v112 offset:36864
  v_mfma_f32_16x16x32_bf16 v[60:63], a[24:27], a[20:23], v[60:63]
  ds_read_b64_tr_b16 a[46:47], v112 offset:38912
  s_waitcnt lgkmcnt(6)
  v_mfma_f32_16x16x32_bf16 v[56:59], a[28:31], a[16:19], v[56:59]
  s_cmp_lg_u32 s52, 0
  s_cbranch_scc1 L_nc_KVC_o
  s_waitcnt vmcnt(0)
  v_cmp_ne_u32 vcc, v127, v115
  s_cbranch_vccnz L_slow_KVC_o
L_back_KVC_o:
L_nc_KVC_o:
  s_barrier
  s_lshl_b32 s62, s56, 1
  s_and_b32 s65, s52, 1
  s_add_u32 s62, s62, s65
  s_lshl_b32 s62, s62, 5
  v_and_b32 v100, 15, v1
  v_add_u32 v100, s62, v100
  v_lshlrev_b32 v101, 3, v100
  s_mov_b32 s62, 9994240
  buffer_load_dwordx2 v[116:117], v101, s[44:47], s62 offen offset:0 sc1
  buffer_load_dwordx2 v[118:119], v101, s[44:47], s62 offen offset:128 sc1
  s_lshl_b32 s62, s57, 1
  s_lshr_b32 s65, s52, 1
  s_add_u32 s62, s62, s65
  s_lshl_b32 s62, s62, 6
  v_lshrrev_b32 v120, 5, v1
  v_lshlrev_b32 v120, 4, v120
  v_lshl_add_u32 v120, v100, 10, v120
  v_bfe_u32 v101, v1, 4, 1
  v_lshl_add_u32 v120, v101, 5, v120
  v_add_u32 v120, s62, v120
  s_mov_b32 s4, 16384
  ds_read_b128 a[0:3], v113 offset:16384
  v_add_u32 v111, 65536, v111
  ds_read_b64_tr_b16 a[8:9], v111 offset:0
  v_mfma_f32_16x16x32_bf16 v[64:67], a[28:31], a[20:23], v[64:67]
  ds_read_b64_tr_b16 a[10:11], v111 offset:2048
  ds_read_b128 a[4:7], v113 offset:17408
  s_waitcnt lgkmcnt(6)
  v_mfma_f32_16x16x32_bf16 v[52:55], a[40:43], a[32:35], v[52:55]
  v_add_u32 v112, 65536, v112
  ds_read_b64_tr_b16 a[12:13], v112 offset:0
  v_mfma_f32_16x16x32_bf16 v[60:63], a[40:43], a[36:39], v[60:63]
  ds_read_b64_tr_b16 a[14:15], v112 offset:2048
  s_waitcnt lgkmcnt(6)
  v_mfma_f32_16x16x32_bf16 v[56:59], a[44:47], a[32:35], v[56:59]
  ds_read_b128 a[16:19], v113 offset:20480
  ds_read_b64_tr_b16 a[24:25], v111 offset:4096
  v_mfma_f32_16x16x32_bf16 v[64:67], a[44:47], a[36:39], v[64:67]
  ds_read_b64_tr_b16 a[26:27], v111 offset:6144
  ds_read_b128 a[20:23], v113 offset:21504
  s_waitcnt lgkmcnt(6)
  v_mfma_f32_16x16x32_bf16 v[52:55], a[8:11], a[0:3], v[52:55]
  ds_read_b64_tr_b16 a[28:29], v112 offset:4096
  v_mfma_f32_16x16x32_bf16 v[60:63], a[8:11], a[4:7], v[60:63]
  ds_read_b64_tr_b16 a[30:31], v112 offset:6144
  s_waitcnt lgkmcnt(6)
  v_mfma_f32_16x16x32_bf16 v[56:59], a[12:15], a[0:3], v[56:59]
  s_barrier
  ds_read_b128 a[32:35], v113 offset:24576
  ds_read_b64_tr_b16 a[40:41], v111 offset:8192
  v_mfma_f32_16x16x32_bf16 v[64:67], a[12:15], a[4:7], v[64:67]
  ds_read_b64_tr_b16 a[42:43], v111 offset:10240
  ds_read_b128 a[36:39], v113 offset:25600
  s_waitcnt lgkmcnt(6)
  v_mfma_f32_16x16x32_bf16 v[52:55], a[24:27], a[16:19], v[52:55]
  ds_read_b64_tr_b16 a[44:45], v112 offset:8192
  v_mfma_f32_16x16x32_bf16 v[60:63], a[24:27], a[20:23], v[60:63]
  ds_read_b64_tr_b16 a[46:47], v112 offset:10240
  s_waitcnt lgkmcnt(6)
  v_mfma_f32_16x16x32_bf16 v[56:59], a[28:31], a[16:19], v[56:59]
  ds_read_b128 a[0:3], v113 offset:28672
  ds_read_b64_tr_b16 a[8:9], v111 offset:12288
  v_mfma_f32_16x16x32_bf16 v[64:67], a[28:31], a[20:23], v[64:67]
  ds_read_b64_tr_b16 a[10:11], v111 offset:14336
  ds_read_b128 a[4:7], v113 offset:29696
  s_waitcnt lgkmcnt(6)
  v_mfma_f32_16x16x32_bf16 v[52:55], a[40:43], a[32:35], v[52:55]
  ds_read_b64_tr_b16 a[12:13], v112 offset:12288
  v_mfma_f32_16x16x32_bf16 v[60:63], a[40:43], a[36:39], v[60:63]
  ds_read_b64_tr_b16 a[14:15], v112 offset:14336
  s_waitcnt lgkmcnt(6)
  v_mfma_f32_16x16x32_bf16 v[56:59], a[44:47], a[32:35], v[56:59]
  s_barrier
  ds_read_b128 a[16:19], v113 offset:49152
  v_add_u32 v111, 4294901760, v111
  ds_read_b64_tr_b16 a[24:25], v111 offset:57344
  v_mfma_f32_16x16x32_bf16 v[64:67], a[44:47], a[36:39], v[64:67]
  ds_read_b64_tr_b16 a[26:27], v111 offset:59392
  ds_read_b128 a[20:23], v113 offset:50176
  s_waitcnt lgkmcnt(6)
  v_mfma_f32_16x16x32_bf16 v[52:55], a[8:11], a[0:3], v[52:55]
  v_add_u32 v112, 4294901760, v112
  ds_read_b64_tr_b16 a[28:29], v112 offset:57344
  v_mfma_f32_16x16x32_bf16 v[60:63], a[8:11], a[4:7], v[60:63]
  ds_read_b64_tr_b16 a[30:31], v112 offset:59392
  s_waitcnt lgkmcnt(6)
  v_mfma_f32_16x16x32_bf16 v[56:59], a[12:15], a[0:3], v[56:59]
  ds_read_b128 a[32:35], v113 offset:53248
  ds_read_b64_tr_b16 a[40:41], v111 offset:61440
  v_mfma_f32_16x16x32_bf16 v[64:67], a[12:15], a[4:7], v[64:67]
  ds_read_b64_tr_b16 a[42:43], v111 offset:63488
  ds_read_b128 a[36:39], v113 offset:54272
  s_waitcnt lgkmcnt(6)
  v_mfma_f32_16x16x32_bf16 v[52:55], a[24:27], a[16:19], v[52:55]
  ds_read_b64_tr_b16 a[44:45], v112 offset:61440
  v_mfma_f32_16x16x32_bf16 v[60:63], a[24:27], a[20:23], v[60:63]
  ds_read_b64_tr_b16 a[46:47], v112 offset:63488
  s_waitcnt lgkmcnt(6)
  v_mfma_f32_16x16x32_bf16 v[56:59], a[28:31], a[16:19], v[56:59]
  s_barrier
  ds_read_b128 a[0:3], v113 offset:8192
  v_add_u32 v111, 65536, v111
  ds_read_b64_tr_b16 a[8:9], v111 offset:16384
  v_mfma_f32_16x16x32_bf16 v[64:67], a[28:31], a[20:23], v[64:67]
  ds_read_b64_tr_b16 a[10:11], v111 offset:18432
  ds_read_b128 a[4:7], v113 offset:9216
  s_waitcnt lgkmcnt(6)
  v_mfma_f32_16x16x32_bf16 v[52:55], a[40:43], a[32:35], v[52:55]
  v_add_u32 v112, 65536, v112
  ds_read_b64_tr_b16 a[12:13], v112 offset:16384
  v_mfma_f32_16x16x32_bf16 v[60:63], a[40:43], a[36:39], v[60:63]
  ds_read_b64_tr_b16 a[14:15], v112 offset:18432
  s_waitcnt lgkmcnt(6)
  v_mfma_f32_16x16x32_bf16 v[56:59], a[44:47], a[32:35], v[56:59]
  ds_read_b128 a[16:19], v113 offset:12288
  ds_read_b64_tr_b16 a[24:25], v111 offset:20480
  v_mfma_f32_16x16x32_bf16 v[64:67], a[44:47], a[36:39], v[64:67]
  ds_read_b64_tr_b16 a[26:27], v111 offset:22528
  ds_read_b128 a[20:23], v113 offset:13312
  s_waitcnt lgkmcnt(6)
  v_mfma_f32_16x16x32_bf16 v[52:55], a[8:11], a[0:3], v[52:55]
  ds_read_b64_tr_b16 a[28:29], v112 offset:20480
  v_mfma_f32_16x16x32_bf16 v[60:63], a[8:11], a[4:7], v[60:63]
  ds_read_b64_tr_b16 a[30:31], v112 offset:22528
  s_waitcnt lgkmcnt(6)
  v_mfma_f32_16x16x32_bf16 v[56:59], a[12:15], a[0:3], v[56:59]
  s_barrier
  v_add_u32 v113, 65536, v113
  ds_read_b128 a[32:35], v113 offset:32768
  v_add_u32 v111, 4294901760, v111
  ds_read_b64_tr_b16 a[40:41], v111 offset:40960
  v_mfma_f32_16x16x32_bf16 v[64:67], a[12:15], a[4:7], v[64:67]
  ds_read_b64_tr_b16 a[42:43], v111 offset:43008
  ds_read_b128 a[36:39], v113 offset:33792
  s_waitcnt lgkmcnt(6)
  v_mfma_f32_16x16x32_bf16 v[52:55], a[24:27], a[16:19], v[52:55]
  v_add_u32 v112, 4294901760, v112
  ds_read_b64_tr_b16 a[44:45], v112 offset:40960
  v_mfma_f32_16x16x32_bf16 v[60:63], a[24:27], a[20:23], v[60:63]
  ds_read_b64_tr_b16 a[46:47], v112 offset:43008
  s_waitcnt lgkmcnt(6)
  v_mfma_f32_16x16x32_bf16 v[56:59], a[28:31], a[16:19], v[56:59]
  ds_read_b128 a[0:3], v113 offset:36864
  ds_read_b64_tr_b16 a[8:9], v111 offset:45056
  v_mfma_f32_16x16x32_bf16 v[64:67], a[28:31], a[20:23], v[64:67]
  ds_read_b64_tr_b16 a[10:11], v111 offset:47104
  ds_read_b128 a[4:7], v113 offset:37888
  s_waitcnt lgkmcnt(6)
  v_mfma_f32_16x16x32_bf16 v[4:7], a[40:43], a[32:35], 0
  ds_read_b64_tr_b16 a[12:13], v112 offset:45056
  v_mfma_f32_16x16x32_bf16 v[12:15], a[40:43], a[36:39], 0
  ds_read_b64_tr_b16 a[14:15], v112 offset:47104
  s_waitcnt lgkmcnt(6)
  v_mfma_f32_16x16x32_bf16 v[8:11], a[44:47], a[32:35], 0
  s_barrier
  ds_read_b128 a[16:19], v113 offset:40960
  v_add_u32 v111, 65536, v111
  ds_read_b64_tr_b16 a[24:25], v111 offset:24576
  v_mfma_f32_16x16x32_bf16 v[16:19], a[44:47], a[36:39], 0
  ds_read_b64_tr_b16 a[26:27], v111 offset:26624
  ds_read_b128 a[20:23], v113 offset:41984
  s_waitcnt lgkmcnt(6)
  v_mfma_f32_16x16x32_bf16 v[4:7], a[8:11], a[0:3], v[4:7]
  v_add_u32 v112, 65536, v112
  ds_read_b64_tr_b16 a[28:29], v112 offset:24576
  v_mfma_f32_16x16x32_bf16 v[12:15], a[8:11], a[4:7], v[12:15]
  ds_read_b64_tr_b16 a[30:31], v112 offset:26624
  s_waitcnt lgkmcnt(6)
  v_mfma_f32_16x16x32_bf16 v[8:11], a[12:15], a[0:3], v[8:11]
  ds_read_b128 a[32:35], v113 offset:45056
  ds_read_b64_tr_b16 a[40:41], v111 offset:28672
  v_mfma_f32_16x16x32_bf16 v[16:19], a[12:15], a[4:7], v[16:19]
  ds_read_b64_tr_b16 a[42:43], v111 offset:30720
  ds_read_b128 a[36:39], v113 offset:46080
  s_waitcnt lgkmcnt(6)
  v_mfma_f32_16x16x32_bf16 v[4:7], a[24:27], a[16:19], v[4:7]
  ds_read_b64_tr_b16 a[44:45], v112 offset:28672
  v_mfma_f32_16x16x32_bf16 v[12:15], a[24:27], a[20:23], v[12:15]
  ds_read_b64_tr_b16 a[46:47], v112 offset:30720
  s_waitcnt lgkmcnt(6)
  v_mfma_f32_16x16x32_bf16 v[8:11], a[28:31], a[16:19], v[8:11]
  s_barrier
  ds_read_b128 a[0:3], v113 offset:49152
  ds_read_b64_tr_b16 a[8:9], v111 offset:57344
  s_waitcnt vmcnt(0)
  v_mul_f32 v52, v52, v117
  v_mul_f32 v53, v53, v117
  v_mul_f32 v54, v54, v117
  v_mul_f32 v55, v55, v117
  v_mul_f32 v56, v56, v117
  v_mul_f32 v57, v57, v117
  v_mul_f32 v58, v58, v117
  v_mfma_f32_16x16x32_bf16 v[16:19], a[28:31], a[20:23], v[16:19]
  ds_read_b64_tr_b16 a[10:11], v111 offset:59392
  ds_read_b128 a[4:7], v113 offset:50176
  v_mul_f32 v59, v59, v117
  v_mul_f32 v60, v60, v119
  v_mul_f32 v61, v61, v119
  v_mul_f32 v62, v62, v119
  v_mul_f32 v63, v63, v119
  v_mul_f32 v64, v64, v119
  v_mul_f32 v65, v65, v119
  v_mul_f32 v66, v66, v119
  s_waitcnt lgkmcnt(6)
  v_mfma_f32_16x16x32_bf16 v[4:7], a[40:43], a[32:35], v[4:7]
  ds_read_b64_tr_b16 a[12:13], v112 offset:57344
  v_mul_f32 v67, v67, v119
  v_mfma_f32_16x16x32_bf16 v[12:15], a[40:43], a[36:39], v[12:15]
  ds_read_b64_tr_b16 a[14:15], v112 offset:59392
  s_waitcnt lgkmcnt(6)
  v_mfma_f32_16x16x32_bf16 v[8:11], a[44:47], a[32:35], v[8:11]
  ds_read_b128 a[16:19], v113 offset:53248
  ds_read_b64_tr_b16 a[24:25], v111 offset:61440
  v_mfma_f32_16x16x32_bf16 v[16:19], a[44:47], a[36:39], v[16:19]
  ds_read_b64_tr_b16 a[26:27], v111 offset:63488
  ds_read_b128 a[20:23], v113 offset:54272
  s_waitcnt lgkmcnt(6)
  v_mfma_f32_16x16x32_bf16 v[4:7], a[8:11], a[0:3], v[4:7]
  ds_read_b64_tr_b16 a[28:29], v112 offset:61440
  v_mfma_f32_16x16x32_bf16 v[12:15], a[8:11], a[4:7], v[12:15]
  ds_read_b64_tr_b16 a[30:31], v112 offset:63488
  s_waitcnt lgkmcnt(6)
  v_mfma_f32_16x16x32_bf16 v[8:11], a[12:15], a[0:3], v[8:11]
  s_barrier
  v_add_u32 v113, 4294901760, v113
  ds_read_b128 a[32:35], v113 offset:0
  v_add_u32 v111, 4294901760, v111
  ds_read_b64_tr_b16 a[40:41], v111 offset:32768
  v_mfma_f32_16x16x32_bf16 v[16:19], a[12:15], a[4:7], v[16:19]
  ds_read_b64_tr_b16 a[42:43], v111 offset:34816
  ds_read_b128 a[36:39], v113 offset:1024
  s_waitcnt lgkmcnt(6)
  v_mfma_f32_16x16x32_bf16 v[4:7], a[24:27], a[16:19], v[4:7]
  v_add_u32 v112, 4294901760, v112
  ds_read_b64_tr_b16 a[44:45], v112 offset:32768
  v_mfma_f32_16x16x32_bf16 v[12:15], a[24:27], a[20:23], v[12:15]
  ds_read_b64_tr_b16 a[46:47], v112 offset:34816
  s_waitcnt lgkmcnt(6)
  v_mfma_f32_16x16x32_bf16 v[8:11], a[28:31], a[16:19], v[8:11]
  ds_read_b128 a[0:3], v113 offset:4096
  ds_read_b64_tr_b16 a[8:9], v111 offset:36864
  v_mfma_f32_16x16x32_bf16 v[16:19], a[28:31], a[20:23], v[16:19]
  ds_read_b64_tr_b16 a[10:11], v111 offset:38912
  ds_read_b128 a[4:7], v113 offset:5120
  s_waitcnt lgkmcnt(6)
  v_mfma_f32_16x16x32_bf16 v[4:7], a[40:43], a[32:35], v[4:7]
  ds_read_b64_tr_b16 a[12:13], v112 offset:36864
  v_mfma_f32_16x16x32_bf16 v[12:15], a[40:43], a[36:39], v[12:15]
  ds_read_b64_tr_b16 a[14:15], v112 offset:38912
  s_waitcnt lgkmcnt(6)
  v_mfma_f32_16x16x32_bf16 v[8:11], a[44:47], a[32:35], v[8:11]
  s_barrier
  ds_read_b128 a[16:19], v113 offset:16384
  v_add_u32 v111, 65536, v111
  ds_read_b64_tr_b16 a[24:25], v111 offset:0
  v_mfma_f32_16x16x32_bf16 v[16:19], a[44:47], a[36:39], v[16:19]
  ds_read_b64_tr_b16 a[26:27], v111 offset:2048
  ds_read_b128 a[20:23], v113 offset:17408
  s_waitcnt lgkmcnt(6)
  v_mfma_f32_16x16x32_bf16 v[4:7], a[8:11], a[0:3], v[4:7]
  v_add_u32 v112, 65536, v112
  ds_read_b64_tr_b16 a[28:29], v112 offset:0
  v_mfma_f32_16x16x32_bf16 v[12:15], a[8:11], a[4:7], v[12:15]
  ds_read_b64_tr_b16 a[30:31], v112 offset:2048
  s_waitcnt lgkmcnt(6)
  v_mfma_f32_16x16x32_bf16 v[8:11], a[12:15], a[0:3], v[8:11]
  ds_read_b128 a[32:35], v113 offset:20480
  ds_read_b64_tr_b16 a[40:41], v111 offset:4096
  v_mfma_f32_16x16x32_bf16 v[16:19], a[12:15], a[4:7], v[16:19]
  ds_read_b64_tr_b16 a[42:43], v111 offset:6144
  ds_read_b128 a[36:39], v113 offset:21504
  s_waitcnt lgkmcnt(6)
  v_mfma_f32_16x16x32_bf16 v[4:7], a[24:27], a[16:19], v[4:7]
  ds_read_b64_tr_b16 a[44:45], v112 offset:4096
  v_mfma_f32_16x16x32_bf16 v[12:15], a[24:27], a[20:23], v[12:15]
  ds_read_b64_tr_b16 a[46:47], v112 offset:6144
  s_waitcnt lgkmcnt(6)
  v_mfma_f32_16x16x32_bf16 v[8:11], a[28:31], a[16:19], v[8:11]
  s_barrier
  ds_read_b128 a[0:3], v113 offset:24576
  ds_read_b64_tr_b16 a[8:9], v111 offset:8192
  v_mfma_f32_16x16x32_bf16 v[16:19], a[28:31], a[20:23], v[16:19]
  ds_read_b64_tr_b16 a[10:11], v111 offset:10240
  ds_read_b128 a[4:7], v113 offset:25600
  s_waitcnt lgkmcnt(6)
  v_mfma_f32_16x16x32_bf16 v[4:7], a[40:43], a[32:35], v[4:7]
  ds_read_b64_tr_b16 a[12:13], v112 offset:8192
  v_mfma_f32_16x16x32_bf16 v[12:15], a[40:43], a[36:39], v[12:15]
  ds_read_b64_tr_b16 a[14:15], v112 offset:10240
  s_waitcnt lgkmcnt(6)
  v_mfma_f32_16x16x32_bf16 v[8:11], a[44:47], a[32:35], v[8:11]
  ds_read_b128 a[16:19], v113 offset:28672
  ds_read_b64_tr_b16 a[24:25], v111 offset:12288
  v_mfma_f32_16x16x32_bf16 v[16:19], a[44:47], a[36:39], v[16:19]
  ds_read_b64_tr_b16 a[26:27], v111 offset:14336
  ds_read_b128 a[20:23], v113 offset:29696
  s_waitcnt lgkmcnt(6)
  v_mfma_f32_16x16x32_bf16 v[4:7], a[8:11], a[0:3], v[4:7]
  ds_read_b64_tr_b16 a[28:29], v112 offset:12288
  v_mfma_f32_16x16x32_bf16 v[12:15], a[8:11], a[4:7], v[12:15]
  ds_read_b64_tr_b16 a[30:31], v112 offset:14336
  s_waitcnt lgkmcnt(6)
  v_mfma_f32_16x16x32_bf16 v[8:11], a[12:15], a[0:3], v[8:11]
  s_barrier
  ds_read_b128 a[32:35], v113 offset:49152
  v_add_u32 v111, 4294901760, v111
  ds_read_b64_tr_b16 a[40:41], v111 offset:57344
  v_mfma_f32_16x16x32_bf16 v[16:19], a[12:15], a[4:7], v[16:19]
  ds_read_b64_tr_b16 a[42:43], v111 offset:59392
  ds_read_b128 a[36:39], v113 offset:50176
  s_waitcnt lgkmcnt(6)
  v_mfma_f32_16x16x32_bf16 v[4:7], a[24:27], a[16:19], v[4:7]
  v_add_u32 v112, 4294901760, v112
  ds_read_b64_tr_b16 a[44:45], v112 offset:57344
  v_mfma_f32_16x16x32_bf16 v[12:15], a[24:27], a[20:23], v[12:15]
  ds_read_b64_tr_b16 a[46:47], v112 offset:59392
  s_waitcnt lgkmcnt(6)
  v_mfma_f32_16x16x32_bf16 v[8:11], a[28:31], a[16:19], v[8:11]
  ds_read_b128 a[0:3], v113 offset:53248
  ds_read_b64_tr_b16 a[8:9], v111 offset:61440
  v_mfma_f32_16x16x32_bf16 v[16:19], a[28:31], a[20:23], v[16:19]
  ds_read_b64_tr_b16 a[10:11], v111 offset:63488
  ds_read_b128 a[4:7], v113 offset:54272
  s_waitcnt lgkmcnt(6)
  v_mfma_f32_16x16x32_bf16 v[4:7], a[40:43], a[32:35], v[4:7]
  ds_read_b64_tr_b16 a[12:13], v112 offset:61440
  v_mfma_f32_16x16x32_bf16 v[12:15], a[40:43], a[36:39], v[12:15]
  ds_read_b64_tr_b16 a[14:15], v112 offset:63488
  s_waitcnt lgkmcnt(6)
  v_mfma_f32_16x16x32_bf16 v[8:11], a[44:47], a[32:35], v[8:11]
  s_barrier
  ds_read_b128 a[16:19], v113 offset:8192
  v_add_u32 v111, 65536, v111
  ds_read_b64_tr_b16 a[24:25], v111 offset:16384
  v_mfma_f32_16x16x32_bf16 v[16:19], a[44:47], a[36:39], v[16:19]
  ds_read_b64_tr_b16 a[26:27], v111 offset:18432
  ds_read_b128 a[20:23], v113 offset:9216
  s_waitcnt lgkmcnt(6)
  v_mfma_f32_16x16x32_bf16 v[4:7], a[8:11], a[0:3], v[4:7]
  v_add_u32 v112, 65536, v112
  ds_read_b64_tr_b16 a[28:29], v112 offset:16384
  v_mfma_f32_16x16x32_bf16 v[12:15], a[8:11], a[4:7], v[12:15]
  ds_read_b64_tr_b16 a[30:31], v112 offset:18432
  s_waitcnt lgkmcnt(6)
  v_mfma_f32_16x16x32_bf16 v[8:11], a[12:15], a[0:3], v[8:11]
  ds_read_b128 a[32:35], v113 offset:12288
  ds_read_b64_tr_b16 a[40:41], v111 offset:20480
  v_mfma_f32_16x16x32_bf16 v[16:19], a[12:15], a[4:7], v[16:19]
  ds_read_b64_tr_b16 a[42:43], v111 offset:22528
  ds_read_b128 a[36:39], v113 offset:13312
  s_waitcnt lgkmcnt(6)
  v_mfma_f32_16x16x32_bf16 v[4:7], a[24:27], a[16:19], v[4:7]
  ds_read_b64_tr_b16 a[44:45], v112 offset:20480
  v_mfma_f32_16x16x32_bf16 v[12:15], a[24:27], a[20:23], v[12:15]
  ds_read_b64_tr_b16 a[46:47], v112 offset:22528
  s_waitcnt lgkmcnt(6)
  v_mfma_f32_16x16x32_bf16 v[8:11], a[28:31], a[16:19], v[8:11]
  v_mfma_f32_16x16x32_bf16 v[16:19], a[28:31], a[20:23], v[16:19]
  s_waitcnt lgkmcnt(2)
  v_mfma_f32_16x16x32_bf16 v[4:7], a[40:43], a[32:35], v[4:7]
  v_mfma_f32_16x16x32_bf16 v[12:15], a[40:43], a[36:39], v[12:15]
  s_waitcnt lgkmcnt(0)
  v_mfma_f32_16x16x32_bf16 v[8:11], a[44:47], a[32:35], v[8:11]
  v_mfma_f32_16x16x32_bf16 v[16:19], a[44:47], a[36:39], v[16:19]
  s_nop 3
  v_fma_f32 v4, v4, v116, v52
  v_fma_f32 v5, v5, v116, v53
  v_fma_f32 v6, v6, v116, v54
  v_fma_f32 v7, v7, v116, v55
  v_fma_f32 v8, v8, v116, v56
  v_fma_f32 v9, v9, v116, v57
  v_fma_f32 v10, v10, v116, v58
  v_fma_f32 v11, v11, v116, v59
  v_cvt_pk_bf16_f32 v68, v4, v5
  v_cvt_pk_bf16_f32 v69, v6, v7
  v_cvt_pk_bf16_f32 v70, v8, v9
  v_cvt_pk_bf16_f32 v71, v10, v11
  s_nop 0
  v_permlane16_swap_b32 v68, v70
  v_permlane16_swap_b32 v69, v71
  buffer_store_dwordx4 v[68:71], v120, s[48:51], 0 offen nt
  v_fma_f32 v12, v12, v118, v60
  v_fma_f32 v13, v13, v118, v61
  v_fma_f32 v14, v14, v118, v62
  v_fma_f32 v15, v15, v118, v63
  v_fma_f32 v16, v16, v118, v64
  v_fma_f32 v17, v17, v118, v65
  v_fma_f32 v18, v18, v118, v66
  v_fma_f32 v19, v19, v118, v67
  v_cvt_pk_bf16_f32 v72, v12, v13
  v_cvt_pk_bf16_f32 v73, v14, v15
  v_cvt_pk_bf16_f32 v74, v16, v17
  v_cvt_pk_bf16_f32 v75, v18, v19
  s_nop 0
  v_permlane16_swap_b32 v72, v74
  v_permlane16_swap_b32 v73, v75
  buffer_store_dwordx4 v[72:75], v120, s[48:51], s4 offen nt
  s_endpgm
L_slow_KVC_nonce:
  s_mov_b32 s68, 1000000
L_spin_KVC_nonce:
  s_sleep 4
  global_load_dword v115, v104, s[20:21] sc1
  s_waitcnt vmcnt(0)
  v_cmp_eq_u32 vcc, 0, v115
  s_cbranch_vccz L_back_KVC_nonce
  s_sub_u32 s68, s68, 1
  s_cmp_lg_u32 s68, 0
  s_cbranch_scc1 L_spin_KVC_nonce
  s_branch L_back_KVC_nonce
L_slow_KVC_hk:
  s_mov_b32 s68, 1000000
L_spin_KVC_hk:
  s_sleep 4
  buffer_load_dword v127, v124, s[44:47], 0 offen sc1
  s_waitcnt vmcnt(0)
  v_cmp_ne_u32 vcc, v127, v115
  s_cbranch_vccz L_back_KVC_hk
  s_sub_u32 s68, s68, 1
  s_cmp_lg_u32 s68, 0
  s_cbranch_scc1 L_spin_KVC_hk
  s_branch L_back_KVC_hk
L_slow_KVC_o:
  s_mov_b32 s68, 1000000
L_spin_KVC_o:
  s_sleep 4
  buffer_load_dword v127, v125, s[44:47], 0 offen sc1
  s_waitcnt vmcnt(0)
  v_cmp_ne_u32 vcc, v127, v115
  s_cbranch_vccz L_back_KVC_o
  s_sub_u32 s68, s68, 1
  s_cmp_lg_u32 s68, 0
  s_cbranch_scc1 L_spin_KVC_o
  s_branch L_back_KVC_o
L_KVL_rest:
  s_lshr_b32 s58, s2, 6
  s_and_b32 s57, s58, 0
  s_lshr_b32 s62, s2, 3
  s_xor_b32 s57, s57, s62
  s_and_b32 s57, s57, 7
  s_and_b32 s62, s2, 7
  s_lshl2_add_u32 s56, s62, s58
  s_lshl_b32 s60, s52, 11
  s_mul_i32 s61, s52, 3072
  s_sub_u32 s32, s12, 4096
  s_subb_u32 s33, s13, 0
  s_and_b32 s33, s33, 0xffff
  s_mov_b32 s34, 1839104
  s_mov_b32 s35, 0x20000
  s_mov_b32 s36, s14
  s_and_b32 s37, s15, 0xffff
  s_mov_b32 s38, 1835008
  s_mov_b32 s39, 0x20000
  s_mov_b32 s40, s8
  s_and_b32 s41, s9, 0xffff
  s_mov_b32 s42, 524288
  s_mov_b32 s43, 0x20000
  s_mov_b32 s44, s22
  s_and_b32 s45, s23, 0xffff
  s_mov_b32 s46, 10354688
  s_mov_b32 s47, 0x20000
  s_mul_i32 s62, s54, 192
  s_add_u32 s62, s62, 6144
  s_and_b32 s63, s54, 1
  s_lshl_b32 s64, s63, 6
  s_add_u32 s64, s64, s62
  s_xor_b32 s63, s63, 1
  s_lshl_b32 s63, s63, 7
  s_add_u32 s63, s63, s62
  s_mov_b32 s62, 3584
  v_mad_u32_u24 v5, v17, s62, v16
  v_add_u32 v20, s64, v5
  v_xor_b32 v21, 64, v20
  v_add_u32 v21, 27648, v21
  v_lshrrev_b32 v4, 2, v1
  s_lshl_b32 s64, s52, 4
  v_add_u32 v4, s64, v4
  v_lshrrev_b32 v5, 4, v1
  v_and_b32 v5, 2, v5
  v_xor_b32 v5, v5, v1
  v_and_b32 v5, 3, v5
  v_lshlrev_b32 v5, 4, v5
  v_mad_u32_u24 v5, v4, s62, v5
  s_sub_u32 s63, s63, 2048
  v_add_u32 v22, s63, v5
  v_lshrrev_b32 v5, 3, v1
  v_and_b32 v5, 6, v5
  v_xor_b32 v5, v5, v1
  v_and_b32 v5, 7, v5
  v_lshlrev_b32 v5, 4, v5
  v_lshl_add_u32 v24, v17, 10, v5
  s_lshl_b32 s62, s57, 7
  v_add_u32 v24, s62, v24
  v_add_u32 v25, 7168, v24
  v_add_u32 v26, s60, v18
  v_add_u32 v27, s60, v18
  s_mul_i32 s67, s56, 294912
  s_mul_i32 s62, s58, 1
  s_lshr_b32 s63, s57, 0
  s_mul_i32 s63, s63, 1
  s_add_u32 s62, s62, s63
  s_add_u32 s9, s62, 0
  s_and_b32 s9, s9, 3
  s_lshl_b32 s9, s9, 13
  s_add_u32 s18, s62, 1
  s_and_b32 s18, s18, 3
  s_lshl_b32 s18, s18, 13
  s_add_u32 s19, s62, 2
  s_and_b32 s19, s19, 3
  s_lshl_b32 s19, s19, 13
  s_add_u32 s22, s62, 3
  s_and_b32 s22, s22, 3
  s_lshl_b32 s22, s22, 13
  v_bfe_u32 v4, v1, 1, 3
  v_lshlrev_b32 v4, 7, v4
  v_and_b32 v5, 1, v1
  v_lshl_add_u32 v4, v5, 2, v4
  s_lshr_b32 s62, s56, 1
  s_lshl_b32 s62, s62, 10
  s_and_b32 s63, s56, 1
  s_lshl_b32 s63, s63, 3
  s_add_u32 s62, s62, s63
  s_add_u32 s62, s62, 10010624
  v_add_u32 v28, s62, v4
  v_add_u32 v29, 16384, v28
  v_add_u32 v30, 49152, v28
  s_mov_b32 s13, 0x3f803f80
  v_mov_b32 v31, 161792
  ds_write_b32 v31, v19 offset:0
  ds_write_b32 v31, v19 offset:4
  ds_write_b32 v31, v19 offset:8
  s_lshl_b32 s62, s52, 10
  s_add_u32 s62, s62, 141312
  v_add_u32 v32, s62, v18
  s_lshl_b32 s62, s52, 2
  s_add_u32 s62, s62, 157696
  v_add_u32 v33, s62, v18
  v_lshlrev_b32 v34, 2, v1
  s_lshl_b32 s62, s54, 2
  s_add_u32 s62, s62, s52
  s_lshl_b32 s62, s62, 4
  s_add_u32 s62, s62, s53
  s_lshl_b32 s14, s62, 10
  s_add_u32 s14, s14, 9437184
  s_lshl_b32 s15, s62, 6
  s_add_u32 s15, s15, 9961472
  s_add_u32 s55, s69, 128
  s_and_b32 s55, s55, 255
  s_add_u32 m0, s59, 32768
  s_mul_i32 s62, s55, 1536
  buffer_load_dwordx4 v8, s[24:27], s55 offen offset:0 lds
  buffer_load_dwordx4 v9, s[24:27], s55 offen offset:1024 lds
  buffer_load_dwordx4 v10, s[24:27], s55 offen offset:2048 lds
  buffer_load_dwordx4 v11, s[24:27], s55 offen offset:3072 lds
  s_add_u32 m0, s59, 49152
  s_nop 0
  buffer_load_dwordx4 v12, s[28:31], s62 offen offset:0 lds
  buffer_load_dwordx4 v13, s[28:31], s62 offen offset:1024 lds
  buffer_load_dwordx4 v14, s[28:31], s62 offen offset:2048 lds
  buffer_load_dwordx4 v15, s[28:31], s62 offen offset:3072 lds
  s_waitcnt vmcnt(8)
  s_barrier
  s_or_b32 s55, s69, 256
  s_add_u32 m0, s59, 65536
  s_mul_i32 s62, s55, 1536
  buffer_load_dwordx4 v8, s[24:27], s55 offen offset:0 lds
  buffer_load_dwordx4 v9, s[24:27], s55 offen offset:1024 lds
  buffer_load_dwordx4 v10, s[24:27], s55 offen offset:2048 lds
  buffer_load_dwordx4 v11, s[24:27], s55 offen offset:3072 lds
  s_add_u32 m0, s59, 81920
  s_nop 0
  buffer_load_dwordx4 v12, s[28:31], s62 offen offset:0 lds
  buffer_load_dwordx4 v13, s[28:31], s62 offen offset:1024 lds
  buffer_load_dwordx4 v14, s[28:31], s62 offen offset:2048 lds
  buffer_load_dwordx4 v15, s[28:31], s62 offen offset:3072 lds
  s_waitcnt vmcnt(8)
  s_barrier
  s_add_u32 s55, s69, 128
  s_and_b32 s55, s55, 255
  s_or_b32 s55, s55, 256
  s_add_u32 m0, s59, 0
  s_mul_i32 s62, s55, 1536
  buffer_load_dwordx4 v8, s[24:27], s55 offen offset:0 lds
  buffer_load_dwordx4 v9, s[24:27], s55 offen offset:1024 lds
  buffer_load_dwordx4 v10, s[24:27], s55 offen offset:2048 lds
  buffer_load_dwordx4 v11, s[24:27], s55 offen offset:3072 lds
  s_add_u32 m0, s59, 98304
  s_nop 0
  buffer_load_dwordx4 v12, s[28:31], s62 offen offset:0 lds
  buffer_load_dwordx4 v13, s[28:31], s62 offen offset:1024 lds
  buffer_load_dwordx4 v14, s[28:31], s62 offen offset:2048 lds
  buffer_load_dwordx4 v15, s[28:31], s62 offen offset:3072 lds
  s_waitcnt vmcnt(8)
  s_barrier
  s_or_b32 s55, s69, 512
  s_add_u32 m0, s59, 16384
  s_mul_i32 s62, s55, 1536
  buffer_load_dwordx4 v8, s[24:27], s55 offen offset:0 lds
  buffer_load_dwordx4 v9, s[24:27], s55 offen offset:1024 lds
  buffer_load_dwordx4 v10, s[24:27], s55 offen offset:2048 lds
  buffer_load_dwordx4 v11, s[24:27], s55 offen offset:3072 lds
  s_add_u32 m0, s59, 32768
  s_nop 0
  buffer_load_dwordx4 v12, s[28:31], s62 offen offset:0 lds
  buffer_load_dwordx4 v13, s[28:31], s62 offen offset:1024 lds
  buffer_load_dwordx4 v14, s[28:31], s62 offen offset:2048 lds
  buffer_load_dwordx4 v15, s[28:31], s62 offen offset:3072 lds
  s_waitcnt vmcnt(8)
  s_barrier
  s_add_u32 s55, s69, 128
  s_and_b32 s55, s55, 255
  s_or_b32 s55, s55, 512
  s_add_u32 m0, s59, 49152
  s_mul_i32 s62, s55, 1536
  buffer_load_dwordx4 v8, s[24:27], s55 offen offset:0 lds
  buffer_load_dwordx4 v9, s[24:27], s55 offen offset:1024 lds
  buffer_load_dwordx4 v10, s[24:27], s55 offen offset:2048 lds
  buffer_load_dwordx4 v11, s[24:27], s55 offen offset:3072 lds
  s_add_u32 m0, s59, 65536
  s_nop 0
  buffer_load_dwordx4 v12, s[28:31], s62 offen offset:0 lds
  buffer_load_dwordx4 v13, s[28:31], s62 offen offset:1024 lds
  buffer_load_dwordx4 v14, s[28:31], s62 offen offset:2048 lds
  buffer_load_dwordx4 v15, s[28:31], s62 offen offset:3072 lds
  s_waitcnt vmcnt(8)
  s_barrier
  s_or_b32 s55, s69, 768
  s_add_u32 m0, s59, 0
  s_mul_i32 s62, s55, 1536
  buffer_load_dwordx4 v8, s[24:27], s55 offen offset:0 lds
  buffer_load_dwordx4 v9, s[24:27], s55 offen offset:1024 lds
  buffer_load_dwordx4 v10, s[24:27], s55 offen offset:2048 lds
  buffer_load_dwordx4 v11, s[24:27], s55 offen offset:3072 lds
  s_add_u32 m0, s59, 81920
  s_nop 0
  buffer_load_dwordx4 v12, s[28:31], s62 offen offset:0 lds
  buffer_load_dwordx4 v13, s[28:31], s62 offen offset:1024 lds
  buffer_load_dwordx4 v14, s[28:31], s62 offen offset:2048 lds
  buffer_load_dwordx4 v15, s[28:31], s62 offen offset:3072 lds
  global_load_dword v35, v19, s[20:21] sc1
  s_waitcnt vmcnt(9)
  s_barrier
  s_add_u32 s55, s69, 128
  s_and_b32 s55, s55, 255
  s_or_b32 s55, s55, 768
  s_add_u32 m0, s59, 16384
  s_mul_i32 s62, s55, 1536
  buffer_load_dwordx4 v8, s[24:27], s55 offen offset:0 lds
  buffer_load_dwordx4 v9, s[24:27], s55 offen offset:1024 lds
  buffer_load_dwordx4 v10, s[24:27], s55 offen offset:2048 lds
  buffer_load_dwordx4 v11, s[24:27], s55 offen offset:3072 lds
  s_add_u32 m0, s59, 98304
  s_nop 0
  buffer_load_dwordx4 v12, s[28:31], s62 offen offset:0 lds
  buffer_load_dwordx4 v13, s[28:31], s62 offen offset:1024 lds
  buffer_load_dwordx4 v14, s[28:31], s62 offen offset:2048 lds
  buffer_load_dwordx4 v15, s[28:31], s62 offen offset:3072 lds
  s_waitcnt vmcnt(9)
  s_waitcnt lgkmcnt(0)
  s_barrier
  s_mov_b32 s55, s69
  s_add_u32 m0, s61, 32768
  s_mul_i32 s62, s55, 1792
  buffer_load_dwordx4 v20, s[32:35], s62 offen offset:0 lds
  buffer_load_dwordx4 v21, s[32:35], s62 offen offset:1024 lds
  buffer_load_dwordx4 v22, s[32:35], s62 offen offset:2048 lds
  s_add_u32 s55, s69, 128
  s_and_b32 s55, s55, 255
  s_add_u32 m0, s61, 45056
  s_mul_i32 s62, s55, 1792
  buffer_load_dwordx4 v20, s[32:35], s62 offen offset:0 lds
  buffer_load_dwordx4 v21, s[32:35], s62 offen offset:1024 lds
  buffer_load_dwordx4 v22, s[32:35], s62 offen offset:2048 lds
  s_or_b32 s55, s69, 256
  s_add_u32 m0, s61, 114688
  s_mul_i32 s62, s55, 1792
  buffer_load_dwordx4 v20, s[32:35], s62 offen offset:0 lds
  buffer_load_dwordx4 v21, s[32:35], s62 offen offset:1024 lds
  buffer_load_dwordx4 v22, s[32:35], s62 offen offset:2048 lds
  s_lshr_b32 s65, s2, 4
  s_lshl_b32 s65, s65, 3
  s_and_b32 s63, s2, 7
  s_add_u32 s65, s65, s63
  s_lshl_b32 s65, s65, 2
  s_add_u32 s65, s65, s52
  s_mul_i32 s63, s65, 3584
  s_add_u32 s63, s63, 0
  v_lshlrev_b32 v6, 7, v1
  v_add_u32 v6, s63, v6
  v_cmp_le_u32 vcc, 28, v1
  s_nop 1
  v_cndmask_b32 v6, v6, -1, vcc
  buffer_load_dword v3, v6, s[36:39], 0 offen
  s_mul_i32 s63, s65, 1024
  s_add_u32 s63, s63, 0
  v_lshlrev_b32 v6, 7, v1
  v_add_u32 v6, s63, v6
  v_cmp_le_u32 vcc, 8, v1
  s_nop 1
  v_cndmask_b32 v6, v6, -1, vcc
  buffer_load_dword v3, v6, s[40:43], 0 offen
  s_waitcnt vmcnt(11)
  s_barrier
  s_add_u32 s55, s69, 128
  s_and_b32 s55, s55, 255
  s_or_b32 s55, s55, 256
  s_add_u32 m0, s61, 57344
  s_mul_i32 s62, s55, 1792
  buffer_load_dwordx4 v20, s[32:35], s62 offen offset:0 lds
  buffer_load_dwordx4 v21, s[32:35], s62 offen offset:1024 lds
  buffer_load_dwordx4 v22, s[32:35], s62 offen offset:2048 lds
  s_or_b32 s55, s69, 512
  s_add_u32 m0, s61, 69632
  s_mul_i32 s62, s55, 1792
  buffer_load_dwordx4 v20, s[32:35], s62 offen offset:0 lds
  buffer_load_dwordx4 v21, s[32:35], s62 offen offset:1024 lds
  buffer_load_dwordx4 v22, s[32:35], s62 offen offset:2048 lds
  v_cmp_eq_u32 vcc, 0, v35
  s_cbranch_vccnz L_slow_KVL_nonce
L_back_KVL_nonce:
  s_barrier
  s_add_u32 s55, s69, 128
  s_and_b32 s55, s55, 255
  s_or_b32 s55, s55, 512
  s_add_u32 m0, s61, 0
  s_mul_i32 s62, s55, 1792
  buffer_load_dwordx4 v20, s[32:35], s62 offen offset:0 lds
  buffer_load_dwordx4 v21, s[32:35], s62 offen offset:1024 lds
  buffer_load_dwordx4 v22, s[32:35], s62 offen offset:2048 lds
  s_or_b32 s55, s69, 768
  s_add_u32 m0, s61, 12288
  s_mul_i32 s62, s55, 1792
  buffer_load_dwordx4 v20, s[32:35], s62 offen offset:0 lds
  buffer_load_dwordx4 v21, s[32:35], s62 offen offset:1024 lds
  buffer_load_dwordx4 v22, s[32:35], s62 offen offset:2048 lds
  s_add_u32 s55, s69, 128
  s_and_b32 s55, s55, 255
  s_or_b32 s55, s55, 768
  s_add_u32 m0, s61, 81920
  s_mul_i32 s62, s55, 1792
  buffer_load_dwordx4 v20, s[32:35], s62 offen offset:0 lds
  buffer_load_dwordx4 v21, s[32:35], s62 offen offset:1024 lds
  buffer_load_dwordx4 v22, s[32:35], s62 offen offset:2048 lds
  s_add_u32 m0, s60, 24576
  s_mov_b32 s63, s9
  s_lshl3_add_u32 s63, s63, 0
  buffer_load_dwordx4 v24, s[36:39], s63 offen offset:0 lds
  buffer_load_dwordx4 v25, s[36:39], s63 offen offset:1024 lds
  s_add_u32 m0, s60, 94208
  s_mov_b32 s63, s18
  s_lshl3_add_u32 s63, s63, 0
  buffer_load_dwordx4 v24, s[36:39], s63 offen offset:0 lds
  buffer_load_dwordx4 v25, s[36:39], s63 offen offset:1024 lds
  s_waitcnt vmcnt(16)
  s_barrier
  ds_read_b128 v[36:39], v32 offset:0
  ds_read_b128 v[40:43], v32 offset:4096
  ds_read_b128 v[44:47], v32 offset:8192
  ds_read_b128 v[48:51], v32 offset:12288
  ds_read_b32 v52, v33 offset:0
  ds_read_b32 v53, v33 offset:1024
  ds_read_b32 v54, v33 offset:2048
  ds_read_b32 v55, v33 offset:3072
  s_waitcnt lgkmcnt(4)
  v_add_f32 v36, v36, v40
  v_add_f32 v44, v44, v48
  v_add_f32 v37, v37, v41
  v_add_f32 v45, v45, v49
  v_add_f32 v38, v38, v42
  v_add_f32 v46, v46, v50
  v_add_f32 v39, v39, v43
  v_add_f32 v47, v47, v51
  v_add_f32 v36, v36, v44
  v_add_f32 v37, v37, v45
  v_add_f32 v38, v38, v46
  v_add_f32 v39, v39, v47
  buffer_store_dwordx4 v[36:39], v18, s[44:47], s14 offen sc1
  s_waitcnt lgkmcnt(0)
  v_add_f32 v52, v52, v53
  v_add_f32 v54, v54, v55
  v_add_f32 v52, v52, v54
  v_mov_b32 v53, v52
  s_nop 1
  v_permlane16_swap_b32 v53, v52
  v_add_f32 v52, v52, v53
  v_mov_b32 v53, v52
  s_nop 1
  v_permlane32_swap_b32 v53, v52
  v_add_f32 v52, v52, v53
  s_mov_b64 exec, 0xffff
  buffer_store_dword v52, v34, s[44:47], s15 offen sc1
  s_mov_b64 exec, -1
  s_waitcnt vmcnt(0)
  s_lshl_b32 s65, s54, 4
  s_add_u32 s65, s65, s53
  s_lshl_b32 s65, s65, 5
  s_add_u32 s65, s65, s52
  s_lshl_b32 s65, s65, 2
  s_add_u32 s65, s65, 10076160
  s_mov_b64 exec, 1
  buffer_store_dword v35, off, s[44:47], s65 sc1
  s_mov_b64 exec, -1
  s_add_u32 m0, s60, 102400
  s_mov_b32 s63, s19
  s_lshl3_add_u32 s63, s63, 0
  buffer_load_dwordx4 v24, s[36:39], s63 offen offset:0 lds
  buffer_load_dwordx4 v25, s[36:39], s63 offen offset:1024 lds
  s_add_u32 m0, s60, 126976
  s_mov_b32 s63, s22
  s_lshl3_add_u32 s63, s63, 0
  buffer_load_dwordx4 v24, s[36:39], s63 offen offset:0 lds
  buffer_load_dwordx4 v25, s[36:39], s63 offen offset:1024 lds
  s_barrier
  s_add_u32 m0, s60, 32768
  s_mov_b32 s63, s9
  s_lshl3_add_u32 s63, s63, 262144
  buffer_load_dwordx4 v24, s[36:39], s63 offen offset:0 lds
  buffer_load_dwordx4 v25, s[36:39], s63 offen offset:1024 lds
  s_barrier
  buffer_load_dword v60, v28, s[44:47], 0 offen sc1
  s_waitcnt vmcnt(0)
  v_cmp_ne_u32 vcc, v60, v35
  s_cbranch_vccnz L_slow_KVL_hq
L_back_KVL_hq:
  s_cmp_lg_u32 s52, 0
  s_cbranch_scc1 L_post_KVL_hq
  ds_write_b32 v31, v35 offset:0
L_post_KVL_hq:
  s_add_u32 m0, s60, 40960
  s_mov_b32 s64, s9
  s_add_u32 s64, s64, s67
  buffer_load_dwordx4 v26, s[44:47], s64 offen offset:0 sc1 lds
  buffer_load_dwordx4 v26, s[44:47], s64 offen offset:1024 sc1 lds
  s_add_u32 m0, s60, 49152
  s_mov_b32 s64, s18
  s_add_u32 s64, s64, s67
  buffer_load_dwordx4 v26, s[44:47], s64 offen offset:0 sc1 lds
  buffer_load_dwordx4 v26, s[44:47], s64 offen offset:1024 sc1 lds
  s_add_u32 m0, s60, 57344
  s_mov_b32 s64, s19
  s_add_u32 s64, s64, s67
  buffer_load_dwordx4 v26, s[44:47], s64 offen offset:0 sc1 lds
  buffer_load_dwordx4 v26, s[44:47], s64 offen offset:1024 sc1 lds
  s_add_u32 m0, s60, 65536
  s_mov_b32 s63, s18
  s_lshl3_add_u32 s63, s63, 262144
  buffer_load_dwordx4 v24, s[36:39], s63 offen offset:0 lds
  buffer_load_dwordx4 v25, s[36:39], s63 offen offset:1024 lds
  s_add_u32 m0, s60, 73728
  s_mov_b32 s63, s19
  s_lshl3_add_u32 s63, s63, 262144
  buffer_load_dwordx4 v24, s[36:39], s63 offen offset:0 lds
  buffer_load_dwordx4 v25, s[36:39], s63 offen offset:1024 lds
  s_add_u32 m0, s60, 110592
  s_mov_b32 s63, s22
  s_lshl3_add_u32 s63, s63, 262144
  buffer_load_dwordx4 v24, s[36:39], s63 offen offset:0 lds
  buffer_load_dwordx4 v25, s[36:39], s63 offen offset:1024 lds
  s_waitcnt vmcnt(10)
  s_barrier
  s_add_u32 m0, s60, 0
  s_mov_b32 s64, s22
  s_add_u32 s64, s64, s67
  buffer_load_dwordx4 v26, s[44:47], s64 offen offset:0 sc1 lds
  buffer_load_dwordx4 v26, s[44:47], s64 offen offset:1024 sc1 lds
  s_add_u32 m0, s60, 8192
  s_mov_b32 s63, s9
  s_lshl3_add_u32 s63, s63, 524288
  buffer_load_dwordx4 v24, s[36:39], s63 offen offset:0 lds
  buffer_load_dwordx4 v25, s[36:39], s63 offen offset:1024 lds
  s_waitcnt vmcnt(12)
  s_barrier
  s_add_u32 m0, s60, 16384
  s_mov_b32 s64, s9
  s_add_u32 s64, s64, s67
  s_add_u32 s64, s64, 32768
  buffer_load_dwordx4 v26, s[44:47], s64 offen offset:0 sc1 lds
  buffer_load_dwordx4 v26, s[44:47], s64 offen offset:1024 sc1 lds
  s_add_u32 m0, s60, 81920
  s_mov_b32 s63, s18
  s_lshl3_add_u32 s63, s63, 524288
  buffer_load_dwordx4 v24, s[36:39], s63 offen offset:0 lds
  buffer_load_dwordx4 v25, s[36:39], s63 offen offset:1024 lds
  s_waitcnt vmcnt(14)
  s_barrier
  s_add_u32 m0, s60, 24576
  s_mov_b32 s64, s18
  s_add_u32 s64, s64, s67
  s_add_u32 s64, s64, 32768
  buffer_load_dwordx4 v26, s[44:47], s64 offen offset:0 sc1 lds
  buffer_load_dwordx4 v26, s[44:47], s64 offen offset:1024 sc1 lds
  s_add_u32 m0, s60, 40960
  s_mov_b32 s63, s19
  s_lshl3_add_u32 s63, s63, 524288
  buffer_load_dwordx4 v24, s[36:39], s63 offen offset:0 lds
  buffer_load_dwordx4 v25, s[36:39], s63 offen offset:1024 lds
  s_waitcnt vmcnt(10)
  s_barrier
  s_add_u32 m0, s60, 49152
  s_mov_b32 s64, s19
  s_add_u32 s64, s64, s67
  s_add_u32 s64, s64, 32768
  buffer_load_dwordx4 v26, s[44:47], s64 offen offset:0 sc1 lds
  buffer_load_dwordx4 v26, s[44:47], s64 offen offset:1024 sc1 lds
  s_add_u32 m0, s60, 90112
  s_mov_b32 s63, s22
  s_lshl3_add_u32 s63, s63, 524288
  buffer_load_dwordx4 v24, s[36:39], s63 offen offset:0 lds
  buffer_load_dwordx4 v25, s[36:39], s63 offen offset:1024 lds
  s_waitcnt vmcnt(10)
  s_barrier
  s_add_u32 m0, s60, 57344
  s_mov_b32 s64, s22
  s_add_u32 s64, s64, s67
  s_add_u32 s64, s64, 32768
  buffer_load_dwordx4 v26, s[44:47], s64 offen offset:0 sc1 lds
  buffer_load_dwordx4 v26, s[44:47], s64 offen offset:1024 sc1 lds
  s_add_u32 m0, s60, 98304
  s_mov_b32 s63, s9
  s_lshl3_add_u32 s63, s63, 786432
  buffer_load_dwordx4 v24, s[36:39], s63 offen offset:0 lds
  buffer_load_dwordx4 v25, s[36:39], s63 offen offset:1024 lds
  s_waitcnt vmcnt(10)
  s_barrier
  s_add_u32 m0, s60, 0
  s_mov_b32 s64, s9
  s_add_u32 s64, s64, s67
  s_add_u32 s64, s64, 65536
  buffer_load_dwordx4 v26, s[44:47], s64 offen offset:0 sc1 lds
  buffer_load_dwordx4 v26, s[44:47], s64 offen offset:1024 sc1 lds
  s_add_u32 m0, s60, 118784
  s_mov_b32 s63, s18
  s_lshl3_add_u32 s63, s63, 786432
  buffer_load_dwordx4 v24, s[36:39], s63 offen offset:0 lds
  buffer_load_dwordx4 v25, s[36:39], s63 offen offset:1024 lds
  s_waitcnt vmcnt(10)
  s_barrier
  s_add_u32 m0, s60, 16384
  s_mov_b32 s64, s18
  s_add_u32 s64, s64, s67
  s_add_u32 s64, s64, 65536
  buffer_load_dwordx4 v26, s[44:47], s64 offen offset:0 sc1 lds
  buffer_load_dwordx4 v26, s[44:47], s64 offen offset:1024 sc1 lds
  s_add_u32 m0, s60, 32768
  s_mov_b32 s63, s19
  s_lshl3_add_u32 s63, s63, 786432
  buffer_load_dwordx4 v24, s[36:39], s63 offen offset:0 lds
  buffer_load_dwordx4 v25, s[36:39], s63 offen offset:1024 lds
  s_waitcnt vmcnt(10)
  s_barrier
  s_add_u32 m0, s60, 24576
  s_mov_b32 s64, s19
  s_add_u32 s64, s64, s67
  s_add_u32 s64, s64, 65536
  buffer_load_dwordx4 v26, s[44:47], s64 offen offset:0 sc1 lds
  buffer_load_dwordx4 v26, s[44:47], s64 offen offset:1024 sc1 lds
  s_waitcnt vmcnt(8)
  s_barrier
  s_add_u32 m0, s60, 49152
  s_mov_b32 s64, s22
  s_add_u32 s64, s64, s67
  s_add_u32 s64, s64, 65536
  buffer_load_dwordx4 v26, s[44:47], s64 offen offset:0 sc1 lds
  buffer_load_dwordx4 v26, s[44:47], s64 offen offset:1024 sc1 lds
  s_add_u32 m0, s60, 65536
  s_mov_b32 s63, s22
  s_lshl3_add_u32 s63, s63, 786432
  buffer_load_dwordx4 v24, s[36:39], s63 offen offset:0 lds
  buffer_load_dwordx4 v25, s[36:39], s63 offen offset:1024 lds
  s_waitcnt vmcnt(8)
  s_barrier
  s_add_u32 m0, s60, 57344
  s_mov_b32 s64, s9
  s_add_u32 s64, s64, s67
  s_add_u32 s64, s64, 98304
  buffer_load_dwordx4 v26, s[44:47], s64 offen offset:0 sc1 lds
  buffer_load_dwordx4 v26, s[44:47], s64 offen offset:1024 sc1 lds
  s_add_u32 m0, s60, 73728
  s_mov_b32 s63, s9
  s_lshl3_add_u32 s63, s63, 1048576
  buffer_load_dwordx4 v24, s[36:39], s63 offen offset:0 lds
  buffer_load_dwordx4 v25, s[36:39], s63 offen offset:1024 lds
  s_waitcnt vmcnt(8)
  s_barrier
  s_add_u32 m0, s60, 0
  s_mov_b32 s64, s18
  s_add_u32 s64, s64, s67
  s_add_u32 s64, s64, 98304
  buffer_load_dwordx4 v26, s[44:47], s64 offen offset:0 sc1 lds
  buffer_load_dwordx4 v26, s[44:47], s64 offen offset:1024 sc1 lds
  s_add_u32 m0, s60, 8192
  s_mov_b32 s63, s18
  s_lshl3_add_u32 s63, s63, 1048576
  buffer_load_dwordx4 v24, s[36:39], s63 offen offset:0 lds
  buffer_load_dwordx4 v25, s[36:39], s63 offen offset:1024 lds
  s_waitcnt vmcnt(10)
  s_barrier
  s_add_u32 m0, s60, 16384
  s_mov_b32 s64, s19
  s_add_u32 s64, s64, s67
  s_add_u32 s64, s64, 98304
  buffer_load_dwordx4 v26, s[44:47], s64 offen offset:0 sc1 lds
  buffer_load_dwordx4 v26, s[44:47], s64 offen offset:1024 sc1 lds
  s_add_u32 m0, s60, 81920
  s_mov_b32 s63, s19
  s_lshl3_add_u32 s63, s63, 1048576
  buffer_load_dwordx4 v24, s[36:39], s63 offen offset:0 lds
  buffer_load_dwordx4 v25, s[36:39], s63 offen offset:1024 lds
  s_waitcnt vmcnt(10)
  s_barrier
  s_add_u32 m0, s60, 24576
  s_mov_b32 s64, s22
  s_add_u32 s64, s64, s67
  s_add_u32 s64, s64, 98304
  buffer_load_dwordx4 v26, s[44:47], s64 offen offset:0 sc1 lds
  buffer_load_dwordx4 v26, s[44:47], s64 offen offset:1024 sc1 lds
  s_add_u32 m0, s60, 40960
  s_mov_b32 s63, s22
  s_lshl3_add_u32 s63, s63, 1048576
  buffer_load_dwordx4 v24, s[36:39], s63 offen offset:0 lds
  buffer_load_dwordx4 v25, s[36:39], s63 offen offset:1024 lds
  s_waitcnt vmcnt(10)
  s_barrier
  s_add_u32 m0, s60, 49152
  s_mov_b32 s64, s9
  s_add_u32 s64, s64, s67
  s_add_u32 s64, s64, 131072
  buffer_load_dwordx4 v26, s[44:47], s64 offen offset:0 sc1 lds
  buffer_load_dwordx4 v26, s[44:47], s64 offen offset:1024 sc1 lds
  s_add_u32 m0, s60, 90112
  s_mov_b32 s63, s9
  s_lshl3_add_u32 s63, s63, 1310720
  buffer_load_dwordx4 v24, s[36:39], s63 offen offset:0 lds
  buffer_load_dwordx4 v25, s[36:39], s63 offen offset:1024 lds
  s_waitcnt vmcnt(10)
  s_barrier
  s_add_u32 m0, s60, 57344
  s_mov_b32 s64, s18
  s_add_u32 s64, s64, s67
  s_add_u32 s64, s64, 131072
  buffer_load_dwordx4 v26, s[44:47], s64 offen offset:0 sc1 lds
  buffer_load_dwordx4 v26, s[44:47], s64 offen offset:1024 sc1 lds
  s_add_u32 m0, s60, 98304
  s_mov_b32 s63, s18
  s_lshl3_add_u32 s63, s63, 1310720
  buffer_load_dwordx4 v24, s[36:39], s63 offen offset:0 lds
  buffer_load_dwordx4 v25, s[36:39], s63 offen offset:1024 lds
  s_waitcnt vmcnt(10)
  s_barrier
  s_add_u32 m0, s60, 0
  s_mov_b32 s64, s19
  s_add_u32 s64, s64, s67
  s_add_u32 s64, s64, 131072
  buffer_load_dwordx4 v26, s[44:47], s64 offen offset:0 sc1 lds
  buffer_load_dwordx4 v26, s[44:47], s64 offen offset:1024 sc1 lds
  s_add_u32 m0, s60, 106496
  s_mov_b32 s63, s19
  s_lshl3_add_u32 s63, s63, 1310720
  buffer_load_dwordx4 v24, s[36:39], s63 offen offset:0 lds
  buffer_load_dwordx4 v25, s[36:39], s63 offen offset:1024 lds
  s_waitcnt vmcnt(10)
  s_barrier
  s_add_u32 m0, s60, 16384
  s_mov_b32 s64, s22
  s_add_u32 s64, s64, s67
  s_add_u32 s64, s64, 131072
  buffer_load_dwordx4 v26, s[44:47], s64 offen offset:0 sc1 lds
  buffer_load_dwordx4 v26, s[44:47], s64 offen offset:1024 sc1 lds
  s_add_u32 m0, s60, 32768
  s_mov_b32 s63, s22
  s_lshl3_add_u32 s63, s63, 1310720
  buffer_load_dwordx4 v24, s[36:39], s63 offen offset:0 lds
  buffer_load_dwordx4 v25, s[36:39], s63 offen offset:1024 lds
  s_waitcnt vmcnt(10)
  s_barrier
  s_add_u32 m0, s60, 24576
  s_mov_b32 s64, s9
  s_add_u32 s64, s64, s67
  s_add_u32 s64, s64, 163840
  buffer_load_dwordx4 v26, s[44:47], s64 offen offset:0 sc1 lds
  buffer_load_dwordx4 v26, s[44:47], s64 offen offset:1024 sc1 lds
  s_add_u32 m0, s60, 65536
  s_mov_b32 s63, s9
  s_lshl3_add_u32 s63, s63, 1572864
  buffer_load_dwordx4 v24, s[36:39], s63 offen offset:0 lds
  buffer_load_dwordx4 v25, s[36:39], s63 offen offset:1024 lds
  s_waitcnt vmcnt(10)
  s_barrier
  s_add_u32 m0, s60, 49152
  s_mov_b32 s64, s18
  s_add_u32 s64, s64, s67
  s_add_u32 s64, s64, 163840
  buffer_load_dwordx4 v26, s[44:47], s64 offen offset:0 sc1 lds
  buffer_load_dwordx4 v26, s[44:47], s64 offen offset:1024 sc1 lds
  s_add_u32 m0, s60, 73728
  s_mov_b32 s63, s18
  s_lshl3_add_u32 s63, s63, 1572864
  buffer_load_dwordx4 v24, s[36:39], s63 offen offset:0 lds
  buffer_load_dwordx4 v25, s[36:39], s63 offen offset:1024 lds
  s_waitcnt vmcnt(10)
  s_barrier
  s_add_u32 m0, s60, 8192
  s_mov_b32 s64, s19
  s_add_u32 s64, s64, s67
  s_add_u32 s64, s64, 163840
  buffer_load_dwordx4 v26, s[44:47], s64 offen offset:0 sc1 lds
  buffer_load_dwordx4 v26, s[44:47], s64 offen offset:1024 sc1 lds
  s_add_u32 m0, s60, 57344
  s_mov_b32 s63, s19
  s_lshl3_add_u32 s63, s63, 1572864
  buffer_load_dwordx4 v24, s[36:39], s63 offen offset:0 lds
  buffer_load_dwordx4 v25, s[36:39], s63 offen offset:1024 lds
  s_waitcnt vmcnt(10)
  s_barrier
  s_add_u32 m0, s60, 0
  s_mov_b32 s64, s22
  s_add_u32 s64, s64, s67
  s_add_u32 s64, s64, 163840
  buffer_load_dwordx4 v26, s[44:47], s64 offen offset:0 sc1 lds
  buffer_load_dwordx4 v26, s[44:47], s64 offen offset:1024 sc1 lds
  s_add_u32 m0, s60, 81920
  s_mov_b32 s63, s22
  s_lshl3_add_u32 s63, s63, 1572864
  buffer_load_dwordx4 v24, s[36:39], s63 offen offset:0 lds
  buffer_load_dwordx4 v25, s[36:39], s63 offen offset:1024 lds
  s_waitcnt vmcnt(10)
  s_barrier
  s_add_u32 m0, s60, 16384
  s_mov_b32 s64, s9
  s_add_u32 s64, s64, s67
  s_add_u32 s64, s64, 196608
  buffer_load_dwordx4 v26, s[44:47], s64 offen offset:0 sc1 lds
  buffer_load_dwordx4 v26, s[44:47], s64 offen offset:1024 sc1 lds
  s_add_u32 m0, s60, 40960
  s_mov_b32 s63, s9
  s_lshl3_add_u32 s63, s63, 0
  buffer_load_dwordx4 v24, s[40:43], s63 offen offset:0 lds
  buffer_load_dwordx4 v25, s[40:43], s63 offen offset:1024 lds
  s_waitcnt vmcnt(10)
  s_barrier
  s_add_u32 m0, s60, 24576
  s_mov_b32 s64, s18
  s_add_u32 s64, s64, s67
  s_add_u32 s64, s64, 196608
  buffer_load_dwordx4 v26, s[44:47], s64 offen offset:0 sc1 lds
  buffer_load_dwordx4 v26, s[44:47], s64 offen offset:1024 sc1 lds
  s_waitcnt vmcnt(8)
  s_barrier
  s_add_u32 m0, s60, 49152
  s_mov_b32 s64, s19
  s_add_u32 s64, s64, s67
  s_add_u32 s64, s64, 196608
  buffer_load_dwordx4 v26, s[44:47], s64 offen offset:0 sc1 lds
  buffer_load_dwordx4 v26, s[44:47], s64 offen offset:1024 sc1 lds
  s_add_u32 m0, s60, 90112
  s_mov_b32 s63, s18
  s_lshl3_add_u32 s63, s63, 0
  buffer_load_dwordx4 v24, s[40:43], s63 offen offset:0 lds
  buffer_load_dwordx4 v25, s[40:43], s63 offen offset:1024 lds
  s_waitcnt vmcnt(8)
  s_barrier
  s_add_u32 m0, s60, 8192
  s_mov_b32 s64, s22
  s_add_u32 s64, s64, s67
  s_add_u32 s64, s64, 196608
  buffer_load_dwordx4 v26, s[44:47], s64 offen offset:0 sc1 lds
  buffer_load_dwordx4 v26, s[44:47], s64 offen offset:1024 sc1 lds
  s_add_u32 m0, s60, 98304
  s_mov_b32 s64, s9
  s_add_u32 s64, s64, s67
  s_add_u32 s64, s64, 229376
  buffer_load_dwordx4 v26, s[44:47], s64 offen offset:0 sc1 lds
  buffer_load_dwordx4 v26, s[44:47], s64 offen offset:1024 sc1 lds
  s_add_u32 m0, s60, 106496
  s_mov_b32 s64, s18
  s_add_u32 s64, s64, s67
  s_add_u32 s64, s64, 229376
  buffer_load_dwordx4 v26, s[44:47], s64 offen offset:0 sc1 lds
  buffer_load_dwordx4 v26, s[44:47], s64 offen offset:1024 sc1 lds
  s_add_u32 m0, s60, 114688
  s_mov_b32 s64, s19
  s_add_u32 s64, s64, s67
  s_add_u32 s64, s64, 229376
  buffer_load_dwordx4 v26, s[44:47], s64 offen offset:0 sc1 lds
  buffer_load_dwordx4 v26, s[44:47], s64 offen offset:1024 sc1 lds
  s_add_u32 m0, s60, 122880
  s_mov_b32 s63, s19
  s_lshl3_add_u32 s63, s63, 0
  buffer_load_dwordx4 v24, s[40:43], s63 offen offset:0 lds
  buffer_load_dwordx4 v25, s[40:43], s63 offen offset:1024 lds
  s_waitcnt vmcnt(14)
  s_barrier
  s_add_u32 m0, s60, 0
  s_mov_b32 s64, s22
  s_add_u32 s64, s64, s67
  s_add_u32 s64, s64, 229376
  buffer_load_dwordx4 v26, s[44:47], s64 offen offset:0 sc1 lds
  buffer_load_dwordx4 v26, s[44:47], s64 offen offset:1024 sc1 lds
  s_add_u32 m0, s60, 32768
  s_mov_b32 s63, s22
  s_lshl3_add_u32 s63, s63, 0
  buffer_load_dwordx4 v24, s[40:43], s63 offen offset:0 lds
  buffer_load_dwordx4 v25, s[40:43], s63 offen offset:1024 lds
  s_waitcnt vmcnt(16)
  s_barrier
  s_add_u32 m0, s60, 16384
  s_mov_b32 s64, s9
  s_add_u32 s64, s64, s67
  s_add_u32 s64, s64, 262144
  buffer_load_dwordx4 v26, s[44:47], s64 offen offset:0 sc1 lds
  buffer_load_dwordx4 v26, s[44:47], s64 offen offset:1024 sc1 lds
  s_add_u32 m0, s60, 65536
  s_mov_b32 s63, s9
  s_lshl3_add_u32 s63, s63, 262144
  buffer_load_dwordx4 v24, s[40:43], s63 offen offset:0 lds
  buffer_load_dwordx4 v25, s[40:43], s63 offen offset:1024 lds
  s_waitcnt vmcnt(16)
  s_barrier
  s_add_u32 m0, s60, 24576
  s_mov_b32 s64, s18
  s_add_u32 s64, s64, s67
  s_add_u32 s64, s64, 262144
  buffer_load_dwordx4 v26, s[44:47], s64 offen offset:0 sc1 lds
  buffer_load_dwordx4 v26, s[44:47], s64 offen offset:1024 sc1 lds
  s_add_u32 m0, s60, 73728
  s_mov_b32 s63, s18
  s_lshl3_add_u32 s63, s63, 262144
  buffer_load_dwordx4 v24, s[40:43], s63 offen offset:0 lds
  buffer_load_dwordx4 v25, s[40:43], s63 offen offset:1024 lds
  s_waitcnt vmcnt(18)
  s_barrier
  s_add_u32 m0, s60, 49152
  s_mov_b32 s64, s19
  s_add_u32 s64, s64, s67
  s_add_u32 s64, s64, 262144
  buffer_load_dwordx4 v26, s[44:47], s64 offen offset:0 sc1 lds
  buffer_load_dwordx4 v26, s[44:47], s64 offen offset:1024 sc1 lds
  s_add_u32 m0, s60, 57344
  s_mov_b32 s63, s19
  s_lshl3_add_u32 s63, s63, 262144
  buffer_load_dwordx4 v24, s[40:43], s63 offen offset:0 lds
  buffer_load_dwordx4 v25, s[40:43], s63 offen offset:1024 lds
  s_waitcnt vmcnt(20)
  s_barrier
  s_add_u32 m0, s60, 8192
  s_mov_b32 s64, s22
  s_add_u32 s64, s64, s67
  s_add_u32 s64, s64, 262144
  buffer_load_dwordx4 v26, s[44:47], s64 offen offset:0 sc1 lds
  buffer_load_dwordx4 v26, s[44:47], s64 offen offset:1024 sc1 lds
  s_add_u32 m0, s60, 81920
  s_mov_b32 s63, s22
  s_lshl3_add_u32 s63, s63, 262144
  buffer_load_dwordx4 v24, s[40:43], s63 offen offset:0 lds
  buffer_load_dwordx4 v25, s[40:43], s63 offen offset:1024 lds
  s_waitcnt vmcnt(20)
  s_barrier
  s_waitcnt vmcnt(16)
  s_barrier
  s_waitcnt vmcnt(12)
  s_barrier
  s_waitcnt vmcnt(8)
  s_barrier
  s_waitcnt vmcnt(4)
  s_barrier
  s_waitcnt vmcnt(0)
  s_barrier
  s_endpgm
L_slow_KVL_nonce:
  s_mov_b32 s68, 1000000
L_spin_KVL_nonce:
  s_sleep 4
  global_load_dword v35, v19, s[20:21] sc1
  s_waitcnt vmcnt(0)
  v_cmp_eq_u32 vcc, 0, v35
  s_cbranch_vccz L_back_KVL_nonce
  s_sub_u32 s68, s68, 1
  s_cmp_lg_u32 s68, 0
  s_cbranch_scc1 L_spin_KVL_nonce
  s_branch L_back_KVL_nonce
L_slow_KVL_hq:
  s_mov_b32 s68, 1000000
  s_cmp_lg_u32 s52, 0
  s_cbranch_scc1 L_lds0_KVL_hq
L_spin_KVL_hq:
  s_sleep 4
  buffer_load_dword v60, v28, s[44:47], 0 offen sc1
  s_waitcnt vmcnt(0)
  v_cmp_ne_u32 vcc, v60, v35
  s_cbranch_vccz L_back_KVL_hq
  s_sub_u32 s68, s68, 1
  s_cmp_lg_u32 s68, 0
  s_cbranch_scc1 L_spin_KVL_hq
  s_branch L_back_KVL_hq
L_lds0_KVL_hq:
  s_lshl_b32 s68, s68, 3
L_lds_KVL_hq:
  s_sleep 1
  ds_read_b32 v6, v31 offset:0
  s_waitcnt lgkmcnt(0)
  v_cmp_ne_u32 vcc, v6, v35
  s_cbranch_vccz L_post_KVL_hq
  s_sub_u32 s68, s68, 1
  s_cmp_lg_u32 s68, 0
  s_cbranch_scc1 L_lds_KVL_hq
  s_branch L_post_KVL_hq
L_exit:
  s_endpgm
L_end:
.section .rodata,"a"
.p2align 6
.amdhsa_kernel gated_mix__linear_attn_block__dense_activation_relu__prompt_kernel
  .amdhsa_next_free_vgpr 256
  .amdhsa_next_free_sgpr 102
  .amdhsa_accum_offset 128
  .amdhsa_group_segment_fixed_size 0
  .amdhsa_kernarg_size 80
  .amdhsa_user_sgpr_count 2
  .amdhsa_user_sgpr_kernarg_segment_ptr 1
  .amdhsa_system_sgpr_workgroup_id_x 1
.end_amdhsa_kernel
```
